```python
import torch

def _softmax(x, axis=-1):
    return torch.softmax(x, dim=axis)
def _gelu(x):
    return torch.nn.functional.gelu(x, approximate="tanh")
def _silu(x):
    return torch.nn.functional.silu(x)
def _sigmoid(x):
    return torch.sigmoid(x)
def _layernorm(x, axis=-1, eps=1e-5):
    m = x.mean(dim=axis, keepdim=True)
    v = x.var(dim=axis, keepdim=True, unbiased=False)
    return (x - m) / torch.sqrt(v + eps)
def _scatter_add(tgt, idx, src, axis=0):
    return tgt.clone().index_add_(axis, idx, src)
def _segment_sum(src, seg, n):
    out = torch.zeros((n,) + src.shape[1:], dtype=src.dtype)
    return out.index_add_(0, seg, src)
def _pad(x, pw):
    flat = tuple(v for pair in reversed(pw) for v in pair)
    return torch.nn.functional.pad(x, flat)

kernel_name = 'interleave_layers__gqa_block_cached__glu_gated_swiglu__decode'

def setup_inputs():

    _w = (lambda a: (lambda t: t.to(torch.bfloat16) if t.is_floating_point() else t)(torch.as_tensor(a)))
    def _A_setup():
        B, Sq, D = 1, 1, 512
        Hq, Hkv, Sk, Dh = 32, 8, 65536, 128
        assert Hq % Hkv == 0, (Hq, Hkv)
        return {
            "x": _w((lambda *s: torch.randn(*s, dtype=torch.bfloat16) * 0.05)(B, Sq, D)),
            "k_cache": _w((lambda *s: torch.randn(*s, dtype=torch.bfloat16) * 0.8)(B, Hkv, Sk, Dh)),
            "v_cache": _w((lambda *s: torch.randn(*s, dtype=torch.bfloat16) * 1.6)(B, Hkv, Sk, Dh)),
            "wq": _w((lambda *s: torch.randn(*s, dtype=torch.bfloat16) * 0.8)(D, Hq * Dh) * (D ** -0.5)),
            "wo": _w((lambda *s: torch.randn(*s, dtype=torch.bfloat16) * 1.6)(Hq * Dh, D) * ((Hq * Dh) ** -0.5)),
        }
    _A_in = _A_setup()

    def _B_setup():
        B, S, D, F = 1, 1, 512, 1792
        return {
            "x": _w((lambda *s: torch.randn(*s, dtype=torch.bfloat16) * 0.05)(B, S, D)),
            "w1": _w((lambda *s: torch.randn(*s, dtype=torch.bfloat16) * 0.4)(D, F) * (2.0 / D) ** 0.5),
            "w3": _w((lambda *s: torch.randn(*s, dtype=torch.bfloat16) * 0.4)(D, F) * (2.0 / D) ** 0.5),
            "w2": _w((lambda *s: torch.randn(*s, dtype=torch.bfloat16) * 0.4)(F, D) * (2.0 / F) ** 0.5),
        }
    _B_in = _B_setup()

    return {
        "A_x": _A_in["x"],
        "A_k_cache": _A_in["k_cache"],
        "A_v_cache": _A_in["v_cache"],
        "A_wq": _A_in["wq"],
        "A_wo": _A_in["wo"],
        "B_x": _B_in["x"],
        "B_w1": _B_in["w1"],
        "B_w3": _B_in["w3"],
        "B_w2": _B_in["w2"],
    }

def reference(A_x, A_k_cache, A_v_cache, A_wq, A_wo, B_x, B_w1, B_w3, B_w2):
    def _A_ref(x, k_cache, v_cache, wq, wo):
        B, Sq, D = x.shape
        Hq, Dh = 32, 128
        Hkv = k_cache.shape[1]
        rep = Hq // Hkv
        q = (lambda x, *d: x.permute(*d))((x @ wq).reshape(B, Sq, Hq, Dh), 0, 2, 1, 3)
        k = (lambda x, n, axis: torch.repeat_interleave(x, n, dim=axis))(k_cache, rep, axis=1)
        v = (lambda x, n, axis: torch.repeat_interleave(x, n, dim=axis))(v_cache, rep, axis=1)
        scores = torch.einsum("bhqd,bhkd->bhqk", q, k) * (Dh ** -0.5)
        p = _softmax(scores, axis=-1)
        o = torch.einsum("bhqk,bhkd->bhqd", p, v)
        return (lambda x, *d: x.permute(*d))(o, 0, 2, 1, 3).reshape(B, Sq, Hq * Dh) @ wo

    def _B_ref(x, w1, w3, w2):
        gate = torch.einsum("bsd,df->bsf", x, w1)
        up = torch.einsum("bsd,df->bsf", x, w3)
        h = _silu(gate) * up
        out = torch.einsum("bsf,fd->bsd", h, w2)
        return out

    x = A_x
    x = x + _A_ref(_layernorm(x, axis=-1), A_k_cache, A_v_cache, A_wq, A_wo)
    x = x + _B_ref(_layernorm(x, axis=-1), B_w1, B_w3, B_w2)
    x = x + _A_ref(_layernorm(x, axis=-1), A_k_cache, A_v_cache, A_wq, A_wo)
    x = x + _B_ref(_layernorm(x, axis=-1), B_w1, B_w3, B_w2)
    return x
```

```asm
; @launch grid=(256,1,1) block=(256,1,1) lds=163840
.amdgcn_target "amdgcn-amd-amdhsa--gfx950"
.text
.globl interleave_layers__gqa_block_cached__glu_gated_swiglu__decode_kernel
.p2align 8
.type interleave_layers__gqa_block_cached__glu_gated_swiglu__decode_kernel,@function
interleave_layers__gqa_block_cached__glu_gated_swiglu__decode_kernel:
  s_cmp_ge_u32 s2, 256
  s_cbranch_scc1 L_end
  s_load_dwordx16 s[4:19], s[0:1], 0
  s_load_dwordx8 s[20:27], s[0:1], 64
  v_lshrrev_b32 v124, 6, v0
  s_nop 0
  v_readfirstlane_b32 s3, v124
  v_and_b32 v1, 63, v0
  v_and_b32 v2, 15, v1
  v_lshrrev_b32 v3, 4, v1
  s_lshr_b32 s28, s2, 5
  s_and_b32 s29, s2, 31
  s_lshl_b32 s68, s28, 24
  s_lshl_b32 s31, s3, 12
  s_add_u32 s68, s68, s31
  s_mov_b32 s30, 400000
  s_mov_b32 s60, 0x05040100
  s_mov_b32 s61, 0x07060302
  s_mov_b32 s62, 0x3fb8aa3b
  s_mov_b32 s58, 0x3db504f3
  s_mov_b32 s63, 0xfffffffe
  s_and_b32 s31, s2, 7
  s_lshr_b32 s66, s2, 3
  s_lshl_b32 s64, s31, 5
  s_add_u32 s64, s64, s66
  s_mul_i32 s65, s31, 28
  s_add_u32 s65, s65, s66
  s_mul_i32 s47, s3, 36864
  s_add_u32 s47, s47, 16384
  v_xor_b32 v124, v2, v3
  v_lshlrev_b32 v124, 4, v124
  v_lshl_add_u32 v4, v3, 8, v124
  v_xor_b32 v5, 64, v4
  v_xor_b32 v6, 128, v4
  v_xor_b32 v7, 192, v4
  v_lshlrev_b32 v124, 1, v3
  v_xor_b32 v124, v2, v124
  v_lshlrev_b32 v124, 4, v124
  v_lshl_add_u32 v8, v3, 8, v124
  v_xor_b32 v9, 128, v8
  v_xor_b32 v124, v2, v3
  v_lshlrev_b32 v124, 4, v124
  v_lshl_add_u32 v124, v2, 8, v124
  v_xor_b32 v10, 0, v124
  v_add_u32 v10, s47, v10
  v_xor_b32 v11, 64, v124
  v_add_u32 v11, s47, v11
  v_xor_b32 v12, 128, v124
  v_add_u32 v12, s47, v12
  v_xor_b32 v13, 192, v124
  v_add_u32 v13, s47, v13
  v_lshrrev_b32 v124, 2, v2
  v_lshl_add_u32 v124, v3, 2, v124
  v_and_b32 v125, 7, v124
  v_lshlrev_b32 v125, 1, v125
  v_bfe_u32 v126, v2, 1, 1
  v_xor_b32 v125, v125, v126
  v_lshlrev_b32 v125, 4, v125
  v_lshl_add_u32 v125, v124, 8, v125
  v_and_b32 v126, 1, v2
  v_lshl_add_u32 v125, v126, 3, v125
  v_xor_b32 v14, 0, v125
  v_add_u32 v14, s47, v14
  v_xor_b32 v15, 32, v125
  v_add_u32 v15, s47, v15
  v_xor_b32 v16, 64, v125
  v_add_u32 v16, s47, v16
  v_xor_b32 v17, 96, v125
  v_add_u32 v17, s47, v17
  v_xor_b32 v18, 128, v125
  v_add_u32 v18, s47, v18
  v_xor_b32 v19, 160, v125
  v_add_u32 v19, s47, v19
  v_xor_b32 v20, 192, v125
  v_add_u32 v20, s47, v20
  v_xor_b32 v21, 224, v125
  v_add_u32 v21, s47, v21
  v_mov_b32 v30, 1
  v_lshrrev_b32 v25, 1, v1
  v_lshlrev_b32 v25, 7, v25
  v_and_b32 v124, 1, v1
  v_lshl_add_u32 v25, v124, 4, v25
  s_lshr_b32 s67, s2, 3
  s_lshl_b32 s67, s67, 2
  s_add_u32 s67, s67, s3
  s_lshl_b32 s67, s67, 7
  s_add_u32 s67, s67, 98304
  s_waitcnt lgkmcnt(0)
  s_lshl_b32 s31, s2, 14
  s_add_u32 s31, s31, 131072
  s_add_u32 s40, s26, s31
  s_addc_u32 s41, s27, 0
  s_add_u32 s92, s26, s67
  s_addc_u32 s93, s27, 0
  s_cmp_eq_u32 s3, 0
  s_cbranch_scc0 L_if_1
  s_lshl_b32 s31, s2, 7
  s_add_u32 s31, s31, 98304
  v_mov_b32 v124, s31
  v_mov_b32 v125, 0
  s_mov_b64 exec, 1
  global_store_dword v124, v125, s[26:27] sc1
  s_mov_b64 exec, -1
L_if_1:
  v_mov_b32 v84, -1
  v_mov_b32 v85, -1
  v_mov_b32 v86, -1
  v_mov_b32 v87, -1
  v_lshlrev_b32 v80, 4, v0
  v_add_u32 v81, 4096, v80
  v_add_u32 v82, 8192, v80
  v_add_u32 v83, 12288, v80
  global_store_dwordx4 v80, v[84:87], s[40:41] sc1
  global_store_dwordx4 v81, v[84:87], s[40:41] sc1
  global_store_dwordx4 v82, v[84:87], s[40:41] sc1
  s_cmp_ge_u32 s2, 224
  s_cselect_b32 s31, 0, -1
  v_mov_b32 v88, s31
  v_mov_b32 v89, s31
  v_mov_b32 v90, s31
  v_mov_b32 v91, s31
  global_store_dwordx4 v83, v[88:91], s[40:41] sc1
  v_lshrrev_b32 v80, 1, v0
  v_and_b32 v81, 1, v0
  s_lshl_b32 s31, s64, 7
  v_lshl_add_u32 v82, v80, 15, s31
  s_lshl_b32 s66, s2, 7
  s_add_u32 s66, s66, 57344
  v_lshl_add_u32 v83, v80, 12, s66
  v_cmp_gt_u32 vcc, 4, v0
  s_nop 1
  v_cndmask_b32 v82, v83, v82, vcc
  v_lshl_add_u32 v82, v81, 4, v82
  s_cmp_lt_u32 s2, 32
  s_cselect_b32 s31, 12, 4
  v_cmp_gt_u32 vcc, s31, v0
  s_nop 0
  s_and_saveexec_b64 s[56:57], vcc
  s_cbranch_execz L_noshclr
  global_store_dwordx4 v82, v[84:87], s[26:27] sc1
L_noshclr:
  s_mov_b64 exec, -1
  s_lshl_b32 s31, s29, 6
  s_add_u32 s31, s31, 0
  s_lshl_b32 s31, s31, 13
  s_add_u32 s31, s31, s68
  s_add_u32 s32, s6, s31
  s_addc_u32 s33, s7, 0
  s_add_u32 s34, s32, 16384
  s_addc_u32 s35, s33, 0
  s_add_u32 s36, s8, s31
  s_addc_u32 s37, s9, 0
  s_add_u32 s38, s36, 16384
  s_addc_u32 s39, s37, 0
  s_add_u32 m0, s47, 0
  s_nop 0
  global_load_lds_dwordx4 v4, s[32:33] offset:0 nt
  global_load_lds_dwordx4 v5, s[32:33] offset:1024 nt
  global_load_lds_dwordx4 v6, s[32:33] offset:2048 nt
  global_load_lds_dwordx4 v7, s[32:33] offset:3072 nt
  s_add_u32 m0, s47, 4096
  s_nop 0
  global_load_lds_dwordx4 v4, s[34:35] offset:0 nt
  global_load_lds_dwordx4 v5, s[34:35] offset:1024 nt
  global_load_lds_dwordx4 v6, s[34:35] offset:2048 nt
  global_load_lds_dwordx4 v7, s[34:35] offset:3072 nt
  s_add_u32 m0, s47, 8192
  s_nop 0
  global_load_lds_dwordx4 v8, s[36:37] offset:0 nt
  global_load_lds_dwordx4 v9, s[36:37] offset:1024 nt
  global_load_lds_dwordx4 v8, s[36:37] offset:2048 nt
  global_load_lds_dwordx4 v9, s[36:37] offset:3072 nt
  s_add_u32 m0, s47, 12288
  s_nop 0
  global_load_lds_dwordx4 v8, s[38:39] offset:0 nt
  global_load_lds_dwordx4 v9, s[38:39] offset:1024 nt
  global_load_lds_dwordx4 v8, s[38:39] offset:2048 nt
  global_load_lds_dwordx4 v9, s[38:39] offset:3072 nt
  s_lshl_b32 s31, s29, 6
  s_add_u32 s31, s31, 4
  s_lshl_b32 s31, s31, 13
  s_add_u32 s31, s31, s68
  s_add_u32 s32, s6, s31
  s_addc_u32 s33, s7, 0
  s_add_u32 s34, s32, 16384
  s_addc_u32 s35, s33, 0
  s_add_u32 s36, s8, s31
  s_addc_u32 s37, s9, 0
  s_add_u32 s38, s36, 16384
  s_addc_u32 s39, s37, 0
  s_add_u32 m0, s47, 16384
  s_nop 0
  global_load_lds_dwordx4 v4, s[32:33] offset:0 nt
  global_load_lds_dwordx4 v5, s[32:33] offset:1024 nt
  global_load_lds_dwordx4 v6, s[32:33] offset:2048 nt
  global_load_lds_dwordx4 v7, s[32:33] offset:3072 nt
  s_add_u32 m0, s47, 20480
  s_nop 0
  global_load_lds_dwordx4 v4, s[34:35] offset:0 nt
  global_load_lds_dwordx4 v5, s[34:35] offset:1024 nt
  global_load_lds_dwordx4 v6, s[34:35] offset:2048 nt
  global_load_lds_dwordx4 v7, s[34:35] offset:3072 nt
  s_add_u32 m0, s47, 24576
  s_nop 0
  global_load_lds_dwordx4 v8, s[36:37] offset:0 nt
  global_load_lds_dwordx4 v9, s[36:37] offset:1024 nt
  global_load_lds_dwordx4 v8, s[36:37] offset:2048 nt
  global_load_lds_dwordx4 v9, s[36:37] offset:3072 nt
  s_add_u32 m0, s47, 28672
  s_nop 0
  global_load_lds_dwordx4 v8, s[38:39] offset:0 nt
  global_load_lds_dwordx4 v9, s[38:39] offset:1024 nt
  global_load_lds_dwordx4 v8, s[38:39] offset:2048 nt
  global_load_lds_dwordx4 v9, s[38:39] offset:3072 nt
  s_waitcnt vmcnt(32)
  s_barrier
  v_cmp_eq_u32 vcc, 0, v0
  s_nop 0
  s_and_saveexec_b64 s[56:57], vcc
  s_cbranch_execz L_noatom
  v_mov_b32 v124, 0
  global_atomic_add v124, v30, s[24:25]
L_noatom:
  s_mov_b64 exec, -1
  v_lshlrev_b32 v116, 4, v1
  global_load_dwordx4 v[104:107], v116, s[4:5]
  v_and_b32 v124, 3, v0
  s_lshl_b32 s31, s29, 5
  v_lshl_add_u32 v124, v124, 3, s31
  global_load_dwordx2 v[26:27], v124, s[4:5]
  s_waitcnt vmcnt(30)
  ds_read_b128 v[128:131], v10 offset:0
  ds_read_b128 v[132:135], v11 offset:0
  ds_read_b128 v[136:139], v12 offset:0
  ds_read_b128 v[140:143], v13 offset:0
  s_waitcnt lgkmcnt(0)
  s_lshl_b32 s31, s29, 6
  s_add_u32 s31, s31, 8
  s_lshl_b32 s31, s31, 13
  s_add_u32 s31, s31, s68
  s_add_u32 s32, s6, s31
  s_addc_u32 s33, s7, 0
  s_add_u32 s34, s32, 16384
  s_addc_u32 s35, s33, 0
  s_add_u32 s36, s8, s31
  s_addc_u32 s37, s9, 0
  s_add_u32 s38, s36, 16384
  s_addc_u32 s39, s37, 0
  s_add_u32 m0, s47, 0
  s_nop 0
  global_load_lds_dwordx4 v4, s[32:33] offset:0 nt
  global_load_lds_dwordx4 v5, s[32:33] offset:1024 nt
  global_load_lds_dwordx4 v6, s[32:33] offset:2048 nt
  global_load_lds_dwordx4 v7, s[32:33] offset:3072 nt
  s_lshl_b32 s31, s3, 7
  v_lshl_add_u32 v24, v3, 3, s31
  v_lshlrev_b32 v24, 13, v24
  v_lshl_add_u32 v24, v2, 1, v24
  s_lshl_b32 s31, s64, 5
  s_add_u32 s44, s10, s31
  s_addc_u32 s45, s11, 0
  global_load_ushort v48, v24, s[44:45]
  s_add_u32 s44, s44, 8192
  s_addc_u32 s45, s45, 0
  global_load_ushort v49, v24, s[44:45]
  s_add_u32 s44, s44, 8192
  s_addc_u32 s45, s45, 0
  global_load_ushort v50, v24, s[44:45]
  s_add_u32 s44, s44, 8192
  s_addc_u32 s45, s45, 0
  global_load_ushort v51, v24, s[44:45]
  s_add_u32 s44, s44, 8192
  s_addc_u32 s45, s45, 0
  global_load_ushort v52, v24, s[44:45]
  s_add_u32 s44, s44, 8192
  s_addc_u32 s45, s45, 0
  global_load_ushort v53, v24, s[44:45]
  s_add_u32 s44, s44, 8192
  s_addc_u32 s45, s45, 0
  global_load_ushort v54, v24, s[44:45]
  s_add_u32 s44, s44, 8192
  s_addc_u32 s45, s45, 0
  global_load_ushort v55, v24, s[44:45]
  s_add_u32 s44, s44, 204800
  s_addc_u32 s45, s45, 0
  s_waitcnt vmcnt(38)
  ds_read_b128 v[144:147], v10 offset:4096
  ds_read_b128 v[148:151], v11 offset:4096
  ds_read_b128 v[152:155], v12 offset:4096
  ds_read_b128 v[156:159], v13 offset:4096
  s_waitcnt lgkmcnt(0)
  s_add_u32 m0, s47, 4096
  s_nop 0
  global_load_lds_dwordx4 v4, s[34:35] offset:0 nt
  global_load_lds_dwordx4 v5, s[34:35] offset:1024 nt
  global_load_lds_dwordx4 v6, s[34:35] offset:2048 nt
  global_load_lds_dwordx4 v7, s[34:35] offset:3072 nt
  global_load_ushort v56, v24, s[44:45]
  s_add_u32 s44, s44, 8192
  s_addc_u32 s45, s45, 0
  global_load_ushort v57, v24, s[44:45]
  s_add_u32 s44, s44, 8192
  s_addc_u32 s45, s45, 0
  global_load_ushort v58, v24, s[44:45]
  s_add_u32 s44, s44, 8192
  s_addc_u32 s45, s45, 0
  global_load_ushort v59, v24, s[44:45]
  s_add_u32 s44, s44, 8192
  s_addc_u32 s45, s45, 0
  global_load_ushort v60, v24, s[44:45]
  s_add_u32 s44, s44, 8192
  s_addc_u32 s45, s45, 0
  global_load_ushort v61, v24, s[44:45]
  s_add_u32 s44, s44, 8192
  s_addc_u32 s45, s45, 0
  global_load_ushort v62, v24, s[44:45]
  s_add_u32 s44, s44, 8192
  s_addc_u32 s45, s45, 0
  global_load_ushort v63, v24, s[44:45]
  s_add_u32 s44, s44, 204800
  s_addc_u32 s45, s45, 0
  s_waitcnt vmcnt(46)
  ds_read_b64_tr_b16 v[160:161], v14 offset:8192
  ds_read_b64_tr_b16 v[164:165], v15 offset:8192
  ds_read_b64_tr_b16 v[168:169], v16 offset:8192
  ds_read_b64_tr_b16 v[172:173], v17 offset:8192
  ds_read_b64_tr_b16 v[176:177], v18 offset:8192
  ds_read_b64_tr_b16 v[180:181], v19 offset:8192
  ds_read_b64_tr_b16 v[184:185], v20 offset:8192
  ds_read_b64_tr_b16 v[188:189], v21 offset:8192
  s_waitcnt lgkmcnt(0)
  s_add_u32 m0, s47, 8192
  s_nop 0
  global_load_lds_dwordx4 v8, s[36:37] offset:0 nt
  global_load_lds_dwordx4 v9, s[36:37] offset:1024 nt
  global_load_lds_dwordx4 v8, s[36:37] offset:2048 nt
  global_load_lds_dwordx4 v9, s[36:37] offset:3072 nt
  global_load_ushort v64, v24, s[44:45]
  s_add_u32 s44, s44, 8192
  s_addc_u32 s45, s45, 0
  global_load_ushort v65, v24, s[44:45]
  s_add_u32 s44, s44, 8192
  s_addc_u32 s45, s45, 0
  global_load_ushort v66, v24, s[44:45]
  s_add_u32 s44, s44, 8192
  s_addc_u32 s45, s45, 0
  global_load_ushort v67, v24, s[44:45]
  s_add_u32 s44, s44, 8192
  s_addc_u32 s45, s45, 0
  global_load_ushort v68, v24, s[44:45]
  s_add_u32 s44, s44, 8192
  s_addc_u32 s45, s45, 0
  global_load_ushort v69, v24, s[44:45]
  s_add_u32 s44, s44, 8192
  s_addc_u32 s45, s45, 0
  global_load_ushort v70, v24, s[44:45]
  s_add_u32 s44, s44, 8192
  s_addc_u32 s45, s45, 0
  global_load_ushort v71, v24, s[44:45]
  s_add_u32 s44, s44, 204800
  s_addc_u32 s45, s45, 0
  s_waitcnt vmcnt(54)
  ds_read_b64_tr_b16 v[162:163], v14 offset:12288
  ds_read_b64_tr_b16 v[166:167], v15 offset:12288
  ds_read_b64_tr_b16 v[170:171], v16 offset:12288
  ds_read_b64_tr_b16 v[174:175], v17 offset:12288
  ds_read_b64_tr_b16 v[178:179], v18 offset:12288
  ds_read_b64_tr_b16 v[182:183], v19 offset:12288
  ds_read_b64_tr_b16 v[186:187], v20 offset:12288
  ds_read_b64_tr_b16 v[190:191], v21 offset:12288
  s_waitcnt lgkmcnt(0)
  s_add_u32 m0, s47, 12288
  s_nop 0
  global_load_lds_dwordx4 v8, s[38:39] offset:0 nt
  global_load_lds_dwordx4 v9, s[38:39] offset:1024 nt
  global_load_lds_dwordx4 v8, s[38:39] offset:2048 nt
  global_load_lds_dwordx4 v9, s[38:39] offset:3072 nt
  global_load_ushort v72, v24, s[44:45]
  s_add_u32 s44, s44, 8192
  s_addc_u32 s45, s45, 0
  global_load_ushort v73, v24, s[44:45]
  s_add_u32 s44, s44, 8192
  s_addc_u32 s45, s45, 0
  global_load_ushort v74, v24, s[44:45]
  s_add_u32 s44, s44, 8192
  s_addc_u32 s45, s45, 0
  global_load_ushort v75, v24, s[44:45]
  s_add_u32 s44, s44, 8192
  s_addc_u32 s45, s45, 0
  global_load_ushort v76, v24, s[44:45]
  s_add_u32 s44, s44, 8192
  s_addc_u32 s45, s45, 0
  global_load_ushort v77, v24, s[44:45]
  s_add_u32 s44, s44, 8192
  s_addc_u32 s45, s45, 0
  global_load_ushort v78, v24, s[44:45]
  s_add_u32 s44, s44, 8192
  s_addc_u32 s45, s45, 0
  global_load_ushort v79, v24, s[44:45]
  s_add_u32 s44, s44, 204800
  s_addc_u32 s45, s45, 0
  s_waitcnt vmcnt(62)
  ds_read_b128 v[192:195], v10 offset:16384
  ds_read_b128 v[196:199], v11 offset:16384
  ds_read_b128 v[200:203], v12 offset:16384
  ds_read_b128 v[204:207], v13 offset:16384
  s_waitcnt lgkmcnt(0)
  s_lshl_b32 s31, s29, 6
  s_add_u32 s31, s31, 12
  s_lshl_b32 s31, s31, 13
  s_add_u32 s31, s31, s68
  s_add_u32 s32, s6, s31
  s_addc_u32 s33, s7, 0
  s_add_u32 s34, s32, 16384
  s_addc_u32 s35, s33, 0
  s_add_u32 s36, s8, s31
  s_addc_u32 s37, s9, 0
  s_add_u32 s38, s36, 16384
  s_addc_u32 s39, s37, 0
  s_add_u32 m0, s47, 16384
  s_nop 0
  global_load_lds_dwordx4 v4, s[32:33] offset:0 nt
  global_load_lds_dwordx4 v5, s[32:33] offset:1024 nt
  global_load_lds_dwordx4 v6, s[32:33] offset:2048 nt
  global_load_lds_dwordx4 v7, s[32:33] offset:3072 nt
  s_lshl_b32 s31, s2, 14
  s_lshl_b32 s66, s3, 12
  s_add_u32 s31, s31, s66
  s_add_u32 s42, s12, s31
  s_addc_u32 s43, s13, 0
  v_lshlrev_b32 v31, 4, v1
  s_add_u32 m0, s47, 32768
  s_nop 0
  global_load_lds_dwordx4 v31, s[42:43] offset:0 nt
  global_load_lds_dwordx4 v31, s[42:43] offset:1024 nt
  global_load_lds_dwordx4 v31, s[42:43] offset:2048 nt
  global_load_lds_dwordx4 v31, s[42:43] offset:3072 nt
  s_waitcnt vmcnt(63)
  ds_read_b128 v[208:211], v10 offset:20480
  ds_read_b128 v[212:215], v11 offset:20480
  ds_read_b128 v[216:219], v12 offset:20480
  ds_read_b128 v[220:223], v13 offset:20480
  s_waitcnt lgkmcnt(0)
  s_add_u32 m0, s47, 20480
  s_nop 0
  global_load_lds_dwordx4 v4, s[34:35] offset:0 nt
  global_load_lds_dwordx4 v5, s[34:35] offset:1024 nt
  global_load_lds_dwordx4 v6, s[34:35] offset:2048 nt
  global_load_lds_dwordx4 v7, s[34:35] offset:3072 nt
  s_waitcnt vmcnt(63)
  ds_read_b64_tr_b16 v[224:225], v14 offset:24576
  ds_read_b64_tr_b16 v[228:229], v15 offset:24576
  ds_read_b64_tr_b16 v[232:233], v16 offset:24576
  ds_read_b64_tr_b16 v[236:237], v17 offset:24576
  ds_read_b64_tr_b16 v[240:241], v18 offset:24576
  ds_read_b64_tr_b16 v[244:245], v19 offset:24576
  ds_read_b64_tr_b16 v[248:249], v20 offset:24576
  ds_read_b64_tr_b16 v[252:253], v21 offset:24576
  s_waitcnt lgkmcnt(0)
  s_add_u32 m0, s47, 24576
  s_nop 0
  global_load_lds_dwordx4 v8, s[36:37] offset:0 nt
  global_load_lds_dwordx4 v9, s[36:37] offset:1024 nt
  global_load_lds_dwordx4 v8, s[36:37] offset:2048 nt
  global_load_lds_dwordx4 v9, s[36:37] offset:3072 nt
  s_waitcnt vmcnt(63)
  ds_read_b64_tr_b16 v[226:227], v14 offset:28672
  ds_read_b64_tr_b16 v[230:231], v15 offset:28672
  ds_read_b64_tr_b16 v[234:235], v16 offset:28672
  ds_read_b64_tr_b16 v[238:239], v17 offset:28672
  ds_read_b64_tr_b16 v[242:243], v18 offset:28672
  ds_read_b64_tr_b16 v[246:247], v19 offset:28672
  ds_read_b64_tr_b16 v[250:251], v20 offset:28672
  ds_read_b64_tr_b16 v[254:255], v21 offset:28672
  s_waitcnt lgkmcnt(0)
  s_add_u32 m0, s47, 28672
  s_nop 0
  global_load_lds_dwordx4 v8, s[38:39] offset:0 nt
  global_load_lds_dwordx4 v9, s[38:39] offset:1024 nt
  global_load_lds_dwordx4 v8, s[38:39] offset:2048 nt
  global_load_lds_dwordx4 v9, s[38:39] offset:3072 nt
  v_mov_b32 v28, 0
  global_load_dword v29, v28, s[24:25] sc1
  s_waitcnt vmcnt(63)
  ds_read_b128 a[0:3], v10 offset:0
  ds_read_b128 a[4:7], v11 offset:0
  ds_read_b128 a[8:11], v12 offset:0
  ds_read_b128 a[12:15], v13 offset:0
  s_waitcnt lgkmcnt(0)
  s_lshl_b32 s31, s29, 6
  s_add_u32 s31, s31, 16
  s_lshl_b32 s31, s31, 13
  s_add_u32 s31, s31, s68
  s_add_u32 s32, s6, s31
  s_addc_u32 s33, s7, 0
  s_add_u32 s34, s32, 16384
  s_addc_u32 s35, s33, 0
  s_add_u32 s36, s8, s31
  s_addc_u32 s37, s9, 0
  s_add_u32 s38, s36, 16384
  s_addc_u32 s39, s37, 0
  s_add_u32 m0, s47, 0
  s_nop 0
  global_load_lds_dwordx4 v4, s[32:33] offset:0 nt
  global_load_lds_dwordx4 v5, s[32:33] offset:1024 nt
  global_load_lds_dwordx4 v6, s[32:33] offset:2048 nt
  global_load_lds_dwordx4 v7, s[32:33] offset:3072 nt
  s_waitcnt vmcnt(57)
  ds_read_b128 a[16:19], v10 offset:4096
  ds_read_b128 a[20:23], v11 offset:4096
  ds_read_b128 a[24:27], v12 offset:4096
  ds_read_b128 a[28:31], v13 offset:4096
  s_waitcnt lgkmcnt(0)
  s_add_u32 m0, s47, 4096
  s_nop 0
  global_load_lds_dwordx4 v4, s[34:35] offset:0 nt
  global_load_lds_dwordx4 v5, s[34:35] offset:1024 nt
  global_load_lds_dwordx4 v6, s[34:35] offset:2048 nt
  global_load_lds_dwordx4 v7, s[34:35] offset:3072 nt
  s_waitcnt vmcnt(49)
  ds_read_b64_tr_b16 a[32:33], v14 offset:8192
  ds_read_b64_tr_b16 a[36:37], v15 offset:8192
  ds_read_b64_tr_b16 a[40:41], v16 offset:8192
  ds_read_b64_tr_b16 a[44:45], v17 offset:8192
  ds_read_b64_tr_b16 a[48:49], v18 offset:8192
  ds_read_b64_tr_b16 a[52:53], v19 offset:8192
  ds_read_b64_tr_b16 a[56:57], v20 offset:8192
  ds_read_b64_tr_b16 a[60:61], v21 offset:8192
  s_waitcnt lgkmcnt(0)
  s_add_u32 m0, s47, 8192
  s_nop 0
  global_load_lds_dwordx4 v8, s[36:37] offset:0 nt
  global_load_lds_dwordx4 v9, s[36:37] offset:1024 nt
  global_load_lds_dwordx4 v8, s[36:37] offset:2048 nt
  global_load_lds_dwordx4 v9, s[36:37] offset:3072 nt
  s_waitcnt vmcnt(41)
  ds_read_b64_tr_b16 a[34:35], v14 offset:12288
  ds_read_b64_tr_b16 a[38:39], v15 offset:12288
  ds_read_b64_tr_b16 a[42:43], v16 offset:12288
  ds_read_b64_tr_b16 a[46:47], v17 offset:12288
  ds_read_b64_tr_b16 a[50:51], v18 offset:12288
  ds_read_b64_tr_b16 a[54:55], v19 offset:12288
  ds_read_b64_tr_b16 a[58:59], v20 offset:12288
  ds_read_b64_tr_b16 a[62:63], v21 offset:12288
  s_waitcnt lgkmcnt(0)
  s_add_u32 m0, s47, 12288
  s_nop 0
  global_load_lds_dwordx4 v8, s[38:39] offset:0 nt
  global_load_lds_dwordx4 v9, s[38:39] offset:1024 nt
  global_load_lds_dwordx4 v8, s[38:39] offset:2048 nt
  global_load_lds_dwordx4 v9, s[38:39] offset:3072 nt
  s_waitcnt vmcnt(37)
  v_lshl_or_b32 v32, v49, 16, v48
  v_lshl_or_b32 v33, v51, 16, v50
  v_lshl_or_b32 v34, v53, 16, v52
  v_lshl_or_b32 v35, v55, 16, v54
  v_lshl_or_b32 v36, v57, 16, v56
  v_lshl_or_b32 v37, v59, 16, v58
  v_lshl_or_b32 v38, v61, 16, v60
  v_lshl_or_b32 v39, v63, 16, v62
  v_lshl_or_b32 v40, v65, 16, v64
  v_lshl_or_b32 v41, v67, 16, v66
  v_lshl_or_b32 v42, v69, 16, v68
  v_lshl_or_b32 v43, v71, 16, v70
  v_lshl_or_b32 v44, v73, 16, v72
  v_lshl_or_b32 v45, v75, 16, v74
  v_lshl_or_b32 v46, v77, 16, v76
  v_lshl_or_b32 v47, v79, 16, v78
  s_cmp_eq_u32 s3, 0
  s_cbranch_scc0 L_if_2
  v_lshlrev_b32 v116, 4, v1
  v_lshlrev_b32 v108, 16, v104
  v_and_b32 v109, 0xffff0000, v104
  v_lshlrev_b32 v110, 16, v105
  v_and_b32 v111, 0xffff0000, v105
  v_lshlrev_b32 v112, 16, v106
  v_and_b32 v113, 0xffff0000, v106
  v_lshlrev_b32 v114, 16, v107
  v_and_b32 v115, 0xffff0000, v107
  v_readfirstlane_b32 s67, v108
  s_nop 1
  v_subrev_f32 v104, s67, v108
  v_subrev_f32 v105, s67, v109
  v_add_f32 v117, v104, v105
  v_mul_f32 v118, v104, v104
  v_mul_f32 v119, v105, v105
  v_subrev_f32 v104, s67, v110
  v_subrev_f32 v105, s67, v111
  v_add_f32 v117, v117, v104
  v_fmac_f32 v118, v104, v104
  v_add_f32 v117, v117, v105
  v_fmac_f32 v119, v105, v105
  v_subrev_f32 v104, s67, v112
  v_subrev_f32 v105, s67, v113
  v_add_f32 v117, v117, v104
  v_fmac_f32 v118, v104, v104
  v_add_f32 v117, v117, v105
  v_fmac_f32 v119, v105, v105
  v_subrev_f32 v104, s67, v114
  v_subrev_f32 v105, s67, v115
  v_add_f32 v117, v117, v104
  v_fmac_f32 v118, v104, v104
  v_add_f32 v117, v117, v105
  v_fmac_f32 v119, v105, v105
  v_add_f32 v118, v118, v119
  v_add_f32_dpp v117, v117, v117 quad_perm:[1,0,3,2] row_mask:0xf bank_mask:0xf
  s_nop 0
  v_add_f32_dpp v118, v118, v118 quad_perm:[1,0,3,2] row_mask:0xf bank_mask:0xf
  v_add_f32_dpp v117, v117, v117 quad_perm:[2,3,0,1] row_mask:0xf bank_mask:0xf
  s_nop 0
  v_add_f32_dpp v118, v118, v118 quad_perm:[2,3,0,1] row_mask:0xf bank_mask:0xf
  v_add_f32_dpp v117, v117, v117 row_half_mirror row_mask:0xf bank_mask:0xf
  s_nop 0
  v_add_f32_dpp v118, v118, v118 row_half_mirror row_mask:0xf bank_mask:0xf
  v_add_f32_dpp v117, v117, v117 row_mirror row_mask:0xf bank_mask:0xf
  s_nop 0
  v_add_f32_dpp v118, v118, v118 row_mirror row_mask:0xf bank_mask:0xf
  v_mov_b32 v106, v117
  v_mov_b32 v107, v118
  s_nop 0
  v_permlane16_swap_b32 v117, v106
  v_permlane16_swap_b32 v118, v107
  v_add_f32 v117, v117, v106
  v_add_f32 v118, v118, v107
  v_mov_b32 v106, v117
  v_mov_b32 v107, v118
  s_nop 0
  v_permlane32_swap_b32 v117, v106
  v_permlane32_swap_b32 v118, v107
  v_add_f32 v117, v117, v106
  v_add_f32 v118, v118, v107
  v_mul_f32 v117, 0x3b000000, v117
  v_mul_f32 v118, 0x3b000000, v118
  v_fma_f32 v118, -v117, v117, v118
  v_max_f32 v118, 0, v118
  v_add_f32 v117, s67, v117
  v_cvt_pk_bf16_f32 v119, v117, v118
  v_lshlrev_b32 v117, 16, v119
  v_and_b32 v118, 0xffff0000, v119
  v_add_f32 v118, 0x3727c5ac, v118
  v_cvt_pk_bf16_f32 v118, v118, v118
  v_lshlrev_b32 v118, 16, v118
  v_sqrt_f32 v118, v118
  v_sub_f32 v108, v108, v117
  v_sub_f32 v109, v109, v117
  v_sub_f32 v110, v110, v117
  v_sub_f32 v111, v111, v117
  v_sub_f32 v112, v112, v117
  v_sub_f32 v113, v113, v117
  v_sub_f32 v114, v114, v117
  v_sub_f32 v115, v115, v117
  v_cvt_pk_bf16_f32 v118, v118, v118
  v_lshlrev_b32 v118, 16, v118
  v_rcp_f32 v118, v118
  v_cvt_pk_bf16_f32 v104, v108, v109
  v_cvt_pk_bf16_f32 v105, v110, v111
  v_cvt_pk_bf16_f32 v106, v112, v113
  v_cvt_pk_bf16_f32 v107, v114, v115
  v_lshlrev_b32 v108, 16, v104
  v_and_b32 v109, 0xffff0000, v104
  v_lshlrev_b32 v110, 16, v105
  v_and_b32 v111, 0xffff0000, v105
  v_lshlrev_b32 v112, 16, v106
  v_and_b32 v113, 0xffff0000, v106
  v_lshlrev_b32 v114, 16, v107
  v_and_b32 v115, 0xffff0000, v107
  v_mul_f32 v108, v108, v118
  v_mul_f32 v109, v109, v118
  v_mul_f32 v110, v110, v118
  v_mul_f32 v111, v111, v118
  v_mul_f32 v112, v112, v118
  v_mul_f32 v113, v113, v118
  v_mul_f32 v114, v114, v118
  v_mul_f32 v115, v115, v118
  v_cvt_pk_bf16_f32 v104, v108, v109
  v_cvt_pk_bf16_f32 v105, v110, v111
  v_cvt_pk_bf16_f32 v106, v112, v113
  v_cvt_pk_bf16_f32 v107, v114, v115
  ds_write_b128 v116, v[104:107] offset:12288
  s_waitcnt lgkmcnt(0)
L_if_2:
  s_waitcnt vmcnt(33)
  ds_read_b128 a[64:67], v10 offset:16384
  ds_read_b128 a[68:71], v11 offset:16384
  ds_read_b128 a[72:75], v12 offset:16384
  ds_read_b128 a[76:79], v13 offset:16384
  s_waitcnt lgkmcnt(0)
  s_lshl_b32 s31, s29, 6
  s_add_u32 s31, s31, 20
  s_lshl_b32 s31, s31, 13
  s_add_u32 s31, s31, s68
  s_add_u32 s32, s6, s31
  s_addc_u32 s33, s7, 0
  s_add_u32 s34, s32, 16384
  s_addc_u32 s35, s33, 0
  s_add_u32 s36, s8, s31
  s_addc_u32 s37, s9, 0
  s_add_u32 s38, s36, 16384
  s_addc_u32 s39, s37, 0
  s_add_u32 m0, s47, 16384
  s_nop 0
  global_load_lds_dwordx4 v4, s[32:33] offset:0 nt
  global_load_lds_dwordx4 v5, s[32:33] offset:1024 nt
  global_load_lds_dwordx4 v6, s[32:33] offset:2048 nt
  global_load_lds_dwordx4 v7, s[32:33] offset:3072 nt
  s_waitcnt vmcnt(29)
  ds_read_b128 a[80:83], v10 offset:20480
  ds_read_b128 a[84:87], v11 offset:20480
  ds_read_b128 a[88:91], v12 offset:20480
  ds_read_b128 a[92:95], v13 offset:20480
  s_waitcnt lgkmcnt(0)
  s_add_u32 m0, s47, 20480
  s_nop 0
  global_load_lds_dwordx4 v4, s[34:35] offset:0 nt
  global_load_lds_dwordx4 v5, s[34:35] offset:1024 nt
  global_load_lds_dwordx4 v6, s[34:35] offset:2048 nt
  global_load_lds_dwordx4 v7, s[34:35] offset:3072 nt
  s_barrier
  s_lshl_b32 s31, s3, 8
  v_lshl_add_u32 v31, v3, 4, s31
  ds_read_b128 v[104:107], v31 offset:12288
  ds_read_b128 v[108:111], v31 offset:12352
  ds_read_b128 v[112:115], v31 offset:12416
  ds_read_b128 v[116:119], v31 offset:12480
  s_lshl_b32 s31, s3, 6
  v_lshl_add_u32 v31, v2, 2, s31
  s_waitcnt lgkmcnt(0)
  v_mfma_f32_16x16x32_bf16 v[96:99], v[104:107], v[32:35], 0
  v_mfma_f32_16x16x32_bf16 v[96:99], v[108:111], v[36:39], v[96:99]
  v_mfma_f32_16x16x32_bf16 v[96:99], v[112:115], v[40:43], v[96:99]
  v_mfma_f32_16x16x32_bf16 v[96:99], v[116:119], v[44:47], v[96:99]
  s_nop 7
  ds_write_b32 v31, v96 offset:8448
  s_waitcnt lgkmcnt(0)
  s_waitcnt vmcnt(29)
  ds_read_b64_tr_b16 a[96:97], v14 offset:24576
  ds_read_b64_tr_b16 a[100:101], v15 offset:24576
  ds_read_b64_tr_b16 a[104:105], v16 offset:24576
  ds_read_b64_tr_b16 a[108:109], v17 offset:24576
  ds_read_b64_tr_b16 a[112:113], v18 offset:24576
  ds_read_b64_tr_b16 a[116:117], v19 offset:24576
  ds_read_b64_tr_b16 a[120:121], v20 offset:24576
  ds_read_b64_tr_b16 a[124:125], v21 offset:24576
  s_waitcnt lgkmcnt(0)
  s_add_u32 m0, s47, 24576
  s_nop 0
  global_load_lds_dwordx4 v8, s[36:37] offset:0 nt
  global_load_lds_dwordx4 v9, s[36:37] offset:1024 nt
  global_load_lds_dwordx4 v8, s[36:37] offset:2048 nt
  global_load_lds_dwordx4 v9, s[36:37] offset:3072 nt
  s_waitcnt vmcnt(29)
  ds_read_b64_tr_b16 a[98:99], v14 offset:28672
  ds_read_b64_tr_b16 a[102:103], v15 offset:28672
  ds_read_b64_tr_b16 a[106:107], v16 offset:28672
  ds_read_b64_tr_b16 a[110:111], v17 offset:28672
  ds_read_b64_tr_b16 a[114:115], v18 offset:28672
  ds_read_b64_tr_b16 a[118:119], v19 offset:28672
  ds_read_b64_tr_b16 a[122:123], v20 offset:28672
  ds_read_b64_tr_b16 a[126:127], v21 offset:28672
  s_waitcnt lgkmcnt(0)
  s_add_u32 m0, s47, 28672
  s_nop 0
  global_load_lds_dwordx4 v8, s[38:39] offset:0 nt
  global_load_lds_dwordx4 v9, s[38:39] offset:1024 nt
  global_load_lds_dwordx4 v8, s[38:39] offset:2048 nt
  global_load_lds_dwordx4 v9, s[38:39] offset:3072 nt
  s_barrier
  v_lshlrev_b32 v31, 2, v2
  ds_read_b32 v104, v31 offset:8448
  ds_read_b32 v105, v31 offset:8512
  ds_read_b32 v106, v31 offset:8576
  ds_read_b32 v107, v31 offset:8640
  s_waitcnt lgkmcnt(0)
  v_add_f32 v104, v104, v105
  v_add_f32 v106, v106, v107
  v_add_f32 v108, v104, v106
  s_nop 1
  v_mov_b32_dpp v112, v108 quad_perm:[0,0,2,2] row_mask:0xf bank_mask:0xf
  v_mov_b32_dpp v113, v108 quad_perm:[1,1,3,3] row_mask:0xf bank_mask:0xf
  v_cvt_pk_bf16_f32 v112, v112, v113
  v_min_u32 v112, s63, v112
  v_lshrrev_b32 v113, 1, v2
  v_lshlrev_b32 v113, 2, v113
  s_lshl_b32 s31, s64, 7
  s_add_u32 s31, s31, 0
  v_add_u32 v113, s31, v113
  s_cmp_eq_u32 s3, 0
  s_cbranch_scc0 L_if_3
  global_store_dword v113, v112, s[26:27] sc1
L_if_3:
  s_waitcnt vmcnt(28)
  ds_read_b128 a[128:131], v10 offset:0
  ds_read_b128 a[132:135], v11 offset:0
  ds_read_b128 a[136:139], v12 offset:0
  ds_read_b128 a[140:143], v13 offset:0
  s_waitcnt lgkmcnt(0)
  s_lshl_b32 s31, s29, 6
  s_add_u32 s31, s31, 32
  s_lshl_b32 s31, s31, 13
  s_add_u32 s31, s31, s68
  s_add_u32 s32, s6, s31
  s_addc_u32 s33, s7, 0
  s_add_u32 s34, s32, 16384
  s_addc_u32 s35, s33, 0
  s_add_u32 s36, s8, s31
  s_addc_u32 s37, s9, 0
  s_add_u32 s38, s36, 16384
  s_addc_u32 s39, s37, 0
  s_add_u32 m0, s47, 0
  s_nop 0
  global_load_lds_dwordx4 v4, s[32:33] offset:0 nt
  global_load_lds_dwordx4 v5, s[32:33] offset:1024 nt
  global_load_lds_dwordx4 v6, s[32:33] offset:2048 nt
  global_load_lds_dwordx4 v7, s[32:33] offset:3072 nt
  s_waitcnt vmcnt(28)
  ds_read_b128 a[144:147], v10 offset:4096
  ds_read_b128 a[148:151], v11 offset:4096
  ds_read_b128 a[152:155], v12 offset:4096
  ds_read_b128 a[156:159], v13 offset:4096
  s_waitcnt lgkmcnt(0)
  s_add_u32 m0, s47, 4096
  s_nop 0
  global_load_lds_dwordx4 v4, s[34:35] offset:0 nt
  global_load_lds_dwordx4 v5, s[34:35] offset:1024 nt
  global_load_lds_dwordx4 v6, s[34:35] offset:2048 nt
  global_load_lds_dwordx4 v7, s[34:35] offset:3072 nt
  s_lshl_b32 s31, s28, 12
  s_add_u32 s31, s31, 0
  v_add_u32 v106, s31, v25
  s_cmp_eq_u32 s3, 0
  s_cbranch_scc0 L_if_4
  v_readfirstlane_b32 s31, v29
  s_nop 0
  s_cmp_ge_u32 s31, 256
  s_cbranch_scc1 L_clrdone
  s_nop 1
L_clrwait:
  global_load_dword v29, v28, s[24:25] sc1
  s_waitcnt vmcnt(0)
  v_readfirstlane_b32 s31, v29
  s_sub_u32 s30, s30, 1
  s_cselect_b32 s30, 0, s30
  s_cbranch_scc1 L_clrdone
  s_cmp_lt_u32 s31, 256
  s_cbranch_scc1 L_clrwait
L_clrdone:
L_if_4:
  global_load_dwordx4 v[108:111], v106, s[26:27] sc1
  v_mov_b32 v22, 0xf149f2ca
  v_mov_b32 v23, 0
  v_mov_b32 v48, 0
  v_mov_b32 v49, 0
  v_mov_b32 v50, 0
  v_mov_b32 v51, 0
  v_mov_b32 v52, 0
  v_mov_b32 v53, 0
  v_mov_b32 v54, 0
  v_mov_b32 v55, 0
  v_mov_b32 v56, 0
  v_mov_b32 v57, 0
  v_mov_b32 v58, 0
  v_mov_b32 v59, 0
  v_mov_b32 v60, 0
  v_mov_b32 v61, 0
  v_mov_b32 v62, 0
  v_mov_b32 v63, 0
  v_mov_b32 v64, 0
  v_mov_b32 v65, 0
  v_mov_b32 v66, 0
  v_mov_b32 v67, 0
  v_mov_b32 v68, 0
  v_mov_b32 v69, 0
  v_mov_b32 v70, 0
  v_mov_b32 v71, 0
  v_mov_b32 v72, 0
  v_mov_b32 v73, 0
  v_mov_b32 v74, 0
  v_mov_b32 v75, 0
  v_mov_b32 v76, 0
  v_mov_b32 v77, 0
  v_mov_b32 v78, 0
  v_mov_b32 v79, 0
  v_and_b32 v28, 3, v2
  v_lshlrev_b32 v28, 8, v28
  v_lshl_add_u32 v28, v3, 4, v28
  s_waitcnt vmcnt(29)
  ds_read_b64_tr_b16 a[160:161], v14 offset:8192
  ds_read_b64_tr_b16 a[164:165], v15 offset:8192
  ds_read_b64_tr_b16 a[168:169], v16 offset:8192
  ds_read_b64_tr_b16 a[172:173], v17 offset:8192
  ds_read_b64_tr_b16 a[176:177], v18 offset:8192
  ds_read_b64_tr_b16 a[180:181], v19 offset:8192
  ds_read_b64_tr_b16 a[184:185], v20 offset:8192
  ds_read_b64_tr_b16 a[188:189], v21 offset:8192
  s_waitcnt lgkmcnt(0)
  s_add_u32 m0, s47, 8192
  s_nop 0
  global_load_lds_dwordx4 v8, s[36:37] offset:0 nt
  global_load_lds_dwordx4 v9, s[36:37] offset:1024 nt
  global_load_lds_dwordx4 v8, s[36:37] offset:2048 nt
  global_load_lds_dwordx4 v9, s[36:37] offset:3072 nt
  s_waitcnt vmcnt(29)
  ds_read_b64_tr_b16 a[162:163], v14 offset:12288
  ds_read_b64_tr_b16 a[166:167], v15 offset:12288
  ds_read_b64_tr_b16 a[170:171], v16 offset:12288
  ds_read_b64_tr_b16 a[174:175], v17 offset:12288
  ds_read_b64_tr_b16 a[178:179], v18 offset:12288
  ds_read_b64_tr_b16 a[182:183], v19 offset:12288
  ds_read_b64_tr_b16 a[186:187], v20 offset:12288
  ds_read_b64_tr_b16 a[190:191], v21 offset:12288
  s_waitcnt lgkmcnt(0)
  s_add_u32 m0, s47, 12288
  s_nop 0
  global_load_lds_dwordx4 v8, s[38:39] offset:0 nt
  global_load_lds_dwordx4 v9, s[38:39] offset:1024 nt
  global_load_lds_dwordx4 v8, s[38:39] offset:2048 nt
  global_load_lds_dwordx4 v9, s[38:39] offset:3072 nt
  s_waitcnt vmcnt(29)
  ds_read_b128 a[192:195], v10 offset:16384
  ds_read_b128 a[196:199], v11 offset:16384
  ds_read_b128 a[200:203], v12 offset:16384
  ds_read_b128 a[204:207], v13 offset:16384
  s_waitcnt lgkmcnt(0)
  s_lshl_b32 s31, s29, 6
  s_add_u32 s31, s31, 36
  s_lshl_b32 s31, s31, 13
  s_add_u32 s31, s31, s68
  s_add_u32 s32, s6, s31
  s_addc_u32 s33, s7, 0
  s_add_u32 s34, s32, 16384
  s_addc_u32 s35, s33, 0
  s_add_u32 s36, s8, s31
  s_addc_u32 s37, s9, 0
  s_add_u32 s38, s36, 16384
  s_addc_u32 s39, s37, 0
  s_add_u32 m0, s47, 16384
  s_nop 0
  global_load_lds_dwordx4 v4, s[32:33] offset:0 nt
  global_load_lds_dwordx4 v5, s[32:33] offset:1024 nt
  global_load_lds_dwordx4 v6, s[32:33] offset:2048 nt
  global_load_lds_dwordx4 v7, s[32:33] offset:3072 nt
  s_waitcnt vmcnt(29)
  ds_read_b128 a[208:211], v10 offset:20480
  ds_read_b128 a[212:215], v11 offset:20480
  ds_read_b128 a[216:219], v12 offset:20480
  ds_read_b128 a[220:223], v13 offset:20480
  s_waitcnt lgkmcnt(0)
  s_add_u32 m0, s47, 20480
  s_nop 0
  global_load_lds_dwordx4 v4, s[34:35] offset:0 nt
  global_load_lds_dwordx4 v5, s[34:35] offset:1024 nt
  global_load_lds_dwordx4 v6, s[34:35] offset:2048 nt
  global_load_lds_dwordx4 v7, s[34:35] offset:3072 nt
  s_waitcnt vmcnt(29)
  ds_read_b64_tr_b16 a[224:225], v14 offset:24576
  ds_read_b64_tr_b16 a[228:229], v15 offset:24576
  ds_read_b64_tr_b16 a[232:233], v16 offset:24576
  ds_read_b64_tr_b16 a[236:237], v17 offset:24576
  ds_read_b64_tr_b16 a[240:241], v18 offset:24576
  ds_read_b64_tr_b16 a[244:245], v19 offset:24576
  ds_read_b64_tr_b16 a[248:249], v20 offset:24576
  ds_read_b64_tr_b16 a[252:253], v21 offset:24576
  s_waitcnt lgkmcnt(0)
  s_add_u32 m0, s47, 24576
  s_nop 0
  global_load_lds_dwordx4 v8, s[36:37] offset:0 nt
  global_load_lds_dwordx4 v9, s[36:37] offset:1024 nt
  global_load_lds_dwordx4 v8, s[36:37] offset:2048 nt
  global_load_lds_dwordx4 v9, s[36:37] offset:3072 nt
  s_waitcnt vmcnt(29)
  ds_read_b64_tr_b16 a[226:227], v14 offset:28672
  ds_read_b64_tr_b16 a[230:231], v15 offset:28672
  ds_read_b64_tr_b16 a[234:235], v16 offset:28672
  ds_read_b64_tr_b16 a[238:239], v17 offset:28672
  ds_read_b64_tr_b16 a[242:243], v18 offset:28672
  ds_read_b64_tr_b16 a[246:247], v19 offset:28672
  ds_read_b64_tr_b16 a[250:251], v20 offset:28672
  ds_read_b64_tr_b16 a[254:255], v21 offset:28672
  s_waitcnt lgkmcnt(0)
  s_add_u32 m0, s47, 28672
  s_nop 0
  global_load_lds_dwordx4 v8, s[38:39] offset:0 nt
  global_load_lds_dwordx4 v9, s[38:39] offset:1024 nt
  global_load_lds_dwordx4 v8, s[38:39] offset:2048 nt
  global_load_lds_dwordx4 v9, s[38:39] offset:3072 nt
  s_waitcnt vmcnt(24)
  s_cmp_eq_u32 s3, 0
  s_cbranch_scc0 L_if_5
  v_max_u32 v105, v108, v109
  v_max3_u32 v105, v105, v110, v111
  v_cmp_eq_u32 vcc, -1, v105
  v_lshlrev_b32 v104, 4, v1
  ds_write_b128 v104, v[108:111] offset:11264
  s_waitcnt lgkmcnt(0)
  s_cbranch_vccz L_q0ok
  s_lshl_b32 s31, s28, 12
  s_add_u32 s31, s31, 0
  v_add_u32 v104, s31, v25
  v_lshlrev_b32 v106, 4, v1
  s_nop 1
L_pl_6:
  global_load_dwordx4 v[116:119], v104, s[26:27] sc1
  s_waitcnt vmcnt(0)
  v_max3_u32 v105, v116, v117, v118
  v_max_u32 v105, v105, v119
  v_cmp_eq_u32 vcc, -1, v105
  s_sub_u32 s30, s30, 1
  s_cselect_b32 s30, 0, s30
  s_cbranch_scc1 L_pd_7
  s_cbranch_vccnz L_pl_6
L_pd_7:
  ds_write_b128 v106, v[116:119] offset:11264
  s_waitcnt lgkmcnt(0)
  s_waitcnt vmcnt(0)
L_q0ok:
L_if_5:
  s_barrier
  ds_read_b128 v[32:35], v28 offset:11264
  ds_read_b128 v[36:39], v28 offset:11328
  ds_read_b128 v[40:43], v28 offset:11392
  ds_read_b128 v[44:47], v28 offset:11456
  s_waitcnt lgkmcnt(0)
  s_waitcnt vmcnt(24)
  ds_read_b128 v[80:83], v10 offset:0
  ds_read_b128 v[84:87], v11 offset:0
  ds_read_b128 v[88:91], v12 offset:0
  ds_read_b128 v[92:95], v13 offset:0
  ds_read_b128 v[96:99], v10 offset:4096
  ds_read_b128 v[100:103], v11 offset:4096
  ds_read_b128 v[104:107], v12 offset:4096
  ds_read_b128 v[108:111], v13 offset:4096
  s_waitcnt lgkmcnt(0)
  s_lshl_b32 s31, s29, 6
  s_add_u32 s31, s31, 40
  s_lshl_b32 s31, s31, 13
  s_add_u32 s31, s31, s68
  s_add_u32 s32, s6, s31
  s_addc_u32 s33, s7, 0
  s_add_u32 s34, s32, 16384
  s_addc_u32 s35, s33, 0
  s_add_u32 s36, s8, s31
  s_addc_u32 s37, s9, 0
  s_add_u32 s38, s36, 16384
  s_addc_u32 s39, s37, 0
  v_mfma_f32_16x16x32_bf16 v[112:115], v[80:83], v[32:35], 0
  v_mfma_f32_16x16x32_bf16 v[112:115], v[84:87], v[36:39], v[112:115]
  v_mfma_f32_16x16x32_bf16 v[112:115], v[88:91], v[40:43], v[112:115]
  v_mfma_f32_16x16x32_bf16 v[112:115], v[92:95], v[44:47], v[112:115]
  v_mfma_f32_16x16x32_bf16 v[116:119], v[96:99], v[32:35], 0
  v_mfma_f32_16x16x32_bf16 v[116:119], v[100:103], v[36:39], v[116:119]
  v_mfma_f32_16x16x32_bf16 v[116:119], v[104:107], v[40:43], v[116:119]
  v_mfma_f32_16x16x32_bf16 v[116:119], v[108:111], v[44:47], v[116:119]
  s_add_u32 m0, s47, 0
  s_nop 0
  global_load_lds_dwordx4 v4, s[32:33] offset:0 nt
  global_load_lds_dwordx4 v5, s[32:33] offset:1024 nt
  global_load_lds_dwordx4 v6, s[32:33] offset:2048 nt
  global_load_lds_dwordx4 v7, s[32:33] offset:3072 nt
  s_add_u32 m0, s47, 4096
  s_nop 0
  global_load_lds_dwordx4 v4, s[34:35] offset:0 nt
  global_load_lds_dwordx4 v5, s[34:35] offset:1024 nt
  global_load_lds_dwordx4 v6, s[34:35] offset:2048 nt
  global_load_lds_dwordx4 v7, s[34:35] offset:3072 nt
  s_waitcnt vmcnt(24)
  ds_read_b64_tr_b16 v[80:81], v14 offset:8192
  ds_read_b64_tr_b16 v[84:85], v15 offset:8192
  ds_read_b64_tr_b16 v[88:89], v16 offset:8192
  ds_read_b64_tr_b16 v[92:93], v17 offset:8192
  ds_read_b64_tr_b16 v[96:97], v18 offset:8192
  ds_read_b64_tr_b16 v[100:101], v19 offset:8192
  ds_read_b64_tr_b16 v[104:105], v20 offset:8192
  ds_read_b64_tr_b16 v[108:109], v21 offset:8192
  ds_read_b64_tr_b16 v[82:83], v14 offset:12288
  ds_read_b64_tr_b16 v[86:87], v15 offset:12288
  ds_read_b64_tr_b16 v[90:91], v16 offset:12288
  ds_read_b64_tr_b16 v[94:95], v17 offset:12288
  ds_read_b64_tr_b16 v[98:99], v18 offset:12288
  ds_read_b64_tr_b16 v[102:103], v19 offset:12288
  ds_read_b64_tr_b16 v[106:107], v20 offset:12288
  ds_read_b64_tr_b16 v[110:111], v21 offset:12288
  v_cvt_pk_bf16_f32 v120, v112, v113
  v_cvt_pk_bf16_f32 v121, v114, v115
  v_cvt_pk_bf16_f32 v122, v116, v117
  v_cvt_pk_bf16_f32 v123, v118, v119
  v_lshlrev_b32 v112, 16, v120
  v_and_b32 v113, 0xffff0000, v120
  v_lshlrev_b32 v114, 16, v121
  v_and_b32 v115, 0xffff0000, v121
  v_lshlrev_b32 v116, 16, v122
  v_and_b32 v117, 0xffff0000, v122
  v_lshlrev_b32 v118, 16, v123
  v_and_b32 v119, 0xffff0000, v123
  v_mul_f32 v112, s58, v112
  v_mul_f32 v113, s58, v113
  v_mul_f32 v114, s58, v114
  v_mul_f32 v115, s58, v115
  v_mul_f32 v116, s58, v116
  v_mul_f32 v117, s58, v117
  v_mul_f32 v118, s58, v118
  v_mul_f32 v119, s58, v119
  v_cvt_pk_bf16_f32 v120, v112, v113
  v_cvt_pk_bf16_f32 v121, v114, v115
  v_cvt_pk_bf16_f32 v122, v116, v117
  v_cvt_pk_bf16_f32 v123, v118, v119
  v_lshlrev_b32 v112, 16, v120
  v_and_b32 v113, 0xffff0000, v120
  v_lshlrev_b32 v114, 16, v121
  v_and_b32 v115, 0xffff0000, v121
  v_lshlrev_b32 v116, 16, v122
  v_and_b32 v117, 0xffff0000, v122
  v_lshlrev_b32 v118, 16, v123
  v_and_b32 v119, 0xffff0000, v123
  v_max3_f32 v124, v112, v113, v114
  v_max3_f32 v125, v115, v116, v117
  v_max3_f32 v124, v124, v118, v119
  v_max_f32 v124, v124, v125
  v_mov_b32 v125, v124
  s_nop 1
  v_permlane16_swap_b32 v124, v125
  v_max_f32 v124, v124, v125
  v_mov_b32 v125, v124
  s_nop 1
  v_permlane32_swap_b32 v124, v125
  v_max_f32 v124, v124, v125
  v_mul_f32 v124, s62, v124
  v_max_f32 v124, v124, v22
  v_sub_f32 v24, v22, v124
  v_exp_f32 v24, v24
  v_mov_b32 v22, v124
  v_fma_f32 v112, v112, s62, -v22
  v_fma_f32 v113, v113, s62, -v22
  v_fma_f32 v114, v114, s62, -v22
  v_fma_f32 v115, v115, s62, -v22
  v_fma_f32 v116, v116, s62, -v22
  v_fma_f32 v117, v117, s62, -v22
  v_fma_f32 v118, v118, s62, -v22
  v_fma_f32 v119, v119, s62, -v22
  v_exp_f32 v112, v112
  v_exp_f32 v113, v113
  v_exp_f32 v114, v114
  v_exp_f32 v115, v115
  v_exp_f32 v116, v116
  v_exp_f32 v117, v117
  v_exp_f32 v118, v118
  v_exp_f32 v119, v119
  v_mul_f32 v23, v23, v24
  v_cvt_pk_bf16_f32 v120, v112, v113
  v_cvt_pk_bf16_f32 v121, v114, v115
  v_cvt_pk_bf16_f32 v122, v116, v117
  v_cvt_pk_bf16_f32 v123, v118, v119
  v_add_f32 v124, v112, v113
  v_add_f32 v125, v114, v115
  v_add_f32 v124, v124, v116
  v_add_f32 v125, v125, v117
  v_add_f32 v124, v124, v118
  v_add_f32 v125, v125, v119
  v_add_f32 v124, v124, v125
  v_add_f32 v23, v23, v124
  v_mul_f32_dpp v48, v24, v48 quad_perm:[0,0,0,0] row_mask:0xf bank_mask:0xf
  v_mul_f32_dpp v49, v24, v49 quad_perm:[1,1,1,1] row_mask:0xf bank_mask:0xf
  v_mul_f32_dpp v50, v24, v50 quad_perm:[2,2,2,2] row_mask:0xf bank_mask:0xf
  v_mul_f32_dpp v51, v24, v51 quad_perm:[3,3,3,3] row_mask:0xf bank_mask:0xf
  v_mul_f32_dpp v52, v24, v52 quad_perm:[0,0,0,0] row_mask:0xf bank_mask:0xf
  v_mul_f32_dpp v53, v24, v53 quad_perm:[1,1,1,1] row_mask:0xf bank_mask:0xf
  v_mul_f32_dpp v54, v24, v54 quad_perm:[2,2,2,2] row_mask:0xf bank_mask:0xf
  v_mul_f32_dpp v55, v24, v55 quad_perm:[3,3,3,3] row_mask:0xf bank_mask:0xf
  v_mul_f32_dpp v56, v24, v56 quad_perm:[0,0,0,0] row_mask:0xf bank_mask:0xf
  v_mul_f32_dpp v57, v24, v57 quad_perm:[1,1,1,1] row_mask:0xf bank_mask:0xf
  v_mul_f32_dpp v58, v24, v58 quad_perm:[2,2,2,2] row_mask:0xf bank_mask:0xf
  v_mul_f32_dpp v59, v24, v59 quad_perm:[3,3,3,3] row_mask:0xf bank_mask:0xf
  v_mul_f32_dpp v60, v24, v60 quad_perm:[0,0,0,0] row_mask:0xf bank_mask:0xf
  v_mul_f32_dpp v61, v24, v61 quad_perm:[1,1,1,1] row_mask:0xf bank_mask:0xf
  v_mul_f32_dpp v62, v24, v62 quad_perm:[2,2,2,2] row_mask:0xf bank_mask:0xf
  v_mul_f32_dpp v63, v24, v63 quad_perm:[3,3,3,3] row_mask:0xf bank_mask:0xf
  v_mul_f32_dpp v64, v24, v64 quad_perm:[0,0,0,0] row_mask:0xf bank_mask:0xf
  v_mul_f32_dpp v65, v24, v65 quad_perm:[1,1,1,1] row_mask:0xf bank_mask:0xf
  v_mul_f32_dpp v66, v24, v66 quad_perm:[2,2,2,2] row_mask:0xf bank_mask:0xf
  v_mul_f32_dpp v67, v24, v67 quad_perm:[3,3,3,3] row_mask:0xf bank_mask:0xf
  v_mul_f32_dpp v68, v24, v68 quad_perm:[0,0,0,0] row_mask:0xf bank_mask:0xf
  v_mul_f32_dpp v69, v24, v69 quad_perm:[1,1,1,1] row_mask:0xf bank_mask:0xf
  v_mul_f32_dpp v70, v24, v70 quad_perm:[2,2,2,2] row_mask:0xf bank_mask:0xf
  v_mul_f32_dpp v71, v24, v71 quad_perm:[3,3,3,3] row_mask:0xf bank_mask:0xf
  v_mul_f32_dpp v72, v24, v72 quad_perm:[0,0,0,0] row_mask:0xf bank_mask:0xf
  v_mul_f32_dpp v73, v24, v73 quad_perm:[1,1,1,1] row_mask:0xf bank_mask:0xf
  v_mul_f32_dpp v74, v24, v74 quad_perm:[2,2,2,2] row_mask:0xf bank_mask:0xf
  v_mul_f32_dpp v75, v24, v75 quad_perm:[3,3,3,3] row_mask:0xf bank_mask:0xf
  v_mul_f32_dpp v76, v24, v76 quad_perm:[0,0,0,0] row_mask:0xf bank_mask:0xf
  v_mul_f32_dpp v77, v24, v77 quad_perm:[1,1,1,1] row_mask:0xf bank_mask:0xf
  v_mul_f32_dpp v78, v24, v78 quad_perm:[2,2,2,2] row_mask:0xf bank_mask:0xf
  v_mul_f32_dpp v79, v24, v79 quad_perm:[3,3,3,3] row_mask:0xf bank_mask:0xf
  s_waitcnt lgkmcnt(0)
  v_mfma_f32_16x16x32_bf16 v[48:51], v[120:123], v[80:83], v[48:51]
  v_mfma_f32_16x16x32_bf16 v[52:55], v[120:123], v[84:87], v[52:55]
  v_mfma_f32_16x16x32_bf16 v[56:59], v[120:123], v[88:91], v[56:59]
  v_mfma_f32_16x16x32_bf16 v[60:63], v[120:123], v[92:95], v[60:63]
  v_mfma_f32_16x16x32_bf16 v[64:67], v[120:123], v[96:99], v[64:67]
  v_mfma_f32_16x16x32_bf16 v[68:71], v[120:123], v[100:103], v[68:71]
  v_mfma_f32_16x16x32_bf16 v[72:75], v[120:123], v[104:107], v[72:75]
  v_mfma_f32_16x16x32_bf16 v[76:79], v[120:123], v[108:111], v[76:79]
  s_add_u32 m0, s47, 8192
  s_nop 0
  global_load_lds_dwordx4 v8, s[36:37] offset:0 nt
  global_load_lds_dwordx4 v9, s[36:37] offset:1024 nt
  global_load_lds_dwordx4 v8, s[36:37] offset:2048 nt
  global_load_lds_dwordx4 v9, s[36:37] offset:3072 nt
  s_add_u32 m0, s47, 12288
  s_nop 0
  global_load_lds_dwordx4 v8, s[38:39] offset:0 nt
  global_load_lds_dwordx4 v9, s[38:39] offset:1024 nt
  global_load_lds_dwordx4 v8, s[38:39] offset:2048 nt
  global_load_lds_dwordx4 v9, s[38:39] offset:3072 nt
  s_waitcnt vmcnt(24)
  ds_read_b128 v[80:83], v10 offset:16384
  ds_read_b128 v[84:87], v11 offset:16384
  ds_read_b128 v[88:91], v12 offset:16384
  ds_read_b128 v[92:95], v13 offset:16384
  ds_read_b128 v[96:99], v10 offset:20480
  ds_read_b128 v[100:103], v11 offset:20480
  ds_read_b128 v[104:107], v12 offset:20480
  ds_read_b128 v[108:111], v13 offset:20480
  s_waitcnt lgkmcnt(0)
  s_lshl_b32 s31, s29, 6
  s_add_u32 s31, s31, 44
  s_lshl_b32 s31, s31, 13
  s_add_u32 s31, s31, s68
  s_add_u32 s32, s6, s31
  s_addc_u32 s33, s7, 0
  s_add_u32 s34, s32, 16384
  s_addc_u32 s35, s33, 0
  s_add_u32 s36, s8, s31
  s_addc_u32 s37, s9, 0
  s_add_u32 s38, s36, 16384
  s_addc_u32 s39, s37, 0
  v_mfma_f32_16x16x32_bf16 v[112:115], v[80:83], v[32:35], 0
  v_mfma_f32_16x16x32_bf16 v[112:115], v[84:87], v[36:39], v[112:115]
  v_mfma_f32_16x16x32_bf16 v[112:115], v[88:91], v[40:43], v[112:115]
  v_mfma_f32_16x16x32_bf16 v[112:115], v[92:95], v[44:47], v[112:115]
  v_mfma_f32_16x16x32_bf16 v[116:119], v[96:99], v[32:35], 0
  v_mfma_f32_16x16x32_bf16 v[116:119], v[100:103], v[36:39], v[116:119]
  v_mfma_f32_16x16x32_bf16 v[116:119], v[104:107], v[40:43], v[116:119]
  v_mfma_f32_16x16x32_bf16 v[116:119], v[108:111], v[44:47], v[116:119]
  s_add_u32 m0, s47, 16384
  s_nop 0
  global_load_lds_dwordx4 v4, s[32:33] offset:0 nt
  global_load_lds_dwordx4 v5, s[32:33] offset:1024 nt
  global_load_lds_dwordx4 v6, s[32:33] offset:2048 nt
  global_load_lds_dwordx4 v7, s[32:33] offset:3072 nt
  s_add_u32 m0, s47, 20480
  s_nop 0
  global_load_lds_dwordx4 v4, s[34:35] offset:0 nt
  global_load_lds_dwordx4 v5, s[34:35] offset:1024 nt
  global_load_lds_dwordx4 v6, s[34:35] offset:2048 nt
  global_load_lds_dwordx4 v7, s[34:35] offset:3072 nt
  s_waitcnt vmcnt(24)
  ds_read_b64_tr_b16 v[80:81], v14 offset:24576
  ds_read_b64_tr_b16 v[84:85], v15 offset:24576
  ds_read_b64_tr_b16 v[88:89], v16 offset:24576
  ds_read_b64_tr_b16 v[92:93], v17 offset:24576
  ds_read_b64_tr_b16 v[96:97], v18 offset:24576
  ds_read_b64_tr_b16 v[100:101], v19 offset:24576
  ds_read_b64_tr_b16 v[104:105], v20 offset:24576
  ds_read_b64_tr_b16 v[108:109], v21 offset:24576
  ds_read_b64_tr_b16 v[82:83], v14 offset:28672
  ds_read_b64_tr_b16 v[86:87], v15 offset:28672
  ds_read_b64_tr_b16 v[90:91], v16 offset:28672
  ds_read_b64_tr_b16 v[94:95], v17 offset:28672
  ds_read_b64_tr_b16 v[98:99], v18 offset:28672
  ds_read_b64_tr_b16 v[102:103], v19 offset:28672
  ds_read_b64_tr_b16 v[106:107], v20 offset:28672
  ds_read_b64_tr_b16 v[110:111], v21 offset:28672
  v_cvt_pk_bf16_f32 v120, v112, v113
  v_cvt_pk_bf16_f32 v121, v114, v115
  v_cvt_pk_bf16_f32 v122, v116, v117
  v_cvt_pk_bf16_f32 v123, v118, v119
  v_lshlrev_b32 v112, 16, v120
  v_and_b32 v113, 0xffff0000, v120
  v_lshlrev_b32 v114, 16, v121
  v_and_b32 v115, 0xffff0000, v121
  v_lshlrev_b32 v116, 16, v122
  v_and_b32 v117, 0xffff0000, v122
  v_lshlrev_b32 v118, 16, v123
  v_and_b32 v119, 0xffff0000, v123
  v_mul_f32 v112, s58, v112
  v_mul_f32 v113, s58, v113
  v_mul_f32 v114, s58, v114
  v_mul_f32 v115, s58, v115
  v_mul_f32 v116, s58, v116
  v_mul_f32 v117, s58, v117
  v_mul_f32 v118, s58, v118
  v_mul_f32 v119, s58, v119
  v_cvt_pk_bf16_f32 v120, v112, v113
  v_cvt_pk_bf16_f32 v121, v114, v115
  v_cvt_pk_bf16_f32 v122, v116, v117
  v_cvt_pk_bf16_f32 v123, v118, v119
  v_lshlrev_b32 v112, 16, v120
  v_and_b32 v113, 0xffff0000, v120
  v_lshlrev_b32 v114, 16, v121
  v_and_b32 v115, 0xffff0000, v121
  v_lshlrev_b32 v116, 16, v122
  v_and_b32 v117, 0xffff0000, v122
  v_lshlrev_b32 v118, 16, v123
  v_and_b32 v119, 0xffff0000, v123
  v_max3_f32 v124, v112, v113, v114
  v_max3_f32 v125, v115, v116, v117
  v_max3_f32 v124, v124, v118, v119
  v_max_f32 v124, v124, v125
  v_mov_b32 v125, v124
  s_nop 1
  v_permlane16_swap_b32 v124, v125
  v_max_f32 v124, v124, v125
  v_mov_b32 v125, v124
  s_nop 1
  v_permlane32_swap_b32 v124, v125
  v_max_f32 v124, v124, v125
  v_mul_f32 v124, s62, v124
  v_max_f32 v124, v124, v22
  v_sub_f32 v24, v22, v124
  v_exp_f32 v24, v24
  v_mov_b32 v22, v124
  v_fma_f32 v112, v112, s62, -v22
  v_fma_f32 v113, v113, s62, -v22
  v_fma_f32 v114, v114, s62, -v22
  v_fma_f32 v115, v115, s62, -v22
  v_fma_f32 v116, v116, s62, -v22
  v_fma_f32 v117, v117, s62, -v22
  v_fma_f32 v118, v118, s62, -v22
  v_fma_f32 v119, v119, s62, -v22
  v_exp_f32 v112, v112
  v_exp_f32 v113, v113
  v_exp_f32 v114, v114
  v_exp_f32 v115, v115
  v_exp_f32 v116, v116
  v_exp_f32 v117, v117
  v_exp_f32 v118, v118
  v_exp_f32 v119, v119
  v_mul_f32 v23, v23, v24
  v_cvt_pk_bf16_f32 v120, v112, v113
  v_cvt_pk_bf16_f32 v121, v114, v115
  v_cvt_pk_bf16_f32 v122, v116, v117
  v_cvt_pk_bf16_f32 v123, v118, v119
  v_add_f32 v124, v112, v113
  v_add_f32 v125, v114, v115
  v_add_f32 v124, v124, v116
  v_add_f32 v125, v125, v117
  v_add_f32 v124, v124, v118
  v_add_f32 v125, v125, v119
  v_add_f32 v124, v124, v125
  v_add_f32 v23, v23, v124
  v_mul_f32_dpp v48, v24, v48 quad_perm:[0,0,0,0] row_mask:0xf bank_mask:0xf
  v_mul_f32_dpp v49, v24, v49 quad_perm:[1,1,1,1] row_mask:0xf bank_mask:0xf
  v_mul_f32_dpp v50, v24, v50 quad_perm:[2,2,2,2] row_mask:0xf bank_mask:0xf
  v_mul_f32_dpp v51, v24, v51 quad_perm:[3,3,3,3] row_mask:0xf bank_mask:0xf
  v_mul_f32_dpp v52, v24, v52 quad_perm:[0,0,0,0] row_mask:0xf bank_mask:0xf
  v_mul_f32_dpp v53, v24, v53 quad_perm:[1,1,1,1] row_mask:0xf bank_mask:0xf
  v_mul_f32_dpp v54, v24, v54 quad_perm:[2,2,2,2] row_mask:0xf bank_mask:0xf
  v_mul_f32_dpp v55, v24, v55 quad_perm:[3,3,3,3] row_mask:0xf bank_mask:0xf
  v_mul_f32_dpp v56, v24, v56 quad_perm:[0,0,0,0] row_mask:0xf bank_mask:0xf
  v_mul_f32_dpp v57, v24, v57 quad_perm:[1,1,1,1] row_mask:0xf bank_mask:0xf
  v_mul_f32_dpp v58, v24, v58 quad_perm:[2,2,2,2] row_mask:0xf bank_mask:0xf
  v_mul_f32_dpp v59, v24, v59 quad_perm:[3,3,3,3] row_mask:0xf bank_mask:0xf
  v_mul_f32_dpp v60, v24, v60 quad_perm:[0,0,0,0] row_mask:0xf bank_mask:0xf
  v_mul_f32_dpp v61, v24, v61 quad_perm:[1,1,1,1] row_mask:0xf bank_mask:0xf
  v_mul_f32_dpp v62, v24, v62 quad_perm:[2,2,2,2] row_mask:0xf bank_mask:0xf
  v_mul_f32_dpp v63, v24, v63 quad_perm:[3,3,3,3] row_mask:0xf bank_mask:0xf
  v_mul_f32_dpp v64, v24, v64 quad_perm:[0,0,0,0] row_mask:0xf bank_mask:0xf
  v_mul_f32_dpp v65, v24, v65 quad_perm:[1,1,1,1] row_mask:0xf bank_mask:0xf
  v_mul_f32_dpp v66, v24, v66 quad_perm:[2,2,2,2] row_mask:0xf bank_mask:0xf
  v_mul_f32_dpp v67, v24, v67 quad_perm:[3,3,3,3] row_mask:0xf bank_mask:0xf
  v_mul_f32_dpp v68, v24, v68 quad_perm:[0,0,0,0] row_mask:0xf bank_mask:0xf
  v_mul_f32_dpp v69, v24, v69 quad_perm:[1,1,1,1] row_mask:0xf bank_mask:0xf
  v_mul_f32_dpp v70, v24, v70 quad_perm:[2,2,2,2] row_mask:0xf bank_mask:0xf
  v_mul_f32_dpp v71, v24, v71 quad_perm:[3,3,3,3] row_mask:0xf bank_mask:0xf
  v_mul_f32_dpp v72, v24, v72 quad_perm:[0,0,0,0] row_mask:0xf bank_mask:0xf
  v_mul_f32_dpp v73, v24, v73 quad_perm:[1,1,1,1] row_mask:0xf bank_mask:0xf
  v_mul_f32_dpp v74, v24, v74 quad_perm:[2,2,2,2] row_mask:0xf bank_mask:0xf
  v_mul_f32_dpp v75, v24, v75 quad_perm:[3,3,3,3] row_mask:0xf bank_mask:0xf
  v_mul_f32_dpp v76, v24, v76 quad_perm:[0,0,0,0] row_mask:0xf bank_mask:0xf
  v_mul_f32_dpp v77, v24, v77 quad_perm:[1,1,1,1] row_mask:0xf bank_mask:0xf
  v_mul_f32_dpp v78, v24, v78 quad_perm:[2,2,2,2] row_mask:0xf bank_mask:0xf
  v_mul_f32_dpp v79, v24, v79 quad_perm:[3,3,3,3] row_mask:0xf bank_mask:0xf
  s_waitcnt lgkmcnt(0)
  v_mfma_f32_16x16x32_bf16 v[48:51], v[120:123], v[80:83], v[48:51]
  v_mfma_f32_16x16x32_bf16 v[52:55], v[120:123], v[84:87], v[52:55]
  v_mfma_f32_16x16x32_bf16 v[56:59], v[120:123], v[88:91], v[56:59]
  v_mfma_f32_16x16x32_bf16 v[60:63], v[120:123], v[92:95], v[60:63]
  v_mfma_f32_16x16x32_bf16 v[64:67], v[120:123], v[96:99], v[64:67]
  v_mfma_f32_16x16x32_bf16 v[68:71], v[120:123], v[100:103], v[68:71]
  v_mfma_f32_16x16x32_bf16 v[72:75], v[120:123], v[104:107], v[72:75]
  v_mfma_f32_16x16x32_bf16 v[76:79], v[120:123], v[108:111], v[76:79]
  s_add_u32 m0, s47, 24576
  s_nop 0
  global_load_lds_dwordx4 v8, s[36:37] offset:0 nt
  global_load_lds_dwordx4 v9, s[36:37] offset:1024 nt
  global_load_lds_dwordx4 v8, s[36:37] offset:2048 nt
  global_load_lds_dwordx4 v9, s[36:37] offset:3072 nt
  s_add_u32 m0, s47, 28672
  s_nop 0
  global_load_lds_dwordx4 v8, s[38:39] offset:0 nt
  global_load_lds_dwordx4 v9, s[38:39] offset:1024 nt
  global_load_lds_dwordx4 v8, s[38:39] offset:2048 nt
  global_load_lds_dwordx4 v9, s[38:39] offset:3072 nt
  v_mfma_f32_16x16x32_bf16 v[112:115], v[128:131], v[32:35], 0
  v_mfma_f32_16x16x32_bf16 v[112:115], v[132:135], v[36:39], v[112:115]
  v_mfma_f32_16x16x32_bf16 v[112:115], v[136:139], v[40:43], v[112:115]
  v_mfma_f32_16x16x32_bf16 v[112:115], v[140:143], v[44:47], v[112:115]
  v_mfma_f32_16x16x32_bf16 v[116:119], v[144:147], v[32:35], 0
  v_mfma_f32_16x16x32_bf16 v[116:119], v[148:151], v[36:39], v[116:119]
  v_mfma_f32_16x16x32_bf16 v[116:119], v[152:155], v[40:43], v[116:119]
  v_mfma_f32_16x16x32_bf16 v[116:119], v[156:159], v[44:47], v[116:119]
  s_nop 3
  v_cvt_pk_bf16_f32 v120, v112, v113
  v_cvt_pk_bf16_f32 v121, v114, v115
  s_nop 1
  v_cvt_pk_bf16_f32 v122, v116, v117
  v_cvt_pk_bf16_f32 v123, v118, v119
  v_lshlrev_b32 v112, 16, v120
  v_and_b32 v113, 0xffff0000, v120
  v_lshlrev_b32 v114, 16, v121
  v_and_b32 v115, 0xffff0000, v121
  v_lshlrev_b32 v116, 16, v122
  v_and_b32 v117, 0xffff0000, v122
  v_lshlrev_b32 v118, 16, v123
  v_and_b32 v119, 0xffff0000, v123
  v_mul_f32 v112, s58, v112
  v_mul_f32 v113, s58, v113
  v_mul_f32 v114, s58, v114
  v_mul_f32 v115, s58, v115
  v_mul_f32 v116, s58, v116
  v_mul_f32 v117, s58, v117
  v_mul_f32 v118, s58, v118
  v_mul_f32 v119, s58, v119
  v_cvt_pk_bf16_f32 v120, v112, v113
  v_cvt_pk_bf16_f32 v121, v114, v115
  v_cvt_pk_bf16_f32 v122, v116, v117
  v_cvt_pk_bf16_f32 v123, v118, v119
  v_lshlrev_b32 v112, 16, v120
  v_and_b32 v113, 0xffff0000, v120
  v_lshlrev_b32 v114, 16, v121
  v_and_b32 v115, 0xffff0000, v121
  v_lshlrev_b32 v116, 16, v122
  v_and_b32 v117, 0xffff0000, v122
  v_lshlrev_b32 v118, 16, v123
  v_and_b32 v119, 0xffff0000, v123
  v_max3_f32 v124, v112, v113, v114
  v_max3_f32 v125, v115, v116, v117
  v_max3_f32 v124, v124, v118, v119
  v_max_f32 v124, v124, v125
  v_mov_b32 v125, v124
  s_nop 1
  v_permlane16_swap_b32 v124, v125
  v_max_f32 v124, v124, v125
  v_mov_b32 v125, v124
  s_nop 1
  v_permlane32_swap_b32 v124, v125
  v_max_f32 v124, v124, v125
  v_mul_f32 v124, s62, v124
  v_max_f32 v124, v124, v22
  v_sub_f32 v24, v22, v124
  v_exp_f32 v24, v24
  v_mov_b32 v22, v124
  v_fma_f32 v112, v112, s62, -v22
  v_fma_f32 v113, v113, s62, -v22
  v_fma_f32 v114, v114, s62, -v22
  v_fma_f32 v115, v115, s62, -v22
  v_fma_f32 v116, v116, s62, -v22
  v_fma_f32 v117, v117, s62, -v22
  v_fma_f32 v118, v118, s62, -v22
  v_fma_f32 v119, v119, s62, -v22
  v_exp_f32 v112, v112
  v_exp_f32 v113, v113
  v_exp_f32 v114, v114
  v_exp_f32 v115, v115
  v_exp_f32 v116, v116
  v_exp_f32 v117, v117
  v_exp_f32 v118, v118
  v_exp_f32 v119, v119
  v_mul_f32 v23, v23, v24
  v_cvt_pk_bf16_f32 v120, v112, v113
  v_cvt_pk_bf16_f32 v121, v114, v115
  v_cvt_pk_bf16_f32 v122, v116, v117
  v_cvt_pk_bf16_f32 v123, v118, v119
  v_add_f32 v124, v112, v113
  v_add_f32 v125, v114, v115
  v_add_f32 v124, v124, v116
  v_add_f32 v125, v125, v117
  v_add_f32 v124, v124, v118
  v_add_f32 v125, v125, v119
  v_add_f32 v124, v124, v125
  v_add_f32 v23, v23, v124
  v_mul_f32_dpp v48, v24, v48 quad_perm:[0,0,0,0] row_mask:0xf bank_mask:0xf
  v_mul_f32_dpp v49, v24, v49 quad_perm:[1,1,1,1] row_mask:0xf bank_mask:0xf
  v_mul_f32_dpp v50, v24, v50 quad_perm:[2,2,2,2] row_mask:0xf bank_mask:0xf
  v_mul_f32_dpp v51, v24, v51 quad_perm:[3,3,3,3] row_mask:0xf bank_mask:0xf
  v_mul_f32_dpp v52, v24, v52 quad_perm:[0,0,0,0] row_mask:0xf bank_mask:0xf
  v_mul_f32_dpp v53, v24, v53 quad_perm:[1,1,1,1] row_mask:0xf bank_mask:0xf
  v_mul_f32_dpp v54, v24, v54 quad_perm:[2,2,2,2] row_mask:0xf bank_mask:0xf
  v_mul_f32_dpp v55, v24, v55 quad_perm:[3,3,3,3] row_mask:0xf bank_mask:0xf
  v_mul_f32_dpp v56, v24, v56 quad_perm:[0,0,0,0] row_mask:0xf bank_mask:0xf
  v_mul_f32_dpp v57, v24, v57 quad_perm:[1,1,1,1] row_mask:0xf bank_mask:0xf
  v_mul_f32_dpp v58, v24, v58 quad_perm:[2,2,2,2] row_mask:0xf bank_mask:0xf
  v_mul_f32_dpp v59, v24, v59 quad_perm:[3,3,3,3] row_mask:0xf bank_mask:0xf
  v_mul_f32_dpp v60, v24, v60 quad_perm:[0,0,0,0] row_mask:0xf bank_mask:0xf
  v_mul_f32_dpp v61, v24, v61 quad_perm:[1,1,1,1] row_mask:0xf bank_mask:0xf
  v_mul_f32_dpp v62, v24, v62 quad_perm:[2,2,2,2] row_mask:0xf bank_mask:0xf
  v_mul_f32_dpp v63, v24, v63 quad_perm:[3,3,3,3] row_mask:0xf bank_mask:0xf
  v_mul_f32_dpp v64, v24, v64 quad_perm:[0,0,0,0] row_mask:0xf bank_mask:0xf
  v_mul_f32_dpp v65, v24, v65 quad_perm:[1,1,1,1] row_mask:0xf bank_mask:0xf
  v_mul_f32_dpp v66, v24, v66 quad_perm:[2,2,2,2] row_mask:0xf bank_mask:0xf
  v_mul_f32_dpp v67, v24, v67 quad_perm:[3,3,3,3] row_mask:0xf bank_mask:0xf
  v_mul_f32_dpp v68, v24, v68 quad_perm:[0,0,0,0] row_mask:0xf bank_mask:0xf
  v_mul_f32_dpp v69, v24, v69 quad_perm:[1,1,1,1] row_mask:0xf bank_mask:0xf
  v_mul_f32_dpp v70, v24, v70 quad_perm:[2,2,2,2] row_mask:0xf bank_mask:0xf
  v_mul_f32_dpp v71, v24, v71 quad_perm:[3,3,3,3] row_mask:0xf bank_mask:0xf
  v_mul_f32_dpp v72, v24, v72 quad_perm:[0,0,0,0] row_mask:0xf bank_mask:0xf
  v_mul_f32_dpp v73, v24, v73 quad_perm:[1,1,1,1] row_mask:0xf bank_mask:0xf
  v_mul_f32_dpp v74, v24, v74 quad_perm:[2,2,2,2] row_mask:0xf bank_mask:0xf
  v_mul_f32_dpp v75, v24, v75 quad_perm:[3,3,3,3] row_mask:0xf bank_mask:0xf
  v_mul_f32_dpp v76, v24, v76 quad_perm:[0,0,0,0] row_mask:0xf bank_mask:0xf
  v_mul_f32_dpp v77, v24, v77 quad_perm:[1,1,1,1] row_mask:0xf bank_mask:0xf
  v_mul_f32_dpp v78, v24, v78 quad_perm:[2,2,2,2] row_mask:0xf bank_mask:0xf
  v_mul_f32_dpp v79, v24, v79 quad_perm:[3,3,3,3] row_mask:0xf bank_mask:0xf
  v_mfma_f32_16x16x32_bf16 v[48:51], v[120:123], v[160:163], v[48:51]
  v_mfma_f32_16x16x32_bf16 v[52:55], v[120:123], v[164:167], v[52:55]
  v_mfma_f32_16x16x32_bf16 v[56:59], v[120:123], v[168:171], v[56:59]
  v_mfma_f32_16x16x32_bf16 v[60:63], v[120:123], v[172:175], v[60:63]
  v_mfma_f32_16x16x32_bf16 v[64:67], v[120:123], v[176:179], v[64:67]
  v_mfma_f32_16x16x32_bf16 v[68:71], v[120:123], v[180:183], v[68:71]
  v_mfma_f32_16x16x32_bf16 v[72:75], v[120:123], v[184:187], v[72:75]
  v_mfma_f32_16x16x32_bf16 v[76:79], v[120:123], v[188:191], v[76:79]
  s_waitcnt vmcnt(24)
  ds_read_b128 v[80:83], v10 offset:0
  ds_read_b128 v[84:87], v11 offset:0
  ds_read_b128 v[88:91], v12 offset:0
  ds_read_b128 v[92:95], v13 offset:0
  ds_read_b128 v[96:99], v10 offset:4096
  ds_read_b128 v[100:103], v11 offset:4096
  ds_read_b128 v[104:107], v12 offset:4096
  ds_read_b128 v[108:111], v13 offset:4096
  s_waitcnt lgkmcnt(0)
  s_lshl_b32 s31, s29, 6
  s_add_u32 s31, s31, 48
  s_lshl_b32 s31, s31, 13
  s_add_u32 s31, s31, s68
  s_add_u32 s32, s6, s31
  s_addc_u32 s33, s7, 0
  s_add_u32 s34, s32, 16384
  s_addc_u32 s35, s33, 0
  s_add_u32 s36, s8, s31
  s_addc_u32 s37, s9, 0
  s_add_u32 s38, s36, 16384
  s_addc_u32 s39, s37, 0
  v_mfma_f32_16x16x32_bf16 v[112:115], v[80:83], v[32:35], 0
  v_mfma_f32_16x16x32_bf16 v[112:115], v[84:87], v[36:39], v[112:115]
  v_mfma_f32_16x16x32_bf16 v[112:115], v[88:91], v[40:43], v[112:115]
  v_mfma_f32_16x16x32_bf16 v[112:115], v[92:95], v[44:47], v[112:115]
  v_mfma_f32_16x16x32_bf16 v[116:119], v[96:99], v[32:35], 0
  v_mfma_f32_16x16x32_bf16 v[116:119], v[100:103], v[36:39], v[116:119]
  v_mfma_f32_16x16x32_bf16 v[116:119], v[104:107], v[40:43], v[116:119]
  v_mfma_f32_16x16x32_bf16 v[116:119], v[108:111], v[44:47], v[116:119]
  s_add_u32 m0, s47, 0
  s_nop 0
  global_load_lds_dwordx4 v4, s[32:33] offset:0 nt
  global_load_lds_dwordx4 v5, s[32:33] offset:1024 nt
  global_load_lds_dwordx4 v6, s[32:33] offset:2048 nt
  global_load_lds_dwordx4 v7, s[32:33] offset:3072 nt
  s_add_u32 m0, s47, 4096
  s_nop 0
  global_load_lds_dwordx4 v4, s[34:35] offset:0 nt
  global_load_lds_dwordx4 v5, s[34:35] offset:1024 nt
  global_load_lds_dwordx4 v6, s[34:35] offset:2048 nt
  global_load_lds_dwordx4 v7, s[34:35] offset:3072 nt
  s_waitcnt vmcnt(24)
  ds_read_b64_tr_b16 v[80:81], v14 offset:8192
  ds_read_b64_tr_b16 v[84:85], v15 offset:8192
  ds_read_b64_tr_b16 v[88:89], v16 offset:8192
  ds_read_b64_tr_b16 v[92:93], v17 offset:8192
  ds_read_b64_tr_b16 v[96:97], v18 offset:8192
  ds_read_b64_tr_b16 v[100:101], v19 offset:8192
  ds_read_b64_tr_b16 v[104:105], v20 offset:8192
  ds_read_b64_tr_b16 v[108:109], v21 offset:8192
  ds_read_b64_tr_b16 v[82:83], v14 offset:12288
  ds_read_b64_tr_b16 v[86:87], v15 offset:12288
  ds_read_b64_tr_b16 v[90:91], v16 offset:12288
  ds_read_b64_tr_b16 v[94:95], v17 offset:12288
  ds_read_b64_tr_b16 v[98:99], v18 offset:12288
  ds_read_b64_tr_b16 v[102:103], v19 offset:12288
  ds_read_b64_tr_b16 v[106:107], v20 offset:12288
  ds_read_b64_tr_b16 v[110:111], v21 offset:12288
  v_cvt_pk_bf16_f32 v120, v112, v113
  v_cvt_pk_bf16_f32 v121, v114, v115
  v_cvt_pk_bf16_f32 v122, v116, v117
  v_cvt_pk_bf16_f32 v123, v118, v119
  v_lshlrev_b32 v112, 16, v120
  v_and_b32 v113, 0xffff0000, v120
  v_lshlrev_b32 v114, 16, v121
  v_and_b32 v115, 0xffff0000, v121
  v_lshlrev_b32 v116, 16, v122
  v_and_b32 v117, 0xffff0000, v122
  v_lshlrev_b32 v118, 16, v123
  v_and_b32 v119, 0xffff0000, v123
  v_mul_f32 v112, s58, v112
  v_mul_f32 v113, s58, v113
  v_mul_f32 v114, s58, v114
  v_mul_f32 v115, s58, v115
  v_mul_f32 v116, s58, v116
  v_mul_f32 v117, s58, v117
  v_mul_f32 v118, s58, v118
  v_mul_f32 v119, s58, v119
  v_cvt_pk_bf16_f32 v120, v112, v113
  v_cvt_pk_bf16_f32 v121, v114, v115
  v_cvt_pk_bf16_f32 v122, v116, v117
  v_cvt_pk_bf16_f32 v123, v118, v119
  v_lshlrev_b32 v112, 16, v120
  v_and_b32 v113, 0xffff0000, v120
  v_lshlrev_b32 v114, 16, v121
  v_and_b32 v115, 0xffff0000, v121
  v_lshlrev_b32 v116, 16, v122
  v_and_b32 v117, 0xffff0000, v122
  v_lshlrev_b32 v118, 16, v123
  v_and_b32 v119, 0xffff0000, v123
  v_max3_f32 v124, v112, v113, v114
  v_max3_f32 v125, v115, v116, v117
  v_max3_f32 v124, v124, v118, v119
  v_max_f32 v124, v124, v125
  v_mov_b32 v125, v124
  s_nop 1
  v_permlane16_swap_b32 v124, v125
  v_max_f32 v124, v124, v125
  v_mov_b32 v125, v124
  s_nop 1
  v_permlane32_swap_b32 v124, v125
  v_max_f32 v124, v124, v125
  v_mul_f32 v124, s62, v124
  v_max_f32 v124, v124, v22
  v_sub_f32 v24, v22, v124
  v_exp_f32 v24, v24
  v_mov_b32 v22, v124
  v_fma_f32 v112, v112, s62, -v22
  v_fma_f32 v113, v113, s62, -v22
  v_fma_f32 v114, v114, s62, -v22
  v_fma_f32 v115, v115, s62, -v22
  v_fma_f32 v116, v116, s62, -v22
  v_fma_f32 v117, v117, s62, -v22
  v_fma_f32 v118, v118, s62, -v22
  v_fma_f32 v119, v119, s62, -v22
  v_exp_f32 v112, v112
  v_exp_f32 v113, v113
  v_exp_f32 v114, v114
  v_exp_f32 v115, v115
  v_exp_f32 v116, v116
  v_exp_f32 v117, v117
  v_exp_f32 v118, v118
  v_exp_f32 v119, v119
  v_mul_f32 v23, v23, v24
  v_cvt_pk_bf16_f32 v120, v112, v113
  v_cvt_pk_bf16_f32 v121, v114, v115
  v_cvt_pk_bf16_f32 v122, v116, v117
  v_cvt_pk_bf16_f32 v123, v118, v119
  v_add_f32 v124, v112, v113
  v_add_f32 v125, v114, v115
  v_add_f32 v124, v124, v116
  v_add_f32 v125, v125, v117
  v_add_f32 v124, v124, v118
  v_add_f32 v125, v125, v119
  v_add_f32 v124, v124, v125
  v_add_f32 v23, v23, v124
  v_mul_f32_dpp v48, v24, v48 quad_perm:[0,0,0,0] row_mask:0xf bank_mask:0xf
  v_mul_f32_dpp v49, v24, v49 quad_perm:[1,1,1,1] row_mask:0xf bank_mask:0xf
  v_mul_f32_dpp v50, v24, v50 quad_perm:[2,2,2,2] row_mask:0xf bank_mask:0xf
  v_mul_f32_dpp v51, v24, v51 quad_perm:[3,3,3,3] row_mask:0xf bank_mask:0xf
  v_mul_f32_dpp v52, v24, v52 quad_perm:[0,0,0,0] row_mask:0xf bank_mask:0xf
  v_mul_f32_dpp v53, v24, v53 quad_perm:[1,1,1,1] row_mask:0xf bank_mask:0xf
  v_mul_f32_dpp v54, v24, v54 quad_perm:[2,2,2,2] row_mask:0xf bank_mask:0xf
  v_mul_f32_dpp v55, v24, v55 quad_perm:[3,3,3,3] row_mask:0xf bank_mask:0xf
  v_mul_f32_dpp v56, v24, v56 quad_perm:[0,0,0,0] row_mask:0xf bank_mask:0xf
  v_mul_f32_dpp v57, v24, v57 quad_perm:[1,1,1,1] row_mask:0xf bank_mask:0xf
  v_mul_f32_dpp v58, v24, v58 quad_perm:[2,2,2,2] row_mask:0xf bank_mask:0xf
  v_mul_f32_dpp v59, v24, v59 quad_perm:[3,3,3,3] row_mask:0xf bank_mask:0xf
  v_mul_f32_dpp v60, v24, v60 quad_perm:[0,0,0,0] row_mask:0xf bank_mask:0xf
  v_mul_f32_dpp v61, v24, v61 quad_perm:[1,1,1,1] row_mask:0xf bank_mask:0xf
  v_mul_f32_dpp v62, v24, v62 quad_perm:[2,2,2,2] row_mask:0xf bank_mask:0xf
  v_mul_f32_dpp v63, v24, v63 quad_perm:[3,3,3,3] row_mask:0xf bank_mask:0xf
  v_mul_f32_dpp v64, v24, v64 quad_perm:[0,0,0,0] row_mask:0xf bank_mask:0xf
  v_mul_f32_dpp v65, v24, v65 quad_perm:[1,1,1,1] row_mask:0xf bank_mask:0xf
  v_mul_f32_dpp v66, v24, v66 quad_perm:[2,2,2,2] row_mask:0xf bank_mask:0xf
  v_mul_f32_dpp v67, v24, v67 quad_perm:[3,3,3,3] row_mask:0xf bank_mask:0xf
  v_mul_f32_dpp v68, v24, v68 quad_perm:[0,0,0,0] row_mask:0xf bank_mask:0xf
  v_mul_f32_dpp v69, v24, v69 quad_perm:[1,1,1,1] row_mask:0xf bank_mask:0xf
  v_mul_f32_dpp v70, v24, v70 quad_perm:[2,2,2,2] row_mask:0xf bank_mask:0xf
  v_mul_f32_dpp v71, v24, v71 quad_perm:[3,3,3,3] row_mask:0xf bank_mask:0xf
  v_mul_f32_dpp v72, v24, v72 quad_perm:[0,0,0,0] row_mask:0xf bank_mask:0xf
  v_mul_f32_dpp v73, v24, v73 quad_perm:[1,1,1,1] row_mask:0xf bank_mask:0xf
  v_mul_f32_dpp v74, v24, v74 quad_perm:[2,2,2,2] row_mask:0xf bank_mask:0xf
  v_mul_f32_dpp v75, v24, v75 quad_perm:[3,3,3,3] row_mask:0xf bank_mask:0xf
  v_mul_f32_dpp v76, v24, v76 quad_perm:[0,0,0,0] row_mask:0xf bank_mask:0xf
  v_mul_f32_dpp v77, v24, v77 quad_perm:[1,1,1,1] row_mask:0xf bank_mask:0xf
  v_mul_f32_dpp v78, v24, v78 quad_perm:[2,2,2,2] row_mask:0xf bank_mask:0xf
  v_mul_f32_dpp v79, v24, v79 quad_perm:[3,3,3,3] row_mask:0xf bank_mask:0xf
  s_waitcnt lgkmcnt(0)
  v_mfma_f32_16x16x32_bf16 v[48:51], v[120:123], v[80:83], v[48:51]
  v_mfma_f32_16x16x32_bf16 v[52:55], v[120:123], v[84:87], v[52:55]
  v_mfma_f32_16x16x32_bf16 v[56:59], v[120:123], v[88:91], v[56:59]
  v_mfma_f32_16x16x32_bf16 v[60:63], v[120:123], v[92:95], v[60:63]
  v_mfma_f32_16x16x32_bf16 v[64:67], v[120:123], v[96:99], v[64:67]
  v_mfma_f32_16x16x32_bf16 v[68:71], v[120:123], v[100:103], v[68:71]
  v_mfma_f32_16x16x32_bf16 v[72:75], v[120:123], v[104:107], v[72:75]
  v_mfma_f32_16x16x32_bf16 v[76:79], v[120:123], v[108:111], v[76:79]
  s_add_u32 m0, s47, 8192
  s_nop 0
  global_load_lds_dwordx4 v8, s[36:37] offset:0 nt
  global_load_lds_dwordx4 v9, s[36:37] offset:1024 nt
  global_load_lds_dwordx4 v8, s[36:37] offset:2048 nt
  global_load_lds_dwordx4 v9, s[36:37] offset:3072 nt
  s_add_u32 m0, s47, 12288
  s_nop 0
  global_load_lds_dwordx4 v8, s[38:39] offset:0 nt
  global_load_lds_dwordx4 v9, s[38:39] offset:1024 nt
  global_load_lds_dwordx4 v8, s[38:39] offset:2048 nt
  global_load_lds_dwordx4 v9, s[38:39] offset:3072 nt
  v_mfma_f32_16x16x32_bf16 v[112:115], v[192:195], v[32:35], 0
  v_mfma_f32_16x16x32_bf16 v[112:115], v[196:199], v[36:39], v[112:115]
  v_mfma_f32_16x16x32_bf16 v[112:115], v[200:203], v[40:43], v[112:115]
  v_mfma_f32_16x16x32_bf16 v[112:115], v[204:207], v[44:47], v[112:115]
  v_mfma_f32_16x16x32_bf16 v[116:119], v[208:211], v[32:35], 0
  v_mfma_f32_16x16x32_bf16 v[116:119], v[212:215], v[36:39], v[116:119]
  v_mfma_f32_16x16x32_bf16 v[116:119], v[216:219], v[40:43], v[116:119]
  v_mfma_f32_16x16x32_bf16 v[116:119], v[220:223], v[44:47], v[116:119]
  s_nop 3
  v_cvt_pk_bf16_f32 v120, v112, v113
  v_cvt_pk_bf16_f32 v121, v114, v115
  s_nop 1
  v_cvt_pk_bf16_f32 v122, v116, v117
  v_cvt_pk_bf16_f32 v123, v118, v119
  v_lshlrev_b32 v112, 16, v120
  v_and_b32 v113, 0xffff0000, v120
  v_lshlrev_b32 v114, 16, v121
  v_and_b32 v115, 0xffff0000, v121
  v_lshlrev_b32 v116, 16, v122
  v_and_b32 v117, 0xffff0000, v122
  v_lshlrev_b32 v118, 16, v123
  v_and_b32 v119, 0xffff0000, v123
  v_mul_f32 v112, s58, v112
  v_mul_f32 v113, s58, v113
  v_mul_f32 v114, s58, v114
  v_mul_f32 v115, s58, v115
  v_mul_f32 v116, s58, v116
  v_mul_f32 v117, s58, v117
  v_mul_f32 v118, s58, v118
  v_mul_f32 v119, s58, v119
  v_cvt_pk_bf16_f32 v120, v112, v113
  v_cvt_pk_bf16_f32 v121, v114, v115
  v_cvt_pk_bf16_f32 v122, v116, v117
  v_cvt_pk_bf16_f32 v123, v118, v119
  v_lshlrev_b32 v112, 16, v120
  v_and_b32 v113, 0xffff0000, v120
  v_lshlrev_b32 v114, 16, v121
  v_and_b32 v115, 0xffff0000, v121
  v_lshlrev_b32 v116, 16, v122
  v_and_b32 v117, 0xffff0000, v122
  v_lshlrev_b32 v118, 16, v123
  v_and_b32 v119, 0xffff0000, v123
  v_max3_f32 v124, v112, v113, v114
  v_max3_f32 v125, v115, v116, v117
  v_max3_f32 v124, v124, v118, v119
  v_max_f32 v124, v124, v125
  v_mov_b32 v125, v124
  s_nop 1
  v_permlane16_swap_b32 v124, v125
  v_max_f32 v124, v124, v125
  v_mov_b32 v125, v124
  s_nop 1
  v_permlane32_swap_b32 v124, v125
  v_max_f32 v124, v124, v125
  v_mul_f32 v124, s62, v124
  v_max_f32 v124, v124, v22
  v_sub_f32 v24, v22, v124
  v_exp_f32 v24, v24
  v_mov_b32 v22, v124
  v_fma_f32 v112, v112, s62, -v22
  v_fma_f32 v113, v113, s62, -v22
  v_fma_f32 v114, v114, s62, -v22
  v_fma_f32 v115, v115, s62, -v22
  v_fma_f32 v116, v116, s62, -v22
  v_fma_f32 v117, v117, s62, -v22
  v_fma_f32 v118, v118, s62, -v22
  v_fma_f32 v119, v119, s62, -v22
  v_exp_f32 v112, v112
  v_exp_f32 v113, v113
  v_exp_f32 v114, v114
  v_exp_f32 v115, v115
  v_exp_f32 v116, v116
  v_exp_f32 v117, v117
  v_exp_f32 v118, v118
  v_exp_f32 v119, v119
  v_mul_f32 v23, v23, v24
  v_cvt_pk_bf16_f32 v120, v112, v113
  v_cvt_pk_bf16_f32 v121, v114, v115
  v_cvt_pk_bf16_f32 v122, v116, v117
  v_cvt_pk_bf16_f32 v123, v118, v119
  v_add_f32 v124, v112, v113
  v_add_f32 v125, v114, v115
  v_add_f32 v124, v124, v116
  v_add_f32 v125, v125, v117
  v_add_f32 v124, v124, v118
  v_add_f32 v125, v125, v119
  v_add_f32 v124, v124, v125
  v_add_f32 v23, v23, v124
  v_mul_f32_dpp v48, v24, v48 quad_perm:[0,0,0,0] row_mask:0xf bank_mask:0xf
  v_mul_f32_dpp v49, v24, v49 quad_perm:[1,1,1,1] row_mask:0xf bank_mask:0xf
  v_mul_f32_dpp v50, v24, v50 quad_perm:[2,2,2,2] row_mask:0xf bank_mask:0xf
  v_mul_f32_dpp v51, v24, v51 quad_perm:[3,3,3,3] row_mask:0xf bank_mask:0xf
  v_mul_f32_dpp v52, v24, v52 quad_perm:[0,0,0,0] row_mask:0xf bank_mask:0xf
  v_mul_f32_dpp v53, v24, v53 quad_perm:[1,1,1,1] row_mask:0xf bank_mask:0xf
  v_mul_f32_dpp v54, v24, v54 quad_perm:[2,2,2,2] row_mask:0xf bank_mask:0xf
  v_mul_f32_dpp v55, v24, v55 quad_perm:[3,3,3,3] row_mask:0xf bank_mask:0xf
  v_mul_f32_dpp v56, v24, v56 quad_perm:[0,0,0,0] row_mask:0xf bank_mask:0xf
  v_mul_f32_dpp v57, v24, v57 quad_perm:[1,1,1,1] row_mask:0xf bank_mask:0xf
  v_mul_f32_dpp v58, v24, v58 quad_perm:[2,2,2,2] row_mask:0xf bank_mask:0xf
  v_mul_f32_dpp v59, v24, v59 quad_perm:[3,3,3,3] row_mask:0xf bank_mask:0xf
  v_mul_f32_dpp v60, v24, v60 quad_perm:[0,0,0,0] row_mask:0xf bank_mask:0xf
  v_mul_f32_dpp v61, v24, v61 quad_perm:[1,1,1,1] row_mask:0xf bank_mask:0xf
  v_mul_f32_dpp v62, v24, v62 quad_perm:[2,2,2,2] row_mask:0xf bank_mask:0xf
  v_mul_f32_dpp v63, v24, v63 quad_perm:[3,3,3,3] row_mask:0xf bank_mask:0xf
  v_mul_f32_dpp v64, v24, v64 quad_perm:[0,0,0,0] row_mask:0xf bank_mask:0xf
  v_mul_f32_dpp v65, v24, v65 quad_perm:[1,1,1,1] row_mask:0xf bank_mask:0xf
  v_mul_f32_dpp v66, v24, v66 quad_perm:[2,2,2,2] row_mask:0xf bank_mask:0xf
  v_mul_f32_dpp v67, v24, v67 quad_perm:[3,3,3,3] row_mask:0xf bank_mask:0xf
  v_mul_f32_dpp v68, v24, v68 quad_perm:[0,0,0,0] row_mask:0xf bank_mask:0xf
  v_mul_f32_dpp v69, v24, v69 quad_perm:[1,1,1,1] row_mask:0xf bank_mask:0xf
  v_mul_f32_dpp v70, v24, v70 quad_perm:[2,2,2,2] row_mask:0xf bank_mask:0xf
  v_mul_f32_dpp v71, v24, v71 quad_perm:[3,3,3,3] row_mask:0xf bank_mask:0xf
  v_mul_f32_dpp v72, v24, v72 quad_perm:[0,0,0,0] row_mask:0xf bank_mask:0xf
  v_mul_f32_dpp v73, v24, v73 quad_perm:[1,1,1,1] row_mask:0xf bank_mask:0xf
  v_mul_f32_dpp v74, v24, v74 quad_perm:[2,2,2,2] row_mask:0xf bank_mask:0xf
  v_mul_f32_dpp v75, v24, v75 quad_perm:[3,3,3,3] row_mask:0xf bank_mask:0xf
  v_mul_f32_dpp v76, v24, v76 quad_perm:[0,0,0,0] row_mask:0xf bank_mask:0xf
  v_mul_f32_dpp v77, v24, v77 quad_perm:[1,1,1,1] row_mask:0xf bank_mask:0xf
  v_mul_f32_dpp v78, v24, v78 quad_perm:[2,2,2,2] row_mask:0xf bank_mask:0xf
  v_mul_f32_dpp v79, v24, v79 quad_perm:[3,3,3,3] row_mask:0xf bank_mask:0xf
  v_mfma_f32_16x16x32_bf16 v[48:51], v[120:123], v[224:227], v[48:51]
  v_mfma_f32_16x16x32_bf16 v[52:55], v[120:123], v[228:231], v[52:55]
  v_mfma_f32_16x16x32_bf16 v[56:59], v[120:123], v[232:235], v[56:59]
  v_mfma_f32_16x16x32_bf16 v[60:63], v[120:123], v[236:239], v[60:63]
  v_mfma_f32_16x16x32_bf16 v[64:67], v[120:123], v[240:243], v[64:67]
  v_mfma_f32_16x16x32_bf16 v[68:71], v[120:123], v[244:247], v[68:71]
  v_mfma_f32_16x16x32_bf16 v[72:75], v[120:123], v[248:251], v[72:75]
  v_mfma_f32_16x16x32_bf16 v[76:79], v[120:123], v[252:255], v[76:79]
  v_mfma_f32_16x16x32_bf16 v[112:115], a[0:3], v[32:35], 0
  v_mfma_f32_16x16x32_bf16 v[112:115], a[4:7], v[36:39], v[112:115]
  v_mfma_f32_16x16x32_bf16 v[112:115], a[8:11], v[40:43], v[112:115]
  v_mfma_f32_16x16x32_bf16 v[112:115], a[12:15], v[44:47], v[112:115]
  v_mfma_f32_16x16x32_bf16 v[116:119], a[16:19], v[32:35], 0
  v_mfma_f32_16x16x32_bf16 v[116:119], a[20:23], v[36:39], v[116:119]
  v_mfma_f32_16x16x32_bf16 v[116:119], a[24:27], v[40:43], v[116:119]
  v_mfma_f32_16x16x32_bf16 v[116:119], a[28:31], v[44:47], v[116:119]
  s_nop 3
  v_cvt_pk_bf16_f32 v120, v112, v113
  v_cvt_pk_bf16_f32 v121, v114, v115
  s_nop 1
  v_cvt_pk_bf16_f32 v122, v116, v117
  v_cvt_pk_bf16_f32 v123, v118, v119
  v_lshlrev_b32 v112, 16, v120
  v_and_b32 v113, 0xffff0000, v120
  v_lshlrev_b32 v114, 16, v121
  v_and_b32 v115, 0xffff0000, v121
  v_lshlrev_b32 v116, 16, v122
  v_and_b32 v117, 0xffff0000, v122
  v_lshlrev_b32 v118, 16, v123
  v_and_b32 v119, 0xffff0000, v123
  v_mul_f32 v112, s58, v112
  v_mul_f32 v113, s58, v113
  v_mul_f32 v114, s58, v114
  v_mul_f32 v115, s58, v115
  v_mul_f32 v116, s58, v116
  v_mul_f32 v117, s58, v117
  v_mul_f32 v118, s58, v118
  v_mul_f32 v119, s58, v119
  v_cvt_pk_bf16_f32 v120, v112, v113
  v_cvt_pk_bf16_f32 v121, v114, v115
  v_cvt_pk_bf16_f32 v122, v116, v117
  v_cvt_pk_bf16_f32 v123, v118, v119
  v_lshlrev_b32 v112, 16, v120
  v_and_b32 v113, 0xffff0000, v120
  v_lshlrev_b32 v114, 16, v121
  v_and_b32 v115, 0xffff0000, v121
  v_lshlrev_b32 v116, 16, v122
  v_and_b32 v117, 0xffff0000, v122
  v_lshlrev_b32 v118, 16, v123
  v_and_b32 v119, 0xffff0000, v123
  v_max3_f32 v124, v112, v113, v114
  v_max3_f32 v125, v115, v116, v117
  v_max3_f32 v124, v124, v118, v119
  v_max_f32 v124, v124, v125
  v_mov_b32 v125, v124
  s_nop 1
  v_permlane16_swap_b32 v124, v125
  v_max_f32 v124, v124, v125
  v_mov_b32 v125, v124
  s_nop 1
  v_permlane32_swap_b32 v124, v125
  v_max_f32 v124, v124, v125
  v_mul_f32 v124, s62, v124
  v_max_f32 v124, v124, v22
  v_sub_f32 v24, v22, v124
  v_exp_f32 v24, v24
  v_mov_b32 v22, v124
  v_fma_f32 v112, v112, s62, -v22
  v_fma_f32 v113, v113, s62, -v22
  v_fma_f32 v114, v114, s62, -v22
  v_fma_f32 v115, v115, s62, -v22
  v_fma_f32 v116, v116, s62, -v22
  v_fma_f32 v117, v117, s62, -v22
  v_fma_f32 v118, v118, s62, -v22
  v_fma_f32 v119, v119, s62, -v22
  v_exp_f32 v112, v112
  v_exp_f32 v113, v113
  v_exp_f32 v114, v114
  v_exp_f32 v115, v115
  v_exp_f32 v116, v116
  v_exp_f32 v117, v117
  v_exp_f32 v118, v118
  v_exp_f32 v119, v119
  v_mul_f32 v23, v23, v24
  v_cvt_pk_bf16_f32 v120, v112, v113
  v_cvt_pk_bf16_f32 v121, v114, v115
  v_cvt_pk_bf16_f32 v122, v116, v117
  v_cvt_pk_bf16_f32 v123, v118, v119
  v_add_f32 v124, v112, v113
  v_add_f32 v125, v114, v115
  v_add_f32 v124, v124, v116
  v_add_f32 v125, v125, v117
  v_add_f32 v124, v124, v118
  v_add_f32 v125, v125, v119
  v_add_f32 v124, v124, v125
  v_add_f32 v23, v23, v124
  v_mul_f32_dpp v48, v24, v48 quad_perm:[0,0,0,0] row_mask:0xf bank_mask:0xf
  v_mul_f32_dpp v49, v24, v49 quad_perm:[1,1,1,1] row_mask:0xf bank_mask:0xf
  v_mul_f32_dpp v50, v24, v50 quad_perm:[2,2,2,2] row_mask:0xf bank_mask:0xf
  v_mul_f32_dpp v51, v24, v51 quad_perm:[3,3,3,3] row_mask:0xf bank_mask:0xf
  v_mul_f32_dpp v52, v24, v52 quad_perm:[0,0,0,0] row_mask:0xf bank_mask:0xf
  v_mul_f32_dpp v53, v24, v53 quad_perm:[1,1,1,1] row_mask:0xf bank_mask:0xf
  v_mul_f32_dpp v54, v24, v54 quad_perm:[2,2,2,2] row_mask:0xf bank_mask:0xf
  v_mul_f32_dpp v55, v24, v55 quad_perm:[3,3,3,3] row_mask:0xf bank_mask:0xf
  v_mul_f32_dpp v56, v24, v56 quad_perm:[0,0,0,0] row_mask:0xf bank_mask:0xf
  v_mul_f32_dpp v57, v24, v57 quad_perm:[1,1,1,1] row_mask:0xf bank_mask:0xf
  v_mul_f32_dpp v58, v24, v58 quad_perm:[2,2,2,2] row_mask:0xf bank_mask:0xf
  v_mul_f32_dpp v59, v24, v59 quad_perm:[3,3,3,3] row_mask:0xf bank_mask:0xf
  v_mul_f32_dpp v60, v24, v60 quad_perm:[0,0,0,0] row_mask:0xf bank_mask:0xf
  v_mul_f32_dpp v61, v24, v61 quad_perm:[1,1,1,1] row_mask:0xf bank_mask:0xf
  v_mul_f32_dpp v62, v24, v62 quad_perm:[2,2,2,2] row_mask:0xf bank_mask:0xf
  v_mul_f32_dpp v63, v24, v63 quad_perm:[3,3,3,3] row_mask:0xf bank_mask:0xf
  v_mul_f32_dpp v64, v24, v64 quad_perm:[0,0,0,0] row_mask:0xf bank_mask:0xf
  v_mul_f32_dpp v65, v24, v65 quad_perm:[1,1,1,1] row_mask:0xf bank_mask:0xf
  v_mul_f32_dpp v66, v24, v66 quad_perm:[2,2,2,2] row_mask:0xf bank_mask:0xf
  v_mul_f32_dpp v67, v24, v67 quad_perm:[3,3,3,3] row_mask:0xf bank_mask:0xf
  v_mul_f32_dpp v68, v24, v68 quad_perm:[0,0,0,0] row_mask:0xf bank_mask:0xf
  v_mul_f32_dpp v69, v24, v69 quad_perm:[1,1,1,1] row_mask:0xf bank_mask:0xf
  v_mul_f32_dpp v70, v24, v70 quad_perm:[2,2,2,2] row_mask:0xf bank_mask:0xf
  v_mul_f32_dpp v71, v24, v71 quad_perm:[3,3,3,3] row_mask:0xf bank_mask:0xf
  v_mul_f32_dpp v72, v24, v72 quad_perm:[0,0,0,0] row_mask:0xf bank_mask:0xf
  v_mul_f32_dpp v73, v24, v73 quad_perm:[1,1,1,1] row_mask:0xf bank_mask:0xf
  v_mul_f32_dpp v74, v24, v74 quad_perm:[2,2,2,2] row_mask:0xf bank_mask:0xf
  v_mul_f32_dpp v75, v24, v75 quad_perm:[3,3,3,3] row_mask:0xf bank_mask:0xf
  v_mul_f32_dpp v76, v24, v76 quad_perm:[0,0,0,0] row_mask:0xf bank_mask:0xf
  v_mul_f32_dpp v77, v24, v77 quad_perm:[1,1,1,1] row_mask:0xf bank_mask:0xf
  v_mul_f32_dpp v78, v24, v78 quad_perm:[2,2,2,2] row_mask:0xf bank_mask:0xf
  v_mul_f32_dpp v79, v24, v79 quad_perm:[3,3,3,3] row_mask:0xf bank_mask:0xf
  v_mfma_f32_16x16x32_bf16 v[48:51], v[120:123], a[32:35], v[48:51]
  v_mfma_f32_16x16x32_bf16 v[52:55], v[120:123], a[36:39], v[52:55]
  v_mfma_f32_16x16x32_bf16 v[56:59], v[120:123], a[40:43], v[56:59]
  v_mfma_f32_16x16x32_bf16 v[60:63], v[120:123], a[44:47], v[60:63]
  v_mfma_f32_16x16x32_bf16 v[64:67], v[120:123], a[48:51], v[64:67]
  v_mfma_f32_16x16x32_bf16 v[68:71], v[120:123], a[52:55], v[68:71]
  v_mfma_f32_16x16x32_bf16 v[72:75], v[120:123], a[56:59], v[72:75]
  v_mfma_f32_16x16x32_bf16 v[76:79], v[120:123], a[60:63], v[76:79]
  s_waitcnt vmcnt(24)
  ds_read_b128 v[80:83], v10 offset:16384
  ds_read_b128 v[84:87], v11 offset:16384
  ds_read_b128 v[88:91], v12 offset:16384
  ds_read_b128 v[92:95], v13 offset:16384
  ds_read_b128 v[96:99], v10 offset:20480
  ds_read_b128 v[100:103], v11 offset:20480
  ds_read_b128 v[104:107], v12 offset:20480
  ds_read_b128 v[108:111], v13 offset:20480
  s_waitcnt lgkmcnt(0)
  s_lshl_b32 s31, s29, 6
  s_add_u32 s31, s31, 52
  s_lshl_b32 s31, s31, 13
  s_add_u32 s31, s31, s68
  s_add_u32 s32, s6, s31
  s_addc_u32 s33, s7, 0
  s_add_u32 s34, s32, 16384
  s_addc_u32 s35, s33, 0
  s_add_u32 s36, s8, s31
  s_addc_u32 s37, s9, 0
  s_add_u32 s38, s36, 16384
  s_addc_u32 s39, s37, 0
  v_mfma_f32_16x16x32_bf16 v[112:115], v[80:83], v[32:35], 0
  v_mfma_f32_16x16x32_bf16 v[112:115], v[84:87], v[36:39], v[112:115]
  v_mfma_f32_16x16x32_bf16 v[112:115], v[88:91], v[40:43], v[112:115]
  v_mfma_f32_16x16x32_bf16 v[112:115], v[92:95], v[44:47], v[112:115]
  v_mfma_f32_16x16x32_bf16 v[116:119], v[96:99], v[32:35], 0
  v_mfma_f32_16x16x32_bf16 v[116:119], v[100:103], v[36:39], v[116:119]
  v_mfma_f32_16x16x32_bf16 v[116:119], v[104:107], v[40:43], v[116:119]
  v_mfma_f32_16x16x32_bf16 v[116:119], v[108:111], v[44:47], v[116:119]
  s_add_u32 m0, s47, 16384
  s_nop 0
  global_load_lds_dwordx4 v4, s[32:33] offset:0 nt
  global_load_lds_dwordx4 v5, s[32:33] offset:1024 nt
  global_load_lds_dwordx4 v6, s[32:33] offset:2048 nt
  global_load_lds_dwordx4 v7, s[32:33] offset:3072 nt
  s_add_u32 m0, s47, 20480
  s_nop 0
  global_load_lds_dwordx4 v4, s[34:35] offset:0 nt
  global_load_lds_dwordx4 v5, s[34:35] offset:1024 nt
  global_load_lds_dwordx4 v6, s[34:35] offset:2048 nt
  global_load_lds_dwordx4 v7, s[34:35] offset:3072 nt
  s_waitcnt vmcnt(24)
  ds_read_b64_tr_b16 v[80:81], v14 offset:24576
  ds_read_b64_tr_b16 v[84:85], v15 offset:24576
  ds_read_b64_tr_b16 v[88:89], v16 offset:24576
  ds_read_b64_tr_b16 v[92:93], v17 offset:24576
  ds_read_b64_tr_b16 v[96:97], v18 offset:24576
  ds_read_b64_tr_b16 v[100:101], v19 offset:24576
  ds_read_b64_tr_b16 v[104:105], v20 offset:24576
  ds_read_b64_tr_b16 v[108:109], v21 offset:24576
  ds_read_b64_tr_b16 v[82:83], v14 offset:28672
  ds_read_b64_tr_b16 v[86:87], v15 offset:28672
  ds_read_b64_tr_b16 v[90:91], v16 offset:28672
  ds_read_b64_tr_b16 v[94:95], v17 offset:28672
  ds_read_b64_tr_b16 v[98:99], v18 offset:28672
  ds_read_b64_tr_b16 v[102:103], v19 offset:28672
  ds_read_b64_tr_b16 v[106:107], v20 offset:28672
  ds_read_b64_tr_b16 v[110:111], v21 offset:28672
  v_cvt_pk_bf16_f32 v120, v112, v113
  v_cvt_pk_bf16_f32 v121, v114, v115
  v_cvt_pk_bf16_f32 v122, v116, v117
  v_cvt_pk_bf16_f32 v123, v118, v119
  v_lshlrev_b32 v112, 16, v120
  v_and_b32 v113, 0xffff0000, v120
  v_lshlrev_b32 v114, 16, v121
  v_and_b32 v115, 0xffff0000, v121
  v_lshlrev_b32 v116, 16, v122
  v_and_b32 v117, 0xffff0000, v122
  v_lshlrev_b32 v118, 16, v123
  v_and_b32 v119, 0xffff0000, v123
  v_mul_f32 v112, s58, v112
  v_mul_f32 v113, s58, v113
  v_mul_f32 v114, s58, v114
  v_mul_f32 v115, s58, v115
  v_mul_f32 v116, s58, v116
  v_mul_f32 v117, s58, v117
  v_mul_f32 v118, s58, v118
  v_mul_f32 v119, s58, v119
  v_cvt_pk_bf16_f32 v120, v112, v113
  v_cvt_pk_bf16_f32 v121, v114, v115
  v_cvt_pk_bf16_f32 v122, v116, v117
  v_cvt_pk_bf16_f32 v123, v118, v119
  v_lshlrev_b32 v112, 16, v120
  v_and_b32 v113, 0xffff0000, v120
  v_lshlrev_b32 v114, 16, v121
  v_and_b32 v115, 0xffff0000, v121
  v_lshlrev_b32 v116, 16, v122
  v_and_b32 v117, 0xffff0000, v122
  v_lshlrev_b32 v118, 16, v123
  v_and_b32 v119, 0xffff0000, v123
  v_max3_f32 v124, v112, v113, v114
  v_max3_f32 v125, v115, v116, v117
  v_max3_f32 v124, v124, v118, v119
  v_max_f32 v124, v124, v125
  v_mov_b32 v125, v124
  s_nop 1
  v_permlane16_swap_b32 v124, v125
  v_max_f32 v124, v124, v125
  v_mov_b32 v125, v124
  s_nop 1
  v_permlane32_swap_b32 v124, v125
  v_max_f32 v124, v124, v125
  v_mul_f32 v124, s62, v124
  v_max_f32 v124, v124, v22
  v_sub_f32 v24, v22, v124
  v_exp_f32 v24, v24
  v_mov_b32 v22, v124
  v_fma_f32 v112, v112, s62, -v22
  v_fma_f32 v113, v113, s62, -v22
  v_fma_f32 v114, v114, s62, -v22
  v_fma_f32 v115, v115, s62, -v22
  v_fma_f32 v116, v116, s62, -v22
  v_fma_f32 v117, v117, s62, -v22
  v_fma_f32 v118, v118, s62, -v22
  v_fma_f32 v119, v119, s62, -v22
  v_exp_f32 v112, v112
  v_exp_f32 v113, v113
  v_exp_f32 v114, v114
  v_exp_f32 v115, v115
  v_exp_f32 v116, v116
  v_exp_f32 v117, v117
  v_exp_f32 v118, v118
  v_exp_f32 v119, v119
  v_mul_f32 v23, v23, v24
  v_cvt_pk_bf16_f32 v120, v112, v113
  v_cvt_pk_bf16_f32 v121, v114, v115
  v_cvt_pk_bf16_f32 v122, v116, v117
  v_cvt_pk_bf16_f32 v123, v118, v119
  v_add_f32 v124, v112, v113
  v_add_f32 v125, v114, v115
  v_add_f32 v124, v124, v116
  v_add_f32 v125, v125, v117
  v_add_f32 v124, v124, v118
  v_add_f32 v125, v125, v119
  v_add_f32 v124, v124, v125
  v_add_f32 v23, v23, v124
  v_mul_f32_dpp v48, v24, v48 quad_perm:[0,0,0,0] row_mask:0xf bank_mask:0xf
  v_mul_f32_dpp v49, v24, v49 quad_perm:[1,1,1,1] row_mask:0xf bank_mask:0xf
  v_mul_f32_dpp v50, v24, v50 quad_perm:[2,2,2,2] row_mask:0xf bank_mask:0xf
  v_mul_f32_dpp v51, v24, v51 quad_perm:[3,3,3,3] row_mask:0xf bank_mask:0xf
  v_mul_f32_dpp v52, v24, v52 quad_perm:[0,0,0,0] row_mask:0xf bank_mask:0xf
  v_mul_f32_dpp v53, v24, v53 quad_perm:[1,1,1,1] row_mask:0xf bank_mask:0xf
  v_mul_f32_dpp v54, v24, v54 quad_perm:[2,2,2,2] row_mask:0xf bank_mask:0xf
  v_mul_f32_dpp v55, v24, v55 quad_perm:[3,3,3,3] row_mask:0xf bank_mask:0xf
  v_mul_f32_dpp v56, v24, v56 quad_perm:[0,0,0,0] row_mask:0xf bank_mask:0xf
  v_mul_f32_dpp v57, v24, v57 quad_perm:[1,1,1,1] row_mask:0xf bank_mask:0xf
  v_mul_f32_dpp v58, v24, v58 quad_perm:[2,2,2,2] row_mask:0xf bank_mask:0xf
  v_mul_f32_dpp v59, v24, v59 quad_perm:[3,3,3,3] row_mask:0xf bank_mask:0xf
  v_mul_f32_dpp v60, v24, v60 quad_perm:[0,0,0,0] row_mask:0xf bank_mask:0xf
  v_mul_f32_dpp v61, v24, v61 quad_perm:[1,1,1,1] row_mask:0xf bank_mask:0xf
  v_mul_f32_dpp v62, v24, v62 quad_perm:[2,2,2,2] row_mask:0xf bank_mask:0xf
  v_mul_f32_dpp v63, v24, v63 quad_perm:[3,3,3,3] row_mask:0xf bank_mask:0xf
  v_mul_f32_dpp v64, v24, v64 quad_perm:[0,0,0,0] row_mask:0xf bank_mask:0xf
  v_mul_f32_dpp v65, v24, v65 quad_perm:[1,1,1,1] row_mask:0xf bank_mask:0xf
  v_mul_f32_dpp v66, v24, v66 quad_perm:[2,2,2,2] row_mask:0xf bank_mask:0xf
  v_mul_f32_dpp v67, v24, v67 quad_perm:[3,3,3,3] row_mask:0xf bank_mask:0xf
  v_mul_f32_dpp v68, v24, v68 quad_perm:[0,0,0,0] row_mask:0xf bank_mask:0xf
  v_mul_f32_dpp v69, v24, v69 quad_perm:[1,1,1,1] row_mask:0xf bank_mask:0xf
  v_mul_f32_dpp v70, v24, v70 quad_perm:[2,2,2,2] row_mask:0xf bank_mask:0xf
  v_mul_f32_dpp v71, v24, v71 quad_perm:[3,3,3,3] row_mask:0xf bank_mask:0xf
  v_mul_f32_dpp v72, v24, v72 quad_perm:[0,0,0,0] row_mask:0xf bank_mask:0xf
  v_mul_f32_dpp v73, v24, v73 quad_perm:[1,1,1,1] row_mask:0xf bank_mask:0xf
  v_mul_f32_dpp v74, v24, v74 quad_perm:[2,2,2,2] row_mask:0xf bank_mask:0xf
  v_mul_f32_dpp v75, v24, v75 quad_perm:[3,3,3,3] row_mask:0xf bank_mask:0xf
  v_mul_f32_dpp v76, v24, v76 quad_perm:[0,0,0,0] row_mask:0xf bank_mask:0xf
  v_mul_f32_dpp v77, v24, v77 quad_perm:[1,1,1,1] row_mask:0xf bank_mask:0xf
  v_mul_f32_dpp v78, v24, v78 quad_perm:[2,2,2,2] row_mask:0xf bank_mask:0xf
  v_mul_f32_dpp v79, v24, v79 quad_perm:[3,3,3,3] row_mask:0xf bank_mask:0xf
  s_waitcnt lgkmcnt(0)
  v_mfma_f32_16x16x32_bf16 v[48:51], v[120:123], v[80:83], v[48:51]
  v_mfma_f32_16x16x32_bf16 v[52:55], v[120:123], v[84:87], v[52:55]
  v_mfma_f32_16x16x32_bf16 v[56:59], v[120:123], v[88:91], v[56:59]
  v_mfma_f32_16x16x32_bf16 v[60:63], v[120:123], v[92:95], v[60:63]
  v_mfma_f32_16x16x32_bf16 v[64:67], v[120:123], v[96:99], v[64:67]
  v_mfma_f32_16x16x32_bf16 v[68:71], v[120:123], v[100:103], v[68:71]
  v_mfma_f32_16x16x32_bf16 v[72:75], v[120:123], v[104:107], v[72:75]
  v_mfma_f32_16x16x32_bf16 v[76:79], v[120:123], v[108:111], v[76:79]
  s_add_u32 m0, s47, 24576
  s_nop 0
  global_load_lds_dwordx4 v8, s[36:37] offset:0 nt
  global_load_lds_dwordx4 v9, s[36:37] offset:1024 nt
  global_load_lds_dwordx4 v8, s[36:37] offset:2048 nt
  global_load_lds_dwordx4 v9, s[36:37] offset:3072 nt
  s_add_u32 m0, s47, 28672
  s_nop 0
  global_load_lds_dwordx4 v8, s[38:39] offset:0 nt
  global_load_lds_dwordx4 v9, s[38:39] offset:1024 nt
  global_load_lds_dwordx4 v8, s[38:39] offset:2048 nt
  global_load_lds_dwordx4 v9, s[38:39] offset:3072 nt
  v_mfma_f32_16x16x32_bf16 v[112:115], a[64:67], v[32:35], 0
  v_mfma_f32_16x16x32_bf16 v[112:115], a[68:71], v[36:39], v[112:115]
  v_mfma_f32_16x16x32_bf16 v[112:115], a[72:75], v[40:43], v[112:115]
  v_mfma_f32_16x16x32_bf16 v[112:115], a[76:79], v[44:47], v[112:115]
  v_mfma_f32_16x16x32_bf16 v[116:119], a[80:83], v[32:35], 0
  v_mfma_f32_16x16x32_bf16 v[116:119], a[84:87], v[36:39], v[116:119]
  v_mfma_f32_16x16x32_bf16 v[116:119], a[88:91], v[40:43], v[116:119]
  v_mfma_f32_16x16x32_bf16 v[116:119], a[92:95], v[44:47], v[116:119]
  s_nop 3
  v_cvt_pk_bf16_f32 v120, v112, v113
  v_cvt_pk_bf16_f32 v121, v114, v115
  s_nop 1
  v_cvt_pk_bf16_f32 v122, v116, v117
  v_cvt_pk_bf16_f32 v123, v118, v119
  v_lshlrev_b32 v112, 16, v120
  v_and_b32 v113, 0xffff0000, v120
  v_lshlrev_b32 v114, 16, v121
  v_and_b32 v115, 0xffff0000, v121
  v_lshlrev_b32 v116, 16, v122
  v_and_b32 v117, 0xffff0000, v122
  v_lshlrev_b32 v118, 16, v123
  v_and_b32 v119, 0xffff0000, v123
  v_mul_f32 v112, s58, v112
  v_mul_f32 v113, s58, v113
  v_mul_f32 v114, s58, v114
  v_mul_f32 v115, s58, v115
  v_mul_f32 v116, s58, v116
  v_mul_f32 v117, s58, v117
  v_mul_f32 v118, s58, v118
  v_mul_f32 v119, s58, v119
  v_cvt_pk_bf16_f32 v120, v112, v113
  v_cvt_pk_bf16_f32 v121, v114, v115
  v_cvt_pk_bf16_f32 v122, v116, v117
  v_cvt_pk_bf16_f32 v123, v118, v119
  v_lshlrev_b32 v112, 16, v120
  v_and_b32 v113, 0xffff0000, v120
  v_lshlrev_b32 v114, 16, v121
  v_and_b32 v115, 0xffff0000, v121
  v_lshlrev_b32 v116, 16, v122
  v_and_b32 v117, 0xffff0000, v122
  v_lshlrev_b32 v118, 16, v123
  v_and_b32 v119, 0xffff0000, v123
  v_max3_f32 v124, v112, v113, v114
  v_max3_f32 v125, v115, v116, v117
  v_max3_f32 v124, v124, v118, v119
  v_max_f32 v124, v124, v125
  v_mov_b32 v125, v124
  s_nop 1
  v_permlane16_swap_b32 v124, v125
  v_max_f32 v124, v124, v125
  v_mov_b32 v125, v124
  s_nop 1
  v_permlane32_swap_b32 v124, v125
  v_max_f32 v124, v124, v125
  v_mul_f32 v124, s62, v124
  v_max_f32 v124, v124, v22
  v_sub_f32 v24, v22, v124
  v_exp_f32 v24, v24
  v_mov_b32 v22, v124
  v_fma_f32 v112, v112, s62, -v22
  v_fma_f32 v113, v113, s62, -v22
  v_fma_f32 v114, v114, s62, -v22
  v_fma_f32 v115, v115, s62, -v22
  v_fma_f32 v116, v116, s62, -v22
  v_fma_f32 v117, v117, s62, -v22
  v_fma_f32 v118, v118, s62, -v22
  v_fma_f32 v119, v119, s62, -v22
  v_exp_f32 v112, v112
  v_exp_f32 v113, v113
  v_exp_f32 v114, v114
  v_exp_f32 v115, v115
  v_exp_f32 v116, v116
  v_exp_f32 v117, v117
  v_exp_f32 v118, v118
  v_exp_f32 v119, v119
  v_mul_f32 v23, v23, v24
  v_cvt_pk_bf16_f32 v120, v112, v113
  v_cvt_pk_bf16_f32 v121, v114, v115
  v_cvt_pk_bf16_f32 v122, v116, v117
  v_cvt_pk_bf16_f32 v123, v118, v119
  v_add_f32 v124, v112, v113
  v_add_f32 v125, v114, v115
  v_add_f32 v124, v124, v116
  v_add_f32 v125, v125, v117
  v_add_f32 v124, v124, v118
  v_add_f32 v125, v125, v119
  v_add_f32 v124, v124, v125
  v_add_f32 v23, v23, v124
  v_mul_f32_dpp v48, v24, v48 quad_perm:[0,0,0,0] row_mask:0xf bank_mask:0xf
  v_mul_f32_dpp v49, v24, v49 quad_perm:[1,1,1,1] row_mask:0xf bank_mask:0xf
  v_mul_f32_dpp v50, v24, v50 quad_perm:[2,2,2,2] row_mask:0xf bank_mask:0xf
  v_mul_f32_dpp v51, v24, v51 quad_perm:[3,3,3,3] row_mask:0xf bank_mask:0xf
  v_mul_f32_dpp v52, v24, v52 quad_perm:[0,0,0,0] row_mask:0xf bank_mask:0xf
  v_mul_f32_dpp v53, v24, v53 quad_perm:[1,1,1,1] row_mask:0xf bank_mask:0xf
  v_mul_f32_dpp v54, v24, v54 quad_perm:[2,2,2,2] row_mask:0xf bank_mask:0xf
  v_mul_f32_dpp v55, v24, v55 quad_perm:[3,3,3,3] row_mask:0xf bank_mask:0xf
  v_mul_f32_dpp v56, v24, v56 quad_perm:[0,0,0,0] row_mask:0xf bank_mask:0xf
  v_mul_f32_dpp v57, v24, v57 quad_perm:[1,1,1,1] row_mask:0xf bank_mask:0xf
  v_mul_f32_dpp v58, v24, v58 quad_perm:[2,2,2,2] row_mask:0xf bank_mask:0xf
  v_mul_f32_dpp v59, v24, v59 quad_perm:[3,3,3,3] row_mask:0xf bank_mask:0xf
  v_mul_f32_dpp v60, v24, v60 quad_perm:[0,0,0,0] row_mask:0xf bank_mask:0xf
  v_mul_f32_dpp v61, v24, v61 quad_perm:[1,1,1,1] row_mask:0xf bank_mask:0xf
  v_mul_f32_dpp v62, v24, v62 quad_perm:[2,2,2,2] row_mask:0xf bank_mask:0xf
  v_mul_f32_dpp v63, v24, v63 quad_perm:[3,3,3,3] row_mask:0xf bank_mask:0xf
  v_mul_f32_dpp v64, v24, v64 quad_perm:[0,0,0,0] row_mask:0xf bank_mask:0xf
  v_mul_f32_dpp v65, v24, v65 quad_perm:[1,1,1,1] row_mask:0xf bank_mask:0xf
  v_mul_f32_dpp v66, v24, v66 quad_perm:[2,2,2,2] row_mask:0xf bank_mask:0xf
  v_mul_f32_dpp v67, v24, v67 quad_perm:[3,3,3,3] row_mask:0xf bank_mask:0xf
  v_mul_f32_dpp v68, v24, v68 quad_perm:[0,0,0,0] row_mask:0xf bank_mask:0xf
  v_mul_f32_dpp v69, v24, v69 quad_perm:[1,1,1,1] row_mask:0xf bank_mask:0xf
  v_mul_f32_dpp v70, v24, v70 quad_perm:[2,2,2,2] row_mask:0xf bank_mask:0xf
  v_mul_f32_dpp v71, v24, v71 quad_perm:[3,3,3,3] row_mask:0xf bank_mask:0xf
  v_mul_f32_dpp v72, v24, v72 quad_perm:[0,0,0,0] row_mask:0xf bank_mask:0xf
  v_mul_f32_dpp v73, v24, v73 quad_perm:[1,1,1,1] row_mask:0xf bank_mask:0xf
  v_mul_f32_dpp v74, v24, v74 quad_perm:[2,2,2,2] row_mask:0xf bank_mask:0xf
  v_mul_f32_dpp v75, v24, v75 quad_perm:[3,3,3,3] row_mask:0xf bank_mask:0xf
  v_mul_f32_dpp v76, v24, v76 quad_perm:[0,0,0,0] row_mask:0xf bank_mask:0xf
  v_mul_f32_dpp v77, v24, v77 quad_perm:[1,1,1,1] row_mask:0xf bank_mask:0xf
  v_mul_f32_dpp v78, v24, v78 quad_perm:[2,2,2,2] row_mask:0xf bank_mask:0xf
  v_mul_f32_dpp v79, v24, v79 quad_perm:[3,3,3,3] row_mask:0xf bank_mask:0xf
  v_mfma_f32_16x16x32_bf16 v[48:51], v[120:123], a[96:99], v[48:51]
  v_mfma_f32_16x16x32_bf16 v[52:55], v[120:123], a[100:103], v[52:55]
  v_mfma_f32_16x16x32_bf16 v[56:59], v[120:123], a[104:107], v[56:59]
  v_mfma_f32_16x16x32_bf16 v[60:63], v[120:123], a[108:111], v[60:63]
  v_mfma_f32_16x16x32_bf16 v[64:67], v[120:123], a[112:115], v[64:67]
  v_mfma_f32_16x16x32_bf16 v[68:71], v[120:123], a[116:119], v[68:71]
  v_mfma_f32_16x16x32_bf16 v[72:75], v[120:123], a[120:123], v[72:75]
  v_mfma_f32_16x16x32_bf16 v[76:79], v[120:123], a[124:127], v[76:79]
  s_waitcnt vmcnt(24)
  ds_read_b128 v[80:83], v10 offset:0
  ds_read_b128 v[84:87], v11 offset:0
  ds_read_b128 v[88:91], v12 offset:0
  ds_read_b128 v[92:95], v13 offset:0
  ds_read_b128 v[96:99], v10 offset:4096
  ds_read_b128 v[100:103], v11 offset:4096
  ds_read_b128 v[104:107], v12 offset:4096
  ds_read_b128 v[108:111], v13 offset:4096
  s_waitcnt lgkmcnt(0)
  s_lshl_b32 s31, s29, 6
  s_add_u32 s31, s31, 56
  s_lshl_b32 s31, s31, 13
  s_add_u32 s31, s31, s68
  s_add_u32 s32, s6, s31
  s_addc_u32 s33, s7, 0
  s_add_u32 s34, s32, 16384
  s_addc_u32 s35, s33, 0
  s_add_u32 s36, s8, s31
  s_addc_u32 s37, s9, 0
  s_add_u32 s38, s36, 16384
  s_addc_u32 s39, s37, 0
  v_mfma_f32_16x16x32_bf16 v[112:115], v[80:83], v[32:35], 0
  v_mfma_f32_16x16x32_bf16 v[112:115], v[84:87], v[36:39], v[112:115]
  v_mfma_f32_16x16x32_bf16 v[112:115], v[88:91], v[40:43], v[112:115]
  v_mfma_f32_16x16x32_bf16 v[112:115], v[92:95], v[44:47], v[112:115]
  v_mfma_f32_16x16x32_bf16 v[116:119], v[96:99], v[32:35], 0
  v_mfma_f32_16x16x32_bf16 v[116:119], v[100:103], v[36:39], v[116:119]
  v_mfma_f32_16x16x32_bf16 v[116:119], v[104:107], v[40:43], v[116:119]
  v_mfma_f32_16x16x32_bf16 v[116:119], v[108:111], v[44:47], v[116:119]
  s_add_u32 m0, s47, 0
  s_nop 0
  global_load_lds_dwordx4 v4, s[32:33] offset:0
  global_load_lds_dwordx4 v5, s[32:33] offset:1024
  global_load_lds_dwordx4 v6, s[32:33] offset:2048
  global_load_lds_dwordx4 v7, s[32:33] offset:3072
  s_add_u32 m0, s47, 4096
  s_nop 0
  global_load_lds_dwordx4 v4, s[34:35] offset:0
  global_load_lds_dwordx4 v5, s[34:35] offset:1024
  global_load_lds_dwordx4 v6, s[34:35] offset:2048
  global_load_lds_dwordx4 v7, s[34:35] offset:3072
  s_waitcnt vmcnt(24)
  ds_read_b64_tr_b16 v[80:81], v14 offset:8192
  ds_read_b64_tr_b16 v[84:85], v15 offset:8192
  ds_read_b64_tr_b16 v[88:89], v16 offset:8192
  ds_read_b64_tr_b16 v[92:93], v17 offset:8192
  ds_read_b64_tr_b16 v[96:97], v18 offset:8192
  ds_read_b64_tr_b16 v[100:101], v19 offset:8192
  ds_read_b64_tr_b16 v[104:105], v20 offset:8192
  ds_read_b64_tr_b16 v[108:109], v21 offset:8192
  ds_read_b64_tr_b16 v[82:83], v14 offset:12288
  ds_read_b64_tr_b16 v[86:87], v15 offset:12288
  ds_read_b64_tr_b16 v[90:91], v16 offset:12288
  ds_read_b64_tr_b16 v[94:95], v17 offset:12288
  ds_read_b64_tr_b16 v[98:99], v18 offset:12288
  ds_read_b64_tr_b16 v[102:103], v19 offset:12288
  ds_read_b64_tr_b16 v[106:107], v20 offset:12288
  ds_read_b64_tr_b16 v[110:111], v21 offset:12288
  v_cvt_pk_bf16_f32 v120, v112, v113
  v_cvt_pk_bf16_f32 v121, v114, v115
  v_cvt_pk_bf16_f32 v122, v116, v117
  v_cvt_pk_bf16_f32 v123, v118, v119
  v_lshlrev_b32 v112, 16, v120
  v_and_b32 v113, 0xffff0000, v120
  v_lshlrev_b32 v114, 16, v121
  v_and_b32 v115, 0xffff0000, v121
  v_lshlrev_b32 v116, 16, v122
  v_and_b32 v117, 0xffff0000, v122
  v_lshlrev_b32 v118, 16, v123
  v_and_b32 v119, 0xffff0000, v123
  v_mul_f32 v112, s58, v112
  v_mul_f32 v113, s58, v113
  v_mul_f32 v114, s58, v114
  v_mul_f32 v115, s58, v115
  v_mul_f32 v116, s58, v116
  v_mul_f32 v117, s58, v117
  v_mul_f32 v118, s58, v118
  v_mul_f32 v119, s58, v119
  v_cvt_pk_bf16_f32 v120, v112, v113
  v_cvt_pk_bf16_f32 v121, v114, v115
  v_cvt_pk_bf16_f32 v122, v116, v117
  v_cvt_pk_bf16_f32 v123, v118, v119
  v_lshlrev_b32 v112, 16, v120
  v_and_b32 v113, 0xffff0000, v120
  v_lshlrev_b32 v114, 16, v121
  v_and_b32 v115, 0xffff0000, v121
  v_lshlrev_b32 v116, 16, v122
  v_and_b32 v117, 0xffff0000, v122
  v_lshlrev_b32 v118, 16, v123
  v_and_b32 v119, 0xffff0000, v123
  v_max3_f32 v124, v112, v113, v114
  v_max3_f32 v125, v115, v116, v117
  v_max3_f32 v124, v124, v118, v119
  v_max_f32 v124, v124, v125
  v_mov_b32 v125, v124
  s_nop 1
  v_permlane16_swap_b32 v124, v125
  v_max_f32 v124, v124, v125
  v_mov_b32 v125, v124
  s_nop 1
  v_permlane32_swap_b32 v124, v125
  v_max_f32 v124, v124, v125
  v_mul_f32 v124, s62, v124
  v_max_f32 v124, v124, v22
  v_sub_f32 v24, v22, v124
  v_exp_f32 v24, v24
  v_mov_b32 v22, v124
  v_fma_f32 v112, v112, s62, -v22
  v_fma_f32 v113, v113, s62, -v22
  v_fma_f32 v114, v114, s62, -v22
  v_fma_f32 v115, v115, s62, -v22
  v_fma_f32 v116, v116, s62, -v22
  v_fma_f32 v117, v117, s62, -v22
  v_fma_f32 v118, v118, s62, -v22
  v_fma_f32 v119, v119, s62, -v22
  v_exp_f32 v112, v112
  v_exp_f32 v113, v113
  v_exp_f32 v114, v114
  v_exp_f32 v115, v115
  v_exp_f32 v116, v116
  v_exp_f32 v117, v117
  v_exp_f32 v118, v118
  v_exp_f32 v119, v119
  v_mul_f32 v23, v23, v24
  v_cvt_pk_bf16_f32 v120, v112, v113
  v_cvt_pk_bf16_f32 v121, v114, v115
  v_cvt_pk_bf16_f32 v122, v116, v117
  v_cvt_pk_bf16_f32 v123, v118, v119
  v_add_f32 v124, v112, v113
  v_add_f32 v125, v114, v115
  v_add_f32 v124, v124, v116
  v_add_f32 v125, v125, v117
  v_add_f32 v124, v124, v118
  v_add_f32 v125, v125, v119
  v_add_f32 v124, v124, v125
  v_add_f32 v23, v23, v124
  v_mul_f32_dpp v48, v24, v48 quad_perm:[0,0,0,0] row_mask:0xf bank_mask:0xf
  v_mul_f32_dpp v49, v24, v49 quad_perm:[1,1,1,1] row_mask:0xf bank_mask:0xf
  v_mul_f32_dpp v50, v24, v50 quad_perm:[2,2,2,2] row_mask:0xf bank_mask:0xf
  v_mul_f32_dpp v51, v24, v51 quad_perm:[3,3,3,3] row_mask:0xf bank_mask:0xf
  v_mul_f32_dpp v52, v24, v52 quad_perm:[0,0,0,0] row_mask:0xf bank_mask:0xf
  v_mul_f32_dpp v53, v24, v53 quad_perm:[1,1,1,1] row_mask:0xf bank_mask:0xf
  v_mul_f32_dpp v54, v24, v54 quad_perm:[2,2,2,2] row_mask:0xf bank_mask:0xf
  v_mul_f32_dpp v55, v24, v55 quad_perm:[3,3,3,3] row_mask:0xf bank_mask:0xf
  v_mul_f32_dpp v56, v24, v56 quad_perm:[0,0,0,0] row_mask:0xf bank_mask:0xf
  v_mul_f32_dpp v57, v24, v57 quad_perm:[1,1,1,1] row_mask:0xf bank_mask:0xf
  v_mul_f32_dpp v58, v24, v58 quad_perm:[2,2,2,2] row_mask:0xf bank_mask:0xf
  v_mul_f32_dpp v59, v24, v59 quad_perm:[3,3,3,3] row_mask:0xf bank_mask:0xf
  v_mul_f32_dpp v60, v24, v60 quad_perm:[0,0,0,0] row_mask:0xf bank_mask:0xf
  v_mul_f32_dpp v61, v24, v61 quad_perm:[1,1,1,1] row_mask:0xf bank_mask:0xf
  v_mul_f32_dpp v62, v24, v62 quad_perm:[2,2,2,2] row_mask:0xf bank_mask:0xf
  v_mul_f32_dpp v63, v24, v63 quad_perm:[3,3,3,3] row_mask:0xf bank_mask:0xf
  v_mul_f32_dpp v64, v24, v64 quad_perm:[0,0,0,0] row_mask:0xf bank_mask:0xf
  v_mul_f32_dpp v65, v24, v65 quad_perm:[1,1,1,1] row_mask:0xf bank_mask:0xf
  v_mul_f32_dpp v66, v24, v66 quad_perm:[2,2,2,2] row_mask:0xf bank_mask:0xf
  v_mul_f32_dpp v67, v24, v67 quad_perm:[3,3,3,3] row_mask:0xf bank_mask:0xf
  v_mul_f32_dpp v68, v24, v68 quad_perm:[0,0,0,0] row_mask:0xf bank_mask:0xf
  v_mul_f32_dpp v69, v24, v69 quad_perm:[1,1,1,1] row_mask:0xf bank_mask:0xf
  v_mul_f32_dpp v70, v24, v70 quad_perm:[2,2,2,2] row_mask:0xf bank_mask:0xf
  v_mul_f32_dpp v71, v24, v71 quad_perm:[3,3,3,3] row_mask:0xf bank_mask:0xf
  v_mul_f32_dpp v72, v24, v72 quad_perm:[0,0,0,0] row_mask:0xf bank_mask:0xf
  v_mul_f32_dpp v73, v24, v73 quad_perm:[1,1,1,1] row_mask:0xf bank_mask:0xf
  v_mul_f32_dpp v74, v24, v74 quad_perm:[2,2,2,2] row_mask:0xf bank_mask:0xf
  v_mul_f32_dpp v75, v24, v75 quad_perm:[3,3,3,3] row_mask:0xf bank_mask:0xf
  v_mul_f32_dpp v76, v24, v76 quad_perm:[0,0,0,0] row_mask:0xf bank_mask:0xf
  v_mul_f32_dpp v77, v24, v77 quad_perm:[1,1,1,1] row_mask:0xf bank_mask:0xf
  v_mul_f32_dpp v78, v24, v78 quad_perm:[2,2,2,2] row_mask:0xf bank_mask:0xf
  v_mul_f32_dpp v79, v24, v79 quad_perm:[3,3,3,3] row_mask:0xf bank_mask:0xf
  s_waitcnt lgkmcnt(0)
  s_mov_b32 s46, 1
  s_atomic_add s46, s[92:93], 0 glc
  v_mfma_f32_16x16x32_bf16 v[48:51], v[120:123], v[80:83], v[48:51]
  v_mfma_f32_16x16x32_bf16 v[52:55], v[120:123], v[84:87], v[52:55]
  v_mfma_f32_16x16x32_bf16 v[56:59], v[120:123], v[88:91], v[56:59]
  v_mfma_f32_16x16x32_bf16 v[60:63], v[120:123], v[92:95], v[60:63]
  v_mfma_f32_16x16x32_bf16 v[64:67], v[120:123], v[96:99], v[64:67]
  v_mfma_f32_16x16x32_bf16 v[68:71], v[120:123], v[100:103], v[68:71]
  v_mfma_f32_16x16x32_bf16 v[72:75], v[120:123], v[104:107], v[72:75]
  v_mfma_f32_16x16x32_bf16 v[76:79], v[120:123], v[108:111], v[76:79]
  s_add_u32 m0, s47, 8192
  s_nop 0
  global_load_lds_dwordx4 v8, s[36:37] offset:0
  global_load_lds_dwordx4 v9, s[36:37] offset:1024
  global_load_lds_dwordx4 v8, s[36:37] offset:2048
  global_load_lds_dwordx4 v9, s[36:37] offset:3072
  s_add_u32 m0, s47, 12288
  s_nop 0
  global_load_lds_dwordx4 v8, s[38:39] offset:0
  global_load_lds_dwordx4 v9, s[38:39] offset:1024
  global_load_lds_dwordx4 v8, s[38:39] offset:2048
  global_load_lds_dwordx4 v9, s[38:39] offset:3072
  v_mfma_f32_16x16x32_bf16 v[112:115], a[128:131], v[32:35], 0
  v_mfma_f32_16x16x32_bf16 v[112:115], a[132:135], v[36:39], v[112:115]
  v_mfma_f32_16x16x32_bf16 v[112:115], a[136:139], v[40:43], v[112:115]
  v_mfma_f32_16x16x32_bf16 v[112:115], a[140:143], v[44:47], v[112:115]
  v_mfma_f32_16x16x32_bf16 v[116:119], a[144:147], v[32:35], 0
  v_mfma_f32_16x16x32_bf16 v[116:119], a[148:151], v[36:39], v[116:119]
  v_mfma_f32_16x16x32_bf16 v[116:119], a[152:155], v[40:43], v[116:119]
  v_mfma_f32_16x16x32_bf16 v[116:119], a[156:159], v[44:47], v[116:119]
  s_nop 3
  v_cvt_pk_bf16_f32 v120, v112, v113
  v_cvt_pk_bf16_f32 v121, v114, v115
  s_nop 1
  v_cvt_pk_bf16_f32 v122, v116, v117
  v_cvt_pk_bf16_f32 v123, v118, v119
  v_lshlrev_b32 v112, 16, v120
  v_and_b32 v113, 0xffff0000, v120
  v_lshlrev_b32 v114, 16, v121
  v_and_b32 v115, 0xffff0000, v121
  v_lshlrev_b32 v116, 16, v122
  v_and_b32 v117, 0xffff0000, v122
  v_lshlrev_b32 v118, 16, v123
  v_and_b32 v119, 0xffff0000, v123
  v_mul_f32 v112, s58, v112
  v_mul_f32 v113, s58, v113
  v_mul_f32 v114, s58, v114
  v_mul_f32 v115, s58, v115
  v_mul_f32 v116, s58, v116
  v_mul_f32 v117, s58, v117
  v_mul_f32 v118, s58, v118
  v_mul_f32 v119, s58, v119
  v_cvt_pk_bf16_f32 v120, v112, v113
  v_cvt_pk_bf16_f32 v121, v114, v115
  v_cvt_pk_bf16_f32 v122, v116, v117
  v_cvt_pk_bf16_f32 v123, v118, v119
  v_lshlrev_b32 v112, 16, v120
  v_and_b32 v113, 0xffff0000, v120
  v_lshlrev_b32 v114, 16, v121
  v_and_b32 v115, 0xffff0000, v121
  v_lshlrev_b32 v116, 16, v122
  v_and_b32 v117, 0xffff0000, v122
  v_lshlrev_b32 v118, 16, v123
  v_and_b32 v119, 0xffff0000, v123
  v_max3_f32 v124, v112, v113, v114
  v_max3_f32 v125, v115, v116, v117
  v_max3_f32 v124, v124, v118, v119
  v_max_f32 v124, v124, v125
  v_mov_b32 v125, v124
  s_nop 1
  v_permlane16_swap_b32 v124, v125
  v_max_f32 v124, v124, v125
  v_mov_b32 v125, v124
  s_nop 1
  v_permlane32_swap_b32 v124, v125
  v_max_f32 v124, v124, v125
  v_mul_f32 v124, s62, v124
  v_max_f32 v124, v124, v22
  v_sub_f32 v24, v22, v124
  v_exp_f32 v24, v24
  v_mov_b32 v22, v124
  v_fma_f32 v112, v112, s62, -v22
  v_fma_f32 v113, v113, s62, -v22
  v_fma_f32 v114, v114, s62, -v22
  v_fma_f32 v115, v115, s62, -v22
  v_fma_f32 v116, v116, s62, -v22
  v_fma_f32 v117, v117, s62, -v22
  v_fma_f32 v118, v118, s62, -v22
  v_fma_f32 v119, v119, s62, -v22
  v_exp_f32 v112, v112
  v_exp_f32 v113, v113
  v_exp_f32 v114, v114
  v_exp_f32 v115, v115
  v_exp_f32 v116, v116
  v_exp_f32 v117, v117
  v_exp_f32 v118, v118
  v_exp_f32 v119, v119
  v_mul_f32 v23, v23, v24
  v_cvt_pk_bf16_f32 v120, v112, v113
  v_cvt_pk_bf16_f32 v121, v114, v115
  v_cvt_pk_bf16_f32 v122, v116, v117
  v_cvt_pk_bf16_f32 v123, v118, v119
  v_add_f32 v124, v112, v113
  v_add_f32 v125, v114, v115
  v_add_f32 v124, v124, v116
  v_add_f32 v125, v125, v117
  v_add_f32 v124, v124, v118
  v_add_f32 v125, v125, v119
  v_add_f32 v124, v124, v125
  v_add_f32 v23, v23, v124
  v_mul_f32_dpp v48, v24, v48 quad_perm:[0,0,0,0] row_mask:0xf bank_mask:0xf
  v_mul_f32_dpp v49, v24, v49 quad_perm:[1,1,1,1] row_mask:0xf bank_mask:0xf
  v_mul_f32_dpp v50, v24, v50 quad_perm:[2,2,2,2] row_mask:0xf bank_mask:0xf
  v_mul_f32_dpp v51, v24, v51 quad_perm:[3,3,3,3] row_mask:0xf bank_mask:0xf
  v_mul_f32_dpp v52, v24, v52 quad_perm:[0,0,0,0] row_mask:0xf bank_mask:0xf
  v_mul_f32_dpp v53, v24, v53 quad_perm:[1,1,1,1] row_mask:0xf bank_mask:0xf
  v_mul_f32_dpp v54, v24, v54 quad_perm:[2,2,2,2] row_mask:0xf bank_mask:0xf
  v_mul_f32_dpp v55, v24, v55 quad_perm:[3,3,3,3] row_mask:0xf bank_mask:0xf
  v_mul_f32_dpp v56, v24, v56 quad_perm:[0,0,0,0] row_mask:0xf bank_mask:0xf
  v_mul_f32_dpp v57, v24, v57 quad_perm:[1,1,1,1] row_mask:0xf bank_mask:0xf
  v_mul_f32_dpp v58, v24, v58 quad_perm:[2,2,2,2] row_mask:0xf bank_mask:0xf
  v_mul_f32_dpp v59, v24, v59 quad_perm:[3,3,3,3] row_mask:0xf bank_mask:0xf
  v_mul_f32_dpp v60, v24, v60 quad_perm:[0,0,0,0] row_mask:0xf bank_mask:0xf
  v_mul_f32_dpp v61, v24, v61 quad_perm:[1,1,1,1] row_mask:0xf bank_mask:0xf
  v_mul_f32_dpp v62, v24, v62 quad_perm:[2,2,2,2] row_mask:0xf bank_mask:0xf
  v_mul_f32_dpp v63, v24, v63 quad_perm:[3,3,3,3] row_mask:0xf bank_mask:0xf
  v_mul_f32_dpp v64, v24, v64 quad_perm:[0,0,0,0] row_mask:0xf bank_mask:0xf
  v_mul_f32_dpp v65, v24, v65 quad_perm:[1,1,1,1] row_mask:0xf bank_mask:0xf
  v_mul_f32_dpp v66, v24, v66 quad_perm:[2,2,2,2] row_mask:0xf bank_mask:0xf
  v_mul_f32_dpp v67, v24, v67 quad_perm:[3,3,3,3] row_mask:0xf bank_mask:0xf
  v_mul_f32_dpp v68, v24, v68 quad_perm:[0,0,0,0] row_mask:0xf bank_mask:0xf
  v_mul_f32_dpp v69, v24, v69 quad_perm:[1,1,1,1] row_mask:0xf bank_mask:0xf
  v_mul_f32_dpp v70, v24, v70 quad_perm:[2,2,2,2] row_mask:0xf bank_mask:0xf
  v_mul_f32_dpp v71, v24, v71 quad_perm:[3,3,3,3] row_mask:0xf bank_mask:0xf
  v_mul_f32_dpp v72, v24, v72 quad_perm:[0,0,0,0] row_mask:0xf bank_mask:0xf
  v_mul_f32_dpp v73, v24, v73 quad_perm:[1,1,1,1] row_mask:0xf bank_mask:0xf
  v_mul_f32_dpp v74, v24, v74 quad_perm:[2,2,2,2] row_mask:0xf bank_mask:0xf
  v_mul_f32_dpp v75, v24, v75 quad_perm:[3,3,3,3] row_mask:0xf bank_mask:0xf
  v_mul_f32_dpp v76, v24, v76 quad_perm:[0,0,0,0] row_mask:0xf bank_mask:0xf
  v_mul_f32_dpp v77, v24, v77 quad_perm:[1,1,1,1] row_mask:0xf bank_mask:0xf
  v_mul_f32_dpp v78, v24, v78 quad_perm:[2,2,2,2] row_mask:0xf bank_mask:0xf
  v_mul_f32_dpp v79, v24, v79 quad_perm:[3,3,3,3] row_mask:0xf bank_mask:0xf
  v_mfma_f32_16x16x32_bf16 v[48:51], v[120:123], a[160:163], v[48:51]
  v_mfma_f32_16x16x32_bf16 v[52:55], v[120:123], a[164:167], v[52:55]
  v_mfma_f32_16x16x32_bf16 v[56:59], v[120:123], a[168:171], v[56:59]
  v_mfma_f32_16x16x32_bf16 v[60:63], v[120:123], a[172:175], v[60:63]
  v_mfma_f32_16x16x32_bf16 v[64:67], v[120:123], a[176:179], v[64:67]
  v_mfma_f32_16x16x32_bf16 v[68:71], v[120:123], a[180:183], v[68:71]
  v_mfma_f32_16x16x32_bf16 v[72:75], v[120:123], a[184:187], v[72:75]
  v_mfma_f32_16x16x32_bf16 v[76:79], v[120:123], a[188:191], v[76:79]
  v_mfma_f32_16x16x32_bf16 v[112:115], a[192:195], v[32:35], 0
  v_mfma_f32_16x16x32_bf16 v[112:115], a[196:199], v[36:39], v[112:115]
  v_mfma_f32_16x16x32_bf16 v[112:115], a[200:203], v[40:43], v[112:115]
  v_mfma_f32_16x16x32_bf16 v[112:115], a[204:207], v[44:47], v[112:115]
  v_mfma_f32_16x16x32_bf16 v[116:119], a[208:211], v[32:35], 0
  v_mfma_f32_16x16x32_bf16 v[116:119], a[212:215], v[36:39], v[116:119]
  v_mfma_f32_16x16x32_bf16 v[116:119], a[216:219], v[40:43], v[116:119]
  v_mfma_f32_16x16x32_bf16 v[116:119], a[220:223], v[44:47], v[116:119]
  s_nop 3
  v_cvt_pk_bf16_f32 v120, v112, v113
  v_cvt_pk_bf16_f32 v121, v114, v115
  s_nop 1
  v_cvt_pk_bf16_f32 v122, v116, v117
  v_cvt_pk_bf16_f32 v123, v118, v119
  v_lshlrev_b32 v112, 16, v120
  v_and_b32 v113, 0xffff0000, v120
  v_lshlrev_b32 v114, 16, v121
  v_and_b32 v115, 0xffff0000, v121
  v_lshlrev_b32 v116, 16, v122
  v_and_b32 v117, 0xffff0000, v122
  v_lshlrev_b32 v118, 16, v123
  v_and_b32 v119, 0xffff0000, v123
  v_mul_f32 v112, s58, v112
  v_mul_f32 v113, s58, v113
  v_mul_f32 v114, s58, v114
  v_mul_f32 v115, s58, v115
  v_mul_f32 v116, s58, v116
  v_mul_f32 v117, s58, v117
  v_mul_f32 v118, s58, v118
  v_mul_f32 v119, s58, v119
  v_cvt_pk_bf16_f32 v120, v112, v113
  v_cvt_pk_bf16_f32 v121, v114, v115
  v_cvt_pk_bf16_f32 v122, v116, v117
  v_cvt_pk_bf16_f32 v123, v118, v119
  v_lshlrev_b32 v112, 16, v120
  v_and_b32 v113, 0xffff0000, v120
  v_lshlrev_b32 v114, 16, v121
  v_and_b32 v115, 0xffff0000, v121
  v_lshlrev_b32 v116, 16, v122
  v_and_b32 v117, 0xffff0000, v122
  v_lshlrev_b32 v118, 16, v123
  v_and_b32 v119, 0xffff0000, v123
  v_max3_f32 v124, v112, v113, v114
  v_max3_f32 v125, v115, v116, v117
  v_max3_f32 v124, v124, v118, v119
  v_max_f32 v124, v124, v125
  v_mov_b32 v125, v124
  s_nop 1
  v_permlane16_swap_b32 v124, v125
  v_max_f32 v124, v124, v125
  v_mov_b32 v125, v124
  s_nop 1
  v_permlane32_swap_b32 v124, v125
  v_max_f32 v124, v124, v125
  v_mul_f32 v124, s62, v124
  v_max_f32 v124, v124, v22
  v_sub_f32 v24, v22, v124
  v_exp_f32 v24, v24
  v_mov_b32 v22, v124
  v_fma_f32 v112, v112, s62, -v22
  v_fma_f32 v113, v113, s62, -v22
  v_fma_f32 v114, v114, s62, -v22
  v_fma_f32 v115, v115, s62, -v22
  v_fma_f32 v116, v116, s62, -v22
  v_fma_f32 v117, v117, s62, -v22
  v_fma_f32 v118, v118, s62, -v22
  v_fma_f32 v119, v119, s62, -v22
  v_exp_f32 v112, v112
  v_exp_f32 v113, v113
  v_exp_f32 v114, v114
  v_exp_f32 v115, v115
  v_exp_f32 v116, v116
  v_exp_f32 v117, v117
  v_exp_f32 v118, v118
  v_exp_f32 v119, v119
  v_mul_f32 v23, v23, v24
  v_cvt_pk_bf16_f32 v120, v112, v113
  v_cvt_pk_bf16_f32 v121, v114, v115
  v_cvt_pk_bf16_f32 v122, v116, v117
  v_cvt_pk_bf16_f32 v123, v118, v119
  v_add_f32 v124, v112, v113
  v_add_f32 v125, v114, v115
  v_add_f32 v124, v124, v116
  v_add_f32 v125, v125, v117
  v_add_f32 v124, v124, v118
  v_add_f32 v125, v125, v119
  v_add_f32 v124, v124, v125
  v_add_f32 v23, v23, v124
  v_mul_f32_dpp v48, v24, v48 quad_perm:[0,0,0,0] row_mask:0xf bank_mask:0xf
  v_mul_f32_dpp v49, v24, v49 quad_perm:[1,1,1,1] row_mask:0xf bank_mask:0xf
  v_mul_f32_dpp v50, v24, v50 quad_perm:[2,2,2,2] row_mask:0xf bank_mask:0xf
  v_mul_f32_dpp v51, v24, v51 quad_perm:[3,3,3,3] row_mask:0xf bank_mask:0xf
  v_mul_f32_dpp v52, v24, v52 quad_perm:[0,0,0,0] row_mask:0xf bank_mask:0xf
  v_mul_f32_dpp v53, v24, v53 quad_perm:[1,1,1,1] row_mask:0xf bank_mask:0xf
  v_mul_f32_dpp v54, v24, v54 quad_perm:[2,2,2,2] row_mask:0xf bank_mask:0xf
  v_mul_f32_dpp v55, v24, v55 quad_perm:[3,3,3,3] row_mask:0xf bank_mask:0xf
  v_mul_f32_dpp v56, v24, v56 quad_perm:[0,0,0,0] row_mask:0xf bank_mask:0xf
  v_mul_f32_dpp v57, v24, v57 quad_perm:[1,1,1,1] row_mask:0xf bank_mask:0xf
  v_mul_f32_dpp v58, v24, v58 quad_perm:[2,2,2,2] row_mask:0xf bank_mask:0xf
  v_mul_f32_dpp v59, v24, v59 quad_perm:[3,3,3,3] row_mask:0xf bank_mask:0xf
  v_mul_f32_dpp v60, v24, v60 quad_perm:[0,0,0,0] row_mask:0xf bank_mask:0xf
  v_mul_f32_dpp v61, v24, v61 quad_perm:[1,1,1,1] row_mask:0xf bank_mask:0xf
  v_mul_f32_dpp v62, v24, v62 quad_perm:[2,2,2,2] row_mask:0xf bank_mask:0xf
  v_mul_f32_dpp v63, v24, v63 quad_perm:[3,3,3,3] row_mask:0xf bank_mask:0xf
  v_mul_f32_dpp v64, v24, v64 quad_perm:[0,0,0,0] row_mask:0xf bank_mask:0xf
  v_mul_f32_dpp v65, v24, v65 quad_perm:[1,1,1,1] row_mask:0xf bank_mask:0xf
  v_mul_f32_dpp v66, v24, v66 quad_perm:[2,2,2,2] row_mask:0xf bank_mask:0xf
  v_mul_f32_dpp v67, v24, v67 quad_perm:[3,3,3,3] row_mask:0xf bank_mask:0xf
  v_mul_f32_dpp v68, v24, v68 quad_perm:[0,0,0,0] row_mask:0xf bank_mask:0xf
  v_mul_f32_dpp v69, v24, v69 quad_perm:[1,1,1,1] row_mask:0xf bank_mask:0xf
  v_mul_f32_dpp v70, v24, v70 quad_perm:[2,2,2,2] row_mask:0xf bank_mask:0xf
  v_mul_f32_dpp v71, v24, v71 quad_perm:[3,3,3,3] row_mask:0xf bank_mask:0xf
  v_mul_f32_dpp v72, v24, v72 quad_perm:[0,0,0,0] row_mask:0xf bank_mask:0xf
  v_mul_f32_dpp v73, v24, v73 quad_perm:[1,1,1,1] row_mask:0xf bank_mask:0xf
  v_mul_f32_dpp v74, v24, v74 quad_perm:[2,2,2,2] row_mask:0xf bank_mask:0xf
  v_mul_f32_dpp v75, v24, v75 quad_perm:[3,3,3,3] row_mask:0xf bank_mask:0xf
  v_mul_f32_dpp v76, v24, v76 quad_perm:[0,0,0,0] row_mask:0xf bank_mask:0xf
  v_mul_f32_dpp v77, v24, v77 quad_perm:[1,1,1,1] row_mask:0xf bank_mask:0xf
  v_mul_f32_dpp v78, v24, v78 quad_perm:[2,2,2,2] row_mask:0xf bank_mask:0xf
  v_mul_f32_dpp v79, v24, v79 quad_perm:[3,3,3,3] row_mask:0xf bank_mask:0xf
  v_mfma_f32_16x16x32_bf16 v[48:51], v[120:123], a[224:227], v[48:51]
  v_mfma_f32_16x16x32_bf16 v[52:55], v[120:123], a[228:231], v[52:55]
  v_mfma_f32_16x16x32_bf16 v[56:59], v[120:123], a[232:235], v[56:59]
  v_mfma_f32_16x16x32_bf16 v[60:63], v[120:123], a[236:239], v[60:63]
  v_mfma_f32_16x16x32_bf16 v[64:67], v[120:123], a[240:243], v[64:67]
  v_mfma_f32_16x16x32_bf16 v[68:71], v[120:123], a[244:247], v[68:71]
  v_mfma_f32_16x16x32_bf16 v[72:75], v[120:123], a[248:251], v[72:75]
  v_mfma_f32_16x16x32_bf16 v[76:79], v[120:123], a[252:255], v[76:79]
  s_nop 7
L_dtop_8:
  s_waitcnt vmcnt(24)
  ds_read_b128 v[80:83], v10 offset:16384
  ds_read_b128 v[84:87], v11 offset:16384
  ds_read_b128 v[88:91], v12 offset:16384
  ds_read_b128 v[92:95], v13 offset:16384
  ds_read_b128 v[96:99], v10 offset:20480
  ds_read_b128 v[100:103], v11 offset:20480
  ds_read_b128 v[104:107], v12 offset:20480
  ds_read_b128 v[108:111], v13 offset:20480
  s_waitcnt lgkmcnt(0)
  s_cmp_ge_u32 s46, 8
  s_cbranch_scc1 L_dt0_9
  v_mov_b32 v124, s46
  s_nop 0
  v_readfirstlane_b32 s46, v124
  s_and_b32 s31, s29, 24
  s_and_b32 s66, s46, 7
  s_add_u32 s31, s31, s66
  s_lshl_b32 s31, s31, 6
  s_lshr_b32 s66, s46, 3
  s_lshl_b32 s66, s66, 2
  s_sub_u32 s31, s31, s66
  s_add_u32 s31, s31, 60
  s_lshl_b32 s31, s31, 13
  s_add_u32 s31, s31, s68
  s_add_u32 s32, s6, s31
  s_addc_u32 s33, s7, 0
  s_add_u32 s34, s32, 16384
  s_addc_u32 s35, s33, 0
  s_add_u32 s36, s8, s31
  s_addc_u32 s37, s9, 0
  s_add_u32 s38, s36, 16384
  s_addc_u32 s39, s37, 0
  v_mfma_f32_16x16x32_bf16 v[112:115], v[80:83], v[32:35], 0
  v_mfma_f32_16x16x32_bf16 v[112:115], v[84:87], v[36:39], v[112:115]
  v_mfma_f32_16x16x32_bf16 v[112:115], v[88:91], v[40:43], v[112:115]
  v_mfma_f32_16x16x32_bf16 v[112:115], v[92:95], v[44:47], v[112:115]
  v_mfma_f32_16x16x32_bf16 v[116:119], v[96:99], v[32:35], 0
  v_mfma_f32_16x16x32_bf16 v[116:119], v[100:103], v[36:39], v[116:119]
  v_mfma_f32_16x16x32_bf16 v[116:119], v[104:107], v[40:43], v[116:119]
  v_mfma_f32_16x16x32_bf16 v[116:119], v[108:111], v[44:47], v[116:119]
  s_add_u32 m0, s47, 16384
  s_nop 0
  global_load_lds_dwordx4 v4, s[32:33] offset:0 nt
  global_load_lds_dwordx4 v5, s[32:33] offset:1024 nt
  global_load_lds_dwordx4 v6, s[32:33] offset:2048 nt
  global_load_lds_dwordx4 v7, s[32:33] offset:3072 nt
  s_add_u32 m0, s47, 20480
  s_nop 0
  global_load_lds_dwordx4 v4, s[34:35] offset:0 nt
  global_load_lds_dwordx4 v5, s[34:35] offset:1024 nt
  global_load_lds_dwordx4 v6, s[34:35] offset:2048 nt
  global_load_lds_dwordx4 v7, s[34:35] offset:3072 nt
  s_waitcnt vmcnt(24)
  ds_read_b64_tr_b16 v[80:81], v14 offset:24576
  ds_read_b64_tr_b16 v[84:85], v15 offset:24576
  ds_read_b64_tr_b16 v[88:89], v16 offset:24576
  ds_read_b64_tr_b16 v[92:93], v17 offset:24576
  ds_read_b64_tr_b16 v[96:97], v18 offset:24576
  ds_read_b64_tr_b16 v[100:101], v19 offset:24576
  ds_read_b64_tr_b16 v[104:105], v20 offset:24576
  ds_read_b64_tr_b16 v[108:109], v21 offset:24576
  ds_read_b64_tr_b16 v[82:83], v14 offset:28672
  ds_read_b64_tr_b16 v[86:87], v15 offset:28672
  ds_read_b64_tr_b16 v[90:91], v16 offset:28672
  ds_read_b64_tr_b16 v[94:95], v17 offset:28672
  ds_read_b64_tr_b16 v[98:99], v18 offset:28672
  ds_read_b64_tr_b16 v[102:103], v19 offset:28672
  ds_read_b64_tr_b16 v[106:107], v20 offset:28672
  ds_read_b64_tr_b16 v[110:111], v21 offset:28672
  v_cvt_pk_bf16_f32 v120, v112, v113
  v_cvt_pk_bf16_f32 v121, v114, v115
  v_cvt_pk_bf16_f32 v122, v116, v117
  v_cvt_pk_bf16_f32 v123, v118, v119
  v_lshlrev_b32 v112, 16, v120
  v_and_b32 v113, 0xffff0000, v120
  v_lshlrev_b32 v114, 16, v121
  v_and_b32 v115, 0xffff0000, v121
  v_lshlrev_b32 v116, 16, v122
  v_and_b32 v117, 0xffff0000, v122
  v_lshlrev_b32 v118, 16, v123
  v_and_b32 v119, 0xffff0000, v123
  v_mul_f32 v112, s58, v112
  v_mul_f32 v113, s58, v113
  v_mul_f32 v114, s58, v114
  v_mul_f32 v115, s58, v115
  v_mul_f32 v116, s58, v116
  v_mul_f32 v117, s58, v117
  v_mul_f32 v118, s58, v118
  v_mul_f32 v119, s58, v119
  v_cvt_pk_bf16_f32 v120, v112, v113
  v_cvt_pk_bf16_f32 v121, v114, v115
  v_cvt_pk_bf16_f32 v122, v116, v117
  v_cvt_pk_bf16_f32 v123, v118, v119
  v_lshlrev_b32 v112, 16, v120
  v_and_b32 v113, 0xffff0000, v120
  v_lshlrev_b32 v114, 16, v121
  v_and_b32 v115, 0xffff0000, v121
  v_lshlrev_b32 v116, 16, v122
  v_and_b32 v117, 0xffff0000, v122
  v_lshlrev_b32 v118, 16, v123
  v_and_b32 v119, 0xffff0000, v123
  v_max3_f32 v124, v112, v113, v114
  v_max3_f32 v125, v115, v116, v117
  v_max3_f32 v124, v124, v118, v119
  v_max_f32 v124, v124, v125
  v_mov_b32 v125, v124
  s_nop 1
  v_permlane16_swap_b32 v124, v125
  v_max_f32 v124, v124, v125
  v_mov_b32 v125, v124
  s_nop 1
  v_permlane32_swap_b32 v124, v125
  v_max_f32 v124, v124, v125
  v_mul_f32 v124, s62, v124
  v_max_f32 v124, v124, v22
  v_sub_f32 v24, v22, v124
  v_exp_f32 v24, v24
  v_mov_b32 v22, v124
  v_fma_f32 v112, v112, s62, -v22
  v_fma_f32 v113, v113, s62, -v22
  v_fma_f32 v114, v114, s62, -v22
  v_fma_f32 v115, v115, s62, -v22
  v_fma_f32 v116, v116, s62, -v22
  v_fma_f32 v117, v117, s62, -v22
  v_fma_f32 v118, v118, s62, -v22
  v_fma_f32 v119, v119, s62, -v22
  v_exp_f32 v112, v112
  v_exp_f32 v113, v113
  v_exp_f32 v114, v114
  v_exp_f32 v115, v115
  v_exp_f32 v116, v116
  v_exp_f32 v117, v117
  v_exp_f32 v118, v118
  v_exp_f32 v119, v119
  v_mul_f32 v23, v23, v24
  v_cvt_pk_bf16_f32 v120, v112, v113
  v_cvt_pk_bf16_f32 v121, v114, v115
  v_cvt_pk_bf16_f32 v122, v116, v117
  v_cvt_pk_bf16_f32 v123, v118, v119
  v_add_f32 v124, v112, v113
  v_add_f32 v125, v114, v115
  v_add_f32 v124, v124, v116
  v_add_f32 v125, v125, v117
  v_add_f32 v124, v124, v118
  v_add_f32 v125, v125, v119
  v_add_f32 v124, v124, v125
  v_add_f32 v23, v23, v124
  v_mul_f32_dpp v48, v24, v48 quad_perm:[0,0,0,0] row_mask:0xf bank_mask:0xf
  v_mul_f32_dpp v49, v24, v49 quad_perm:[1,1,1,1] row_mask:0xf bank_mask:0xf
  v_mul_f32_dpp v50, v24, v50 quad_perm:[2,2,2,2] row_mask:0xf bank_mask:0xf
  v_mul_f32_dpp v51, v24, v51 quad_perm:[3,3,3,3] row_mask:0xf bank_mask:0xf
  v_mul_f32_dpp v52, v24, v52 quad_perm:[0,0,0,0] row_mask:0xf bank_mask:0xf
  v_mul_f32_dpp v53, v24, v53 quad_perm:[1,1,1,1] row_mask:0xf bank_mask:0xf
  v_mul_f32_dpp v54, v24, v54 quad_perm:[2,2,2,2] row_mask:0xf bank_mask:0xf
  v_mul_f32_dpp v55, v24, v55 quad_perm:[3,3,3,3] row_mask:0xf bank_mask:0xf
  v_mul_f32_dpp v56, v24, v56 quad_perm:[0,0,0,0] row_mask:0xf bank_mask:0xf
  v_mul_f32_dpp v57, v24, v57 quad_perm:[1,1,1,1] row_mask:0xf bank_mask:0xf
  v_mul_f32_dpp v58, v24, v58 quad_perm:[2,2,2,2] row_mask:0xf bank_mask:0xf
  v_mul_f32_dpp v59, v24, v59 quad_perm:[3,3,3,3] row_mask:0xf bank_mask:0xf
  v_mul_f32_dpp v60, v24, v60 quad_perm:[0,0,0,0] row_mask:0xf bank_mask:0xf
  v_mul_f32_dpp v61, v24, v61 quad_perm:[1,1,1,1] row_mask:0xf bank_mask:0xf
  v_mul_f32_dpp v62, v24, v62 quad_perm:[2,2,2,2] row_mask:0xf bank_mask:0xf
  v_mul_f32_dpp v63, v24, v63 quad_perm:[3,3,3,3] row_mask:0xf bank_mask:0xf
  v_mul_f32_dpp v64, v24, v64 quad_perm:[0,0,0,0] row_mask:0xf bank_mask:0xf
  v_mul_f32_dpp v65, v24, v65 quad_perm:[1,1,1,1] row_mask:0xf bank_mask:0xf
  v_mul_f32_dpp v66, v24, v66 quad_perm:[2,2,2,2] row_mask:0xf bank_mask:0xf
  v_mul_f32_dpp v67, v24, v67 quad_perm:[3,3,3,3] row_mask:0xf bank_mask:0xf
  v_mul_f32_dpp v68, v24, v68 quad_perm:[0,0,0,0] row_mask:0xf bank_mask:0xf
  v_mul_f32_dpp v69, v24, v69 quad_perm:[1,1,1,1] row_mask:0xf bank_mask:0xf
  v_mul_f32_dpp v70, v24, v70 quad_perm:[2,2,2,2] row_mask:0xf bank_mask:0xf
  v_mul_f32_dpp v71, v24, v71 quad_perm:[3,3,3,3] row_mask:0xf bank_mask:0xf
  v_mul_f32_dpp v72, v24, v72 quad_perm:[0,0,0,0] row_mask:0xf bank_mask:0xf
  v_mul_f32_dpp v73, v24, v73 quad_perm:[1,1,1,1] row_mask:0xf bank_mask:0xf
  v_mul_f32_dpp v74, v24, v74 quad_perm:[2,2,2,2] row_mask:0xf bank_mask:0xf
  v_mul_f32_dpp v75, v24, v75 quad_perm:[3,3,3,3] row_mask:0xf bank_mask:0xf
  v_mul_f32_dpp v76, v24, v76 quad_perm:[0,0,0,0] row_mask:0xf bank_mask:0xf
  v_mul_f32_dpp v77, v24, v77 quad_perm:[1,1,1,1] row_mask:0xf bank_mask:0xf
  v_mul_f32_dpp v78, v24, v78 quad_perm:[2,2,2,2] row_mask:0xf bank_mask:0xf
  v_mul_f32_dpp v79, v24, v79 quad_perm:[3,3,3,3] row_mask:0xf bank_mask:0xf
  s_waitcnt lgkmcnt(0)
  s_mov_b32 s46, 1
  s_atomic_add s46, s[92:93], 0 glc
  v_mfma_f32_16x16x32_bf16 v[48:51], v[120:123], v[80:83], v[48:51]
  v_mfma_f32_16x16x32_bf16 v[52:55], v[120:123], v[84:87], v[52:55]
  v_mfma_f32_16x16x32_bf16 v[56:59], v[120:123], v[88:91], v[56:59]
  v_mfma_f32_16x16x32_bf16 v[60:63], v[120:123], v[92:95], v[60:63]
  v_mfma_f32_16x16x32_bf16 v[64:67], v[120:123], v[96:99], v[64:67]
  v_mfma_f32_16x16x32_bf16 v[68:71], v[120:123], v[100:103], v[68:71]
  v_mfma_f32_16x16x32_bf16 v[72:75], v[120:123], v[104:107], v[72:75]
  v_mfma_f32_16x16x32_bf16 v[76:79], v[120:123], v[108:111], v[76:79]
  s_add_u32 m0, s47, 24576
  s_nop 0
  global_load_lds_dwordx4 v8, s[36:37] offset:0 nt
  global_load_lds_dwordx4 v9, s[36:37] offset:1024 nt
  global_load_lds_dwordx4 v8, s[36:37] offset:2048 nt
  global_load_lds_dwordx4 v9, s[36:37] offset:3072 nt
  s_add_u32 m0, s47, 28672
  s_nop 0
  global_load_lds_dwordx4 v8, s[38:39] offset:0 nt
  global_load_lds_dwordx4 v9, s[38:39] offset:1024 nt
  global_load_lds_dwordx4 v8, s[38:39] offset:2048 nt
  global_load_lds_dwordx4 v9, s[38:39] offset:3072 nt
  s_waitcnt vmcnt(24)
  ds_read_b128 v[80:83], v10 offset:0
  ds_read_b128 v[84:87], v11 offset:0
  ds_read_b128 v[88:91], v12 offset:0
  ds_read_b128 v[92:95], v13 offset:0
  ds_read_b128 v[96:99], v10 offset:4096
  ds_read_b128 v[100:103], v11 offset:4096
  ds_read_b128 v[104:107], v12 offset:4096
  ds_read_b128 v[108:111], v13 offset:4096
  s_waitcnt lgkmcnt(0)
  s_cmp_ge_u32 s46, 8
  s_cbranch_scc1 L_dt1_10
  v_mov_b32 v124, s46
  s_nop 0
  v_readfirstlane_b32 s46, v124
  s_and_b32 s31, s29, 24
  s_and_b32 s66, s46, 7
  s_add_u32 s31, s31, s66
  s_lshl_b32 s31, s31, 6
  s_lshr_b32 s66, s46, 3
  s_lshl_b32 s66, s66, 2
  s_sub_u32 s31, s31, s66
  s_add_u32 s31, s31, 60
  s_lshl_b32 s31, s31, 13
  s_add_u32 s31, s31, s68
  s_add_u32 s32, s6, s31
  s_addc_u32 s33, s7, 0
  s_add_u32 s34, s32, 16384
  s_addc_u32 s35, s33, 0
  s_add_u32 s36, s8, s31
  s_addc_u32 s37, s9, 0
  s_add_u32 s38, s36, 16384
  s_addc_u32 s39, s37, 0
  v_mfma_f32_16x16x32_bf16 v[112:115], v[80:83], v[32:35], 0
  v_mfma_f32_16x16x32_bf16 v[112:115], v[84:87], v[36:39], v[112:115]
  v_mfma_f32_16x16x32_bf16 v[112:115], v[88:91], v[40:43], v[112:115]
  v_mfma_f32_16x16x32_bf16 v[112:115], v[92:95], v[44:47], v[112:115]
  v_mfma_f32_16x16x32_bf16 v[116:119], v[96:99], v[32:35], 0
  v_mfma_f32_16x16x32_bf16 v[116:119], v[100:103], v[36:39], v[116:119]
  v_mfma_f32_16x16x32_bf16 v[116:119], v[104:107], v[40:43], v[116:119]
  v_mfma_f32_16x16x32_bf16 v[116:119], v[108:111], v[44:47], v[116:119]
  s_add_u32 m0, s47, 0
  s_nop 0
  global_load_lds_dwordx4 v4, s[32:33] offset:0 nt
  global_load_lds_dwordx4 v5, s[32:33] offset:1024 nt
  global_load_lds_dwordx4 v6, s[32:33] offset:2048 nt
  global_load_lds_dwordx4 v7, s[32:33] offset:3072 nt
  s_add_u32 m0, s47, 4096
  s_nop 0
  global_load_lds_dwordx4 v4, s[34:35] offset:0 nt
  global_load_lds_dwordx4 v5, s[34:35] offset:1024 nt
  global_load_lds_dwordx4 v6, s[34:35] offset:2048 nt
  global_load_lds_dwordx4 v7, s[34:35] offset:3072 nt
  s_waitcnt vmcnt(24)
  ds_read_b64_tr_b16 v[80:81], v14 offset:8192
  ds_read_b64_tr_b16 v[84:85], v15 offset:8192
  ds_read_b64_tr_b16 v[88:89], v16 offset:8192
  ds_read_b64_tr_b16 v[92:93], v17 offset:8192
  ds_read_b64_tr_b16 v[96:97], v18 offset:8192
  ds_read_b64_tr_b16 v[100:101], v19 offset:8192
  ds_read_b64_tr_b16 v[104:105], v20 offset:8192
  ds_read_b64_tr_b16 v[108:109], v21 offset:8192
  ds_read_b64_tr_b16 v[82:83], v14 offset:12288
  ds_read_b64_tr_b16 v[86:87], v15 offset:12288
  ds_read_b64_tr_b16 v[90:91], v16 offset:12288
  ds_read_b64_tr_b16 v[94:95], v17 offset:12288
  ds_read_b64_tr_b16 v[98:99], v18 offset:12288
  ds_read_b64_tr_b16 v[102:103], v19 offset:12288
  ds_read_b64_tr_b16 v[106:107], v20 offset:12288
  ds_read_b64_tr_b16 v[110:111], v21 offset:12288
  v_cvt_pk_bf16_f32 v120, v112, v113
  v_cvt_pk_bf16_f32 v121, v114, v115
  v_cvt_pk_bf16_f32 v122, v116, v117
  v_cvt_pk_bf16_f32 v123, v118, v119
  v_lshlrev_b32 v112, 16, v120
  v_and_b32 v113, 0xffff0000, v120
  v_lshlrev_b32 v114, 16, v121
  v_and_b32 v115, 0xffff0000, v121
  v_lshlrev_b32 v116, 16, v122
  v_and_b32 v117, 0xffff0000, v122
  v_lshlrev_b32 v118, 16, v123
  v_and_b32 v119, 0xffff0000, v123
  v_mul_f32 v112, s58, v112
  v_mul_f32 v113, s58, v113
  v_mul_f32 v114, s58, v114
  v_mul_f32 v115, s58, v115
  v_mul_f32 v116, s58, v116
  v_mul_f32 v117, s58, v117
  v_mul_f32 v118, s58, v118
  v_mul_f32 v119, s58, v119
  v_cvt_pk_bf16_f32 v120, v112, v113
  v_cvt_pk_bf16_f32 v121, v114, v115
  v_cvt_pk_bf16_f32 v122, v116, v117
  v_cvt_pk_bf16_f32 v123, v118, v119
  v_lshlrev_b32 v112, 16, v120
  v_and_b32 v113, 0xffff0000, v120
  v_lshlrev_b32 v114, 16, v121
  v_and_b32 v115, 0xffff0000, v121
  v_lshlrev_b32 v116, 16, v122
  v_and_b32 v117, 0xffff0000, v122
  v_lshlrev_b32 v118, 16, v123
  v_and_b32 v119, 0xffff0000, v123
  v_max3_f32 v124, v112, v113, v114
  v_max3_f32 v125, v115, v116, v117
  v_max3_f32 v124, v124, v118, v119
  v_max_f32 v124, v124, v125
  v_mov_b32 v125, v124
  s_nop 1
  v_permlane16_swap_b32 v124, v125
  v_max_f32 v124, v124, v125
  v_mov_b32 v125, v124
  s_nop 1
  v_permlane32_swap_b32 v124, v125
  v_max_f32 v124, v124, v125
  v_mul_f32 v124, s62, v124
  v_max_f32 v124, v124, v22
  v_sub_f32 v24, v22, v124
  v_exp_f32 v24, v24
  v_mov_b32 v22, v124
  v_fma_f32 v112, v112, s62, -v22
  v_fma_f32 v113, v113, s62, -v22
  v_fma_f32 v114, v114, s62, -v22
  v_fma_f32 v115, v115, s62, -v22
  v_fma_f32 v116, v116, s62, -v22
  v_fma_f32 v117, v117, s62, -v22
  v_fma_f32 v118, v118, s62, -v22
  v_fma_f32 v119, v119, s62, -v22
  v_exp_f32 v112, v112
  v_exp_f32 v113, v113
  v_exp_f32 v114, v114
  v_exp_f32 v115, v115
  v_exp_f32 v116, v116
  v_exp_f32 v117, v117
  v_exp_f32 v118, v118
  v_exp_f32 v119, v119
  v_mul_f32 v23, v23, v24
  v_cvt_pk_bf16_f32 v120, v112, v113
  v_cvt_pk_bf16_f32 v121, v114, v115
  v_cvt_pk_bf16_f32 v122, v116, v117
  v_cvt_pk_bf16_f32 v123, v118, v119
  v_add_f32 v124, v112, v113
  v_add_f32 v125, v114, v115
  v_add_f32 v124, v124, v116
  v_add_f32 v125, v125, v117
  v_add_f32 v124, v124, v118
  v_add_f32 v125, v125, v119
  v_add_f32 v124, v124, v125
  v_add_f32 v23, v23, v124
  v_mul_f32_dpp v48, v24, v48 quad_perm:[0,0,0,0] row_mask:0xf bank_mask:0xf
  v_mul_f32_dpp v49, v24, v49 quad_perm:[1,1,1,1] row_mask:0xf bank_mask:0xf
  v_mul_f32_dpp v50, v24, v50 quad_perm:[2,2,2,2] row_mask:0xf bank_mask:0xf
  v_mul_f32_dpp v51, v24, v51 quad_perm:[3,3,3,3] row_mask:0xf bank_mask:0xf
  v_mul_f32_dpp v52, v24, v52 quad_perm:[0,0,0,0] row_mask:0xf bank_mask:0xf
  v_mul_f32_dpp v53, v24, v53 quad_perm:[1,1,1,1] row_mask:0xf bank_mask:0xf
  v_mul_f32_dpp v54, v24, v54 quad_perm:[2,2,2,2] row_mask:0xf bank_mask:0xf
  v_mul_f32_dpp v55, v24, v55 quad_perm:[3,3,3,3] row_mask:0xf bank_mask:0xf
  v_mul_f32_dpp v56, v24, v56 quad_perm:[0,0,0,0] row_mask:0xf bank_mask:0xf
  v_mul_f32_dpp v57, v24, v57 quad_perm:[1,1,1,1] row_mask:0xf bank_mask:0xf
  v_mul_f32_dpp v58, v24, v58 quad_perm:[2,2,2,2] row_mask:0xf bank_mask:0xf
  v_mul_f32_dpp v59, v24, v59 quad_perm:[3,3,3,3] row_mask:0xf bank_mask:0xf
  v_mul_f32_dpp v60, v24, v60 quad_perm:[0,0,0,0] row_mask:0xf bank_mask:0xf
  v_mul_f32_dpp v61, v24, v61 quad_perm:[1,1,1,1] row_mask:0xf bank_mask:0xf
  v_mul_f32_dpp v62, v24, v62 quad_perm:[2,2,2,2] row_mask:0xf bank_mask:0xf
  v_mul_f32_dpp v63, v24, v63 quad_perm:[3,3,3,3] row_mask:0xf bank_mask:0xf
  v_mul_f32_dpp v64, v24, v64 quad_perm:[0,0,0,0] row_mask:0xf bank_mask:0xf
  v_mul_f32_dpp v65, v24, v65 quad_perm:[1,1,1,1] row_mask:0xf bank_mask:0xf
  v_mul_f32_dpp v66, v24, v66 quad_perm:[2,2,2,2] row_mask:0xf bank_mask:0xf
  v_mul_f32_dpp v67, v24, v67 quad_perm:[3,3,3,3] row_mask:0xf bank_mask:0xf
  v_mul_f32_dpp v68, v24, v68 quad_perm:[0,0,0,0] row_mask:0xf bank_mask:0xf
  v_mul_f32_dpp v69, v24, v69 quad_perm:[1,1,1,1] row_mask:0xf bank_mask:0xf
  v_mul_f32_dpp v70, v24, v70 quad_perm:[2,2,2,2] row_mask:0xf bank_mask:0xf
  v_mul_f32_dpp v71, v24, v71 quad_perm:[3,3,3,3] row_mask:0xf bank_mask:0xf
  v_mul_f32_dpp v72, v24, v72 quad_perm:[0,0,0,0] row_mask:0xf bank_mask:0xf
  v_mul_f32_dpp v73, v24, v73 quad_perm:[1,1,1,1] row_mask:0xf bank_mask:0xf
  v_mul_f32_dpp v74, v24, v74 quad_perm:[2,2,2,2] row_mask:0xf bank_mask:0xf
  v_mul_f32_dpp v75, v24, v75 quad_perm:[3,3,3,3] row_mask:0xf bank_mask:0xf
  v_mul_f32_dpp v76, v24, v76 quad_perm:[0,0,0,0] row_mask:0xf bank_mask:0xf
  v_mul_f32_dpp v77, v24, v77 quad_perm:[1,1,1,1] row_mask:0xf bank_mask:0xf
  v_mul_f32_dpp v78, v24, v78 quad_perm:[2,2,2,2] row_mask:0xf bank_mask:0xf
  v_mul_f32_dpp v79, v24, v79 quad_perm:[3,3,3,3] row_mask:0xf bank_mask:0xf
  s_waitcnt lgkmcnt(0)
  s_mov_b32 s46, 1
  s_atomic_add s46, s[92:93], 0 glc
  v_mfma_f32_16x16x32_bf16 v[48:51], v[120:123], v[80:83], v[48:51]
  v_mfma_f32_16x16x32_bf16 v[52:55], v[120:123], v[84:87], v[52:55]
  v_mfma_f32_16x16x32_bf16 v[56:59], v[120:123], v[88:91], v[56:59]
  v_mfma_f32_16x16x32_bf16 v[60:63], v[120:123], v[92:95], v[60:63]
  v_mfma_f32_16x16x32_bf16 v[64:67], v[120:123], v[96:99], v[64:67]
  v_mfma_f32_16x16x32_bf16 v[68:71], v[120:123], v[100:103], v[68:71]
  v_mfma_f32_16x16x32_bf16 v[72:75], v[120:123], v[104:107], v[72:75]
  v_mfma_f32_16x16x32_bf16 v[76:79], v[120:123], v[108:111], v[76:79]
  s_add_u32 m0, s47, 8192
  s_nop 0
  global_load_lds_dwordx4 v8, s[36:37] offset:0 nt
  global_load_lds_dwordx4 v9, s[36:37] offset:1024 nt
  global_load_lds_dwordx4 v8, s[36:37] offset:2048 nt
  global_load_lds_dwordx4 v9, s[36:37] offset:3072 nt
  s_add_u32 m0, s47, 12288
  s_nop 0
  global_load_lds_dwordx4 v8, s[38:39] offset:0 nt
  global_load_lds_dwordx4 v9, s[38:39] offset:1024 nt
  global_load_lds_dwordx4 v8, s[38:39] offset:2048 nt
  global_load_lds_dwordx4 v9, s[38:39] offset:3072 nt
  s_nop 7
  s_branch L_dtop_8
L_dt0_9:
  s_lshl_b32 s31, s29, 6
  s_add_u32 s31, s31, 24
  s_lshl_b32 s31, s31, 13
  s_add_u32 s31, s31, s68
  s_add_u32 s32, s6, s31
  s_addc_u32 s33, s7, 0
  s_add_u32 s34, s32, 16384
  s_addc_u32 s35, s33, 0
  s_add_u32 s36, s8, s31
  s_addc_u32 s37, s9, 0
  s_add_u32 s38, s36, 16384
  s_addc_u32 s39, s37, 0
  v_mfma_f32_16x16x32_bf16 v[112:115], v[80:83], v[32:35], 0
  v_mfma_f32_16x16x32_bf16 v[112:115], v[84:87], v[36:39], v[112:115]
  v_mfma_f32_16x16x32_bf16 v[112:115], v[88:91], v[40:43], v[112:115]
  v_mfma_f32_16x16x32_bf16 v[112:115], v[92:95], v[44:47], v[112:115]
  v_mfma_f32_16x16x32_bf16 v[116:119], v[96:99], v[32:35], 0
  v_mfma_f32_16x16x32_bf16 v[116:119], v[100:103], v[36:39], v[116:119]
  v_mfma_f32_16x16x32_bf16 v[116:119], v[104:107], v[40:43], v[116:119]
  v_mfma_f32_16x16x32_bf16 v[116:119], v[108:111], v[44:47], v[116:119]
  s_add_u32 m0, s47, 16384
  s_nop 0
  global_load_lds_dwordx4 v4, s[32:33] offset:0 nt
  global_load_lds_dwordx4 v5, s[32:33] offset:1024 nt
  global_load_lds_dwordx4 v6, s[32:33] offset:2048 nt
  global_load_lds_dwordx4 v7, s[32:33] offset:3072 nt
  s_add_u32 m0, s47, 20480
  s_nop 0
  global_load_lds_dwordx4 v4, s[34:35] offset:0 nt
  global_load_lds_dwordx4 v5, s[34:35] offset:1024 nt
  global_load_lds_dwordx4 v6, s[34:35] offset:2048 nt
  global_load_lds_dwordx4 v7, s[34:35] offset:3072 nt
  s_waitcnt vmcnt(24)
  ds_read_b64_tr_b16 v[80:81], v14 offset:24576
  ds_read_b64_tr_b16 v[84:85], v15 offset:24576
  ds_read_b64_tr_b16 v[88:89], v16 offset:24576
  ds_read_b64_tr_b16 v[92:93], v17 offset:24576
  ds_read_b64_tr_b16 v[96:97], v18 offset:24576
  ds_read_b64_tr_b16 v[100:101], v19 offset:24576
  ds_read_b64_tr_b16 v[104:105], v20 offset:24576
  ds_read_b64_tr_b16 v[108:109], v21 offset:24576
  ds_read_b64_tr_b16 v[82:83], v14 offset:28672
  ds_read_b64_tr_b16 v[86:87], v15 offset:28672
  ds_read_b64_tr_b16 v[90:91], v16 offset:28672
  ds_read_b64_tr_b16 v[94:95], v17 offset:28672
  ds_read_b64_tr_b16 v[98:99], v18 offset:28672
  ds_read_b64_tr_b16 v[102:103], v19 offset:28672
  ds_read_b64_tr_b16 v[106:107], v20 offset:28672
  ds_read_b64_tr_b16 v[110:111], v21 offset:28672
  v_cvt_pk_bf16_f32 v120, v112, v113
  v_cvt_pk_bf16_f32 v121, v114, v115
  v_cvt_pk_bf16_f32 v122, v116, v117
  v_cvt_pk_bf16_f32 v123, v118, v119
  v_lshlrev_b32 v112, 16, v120
  v_and_b32 v113, 0xffff0000, v120
  v_lshlrev_b32 v114, 16, v121
  v_and_b32 v115, 0xffff0000, v121
  v_lshlrev_b32 v116, 16, v122
  v_and_b32 v117, 0xffff0000, v122
  v_lshlrev_b32 v118, 16, v123
  v_and_b32 v119, 0xffff0000, v123
  v_mul_f32 v112, s58, v112
  v_mul_f32 v113, s58, v113
  v_mul_f32 v114, s58, v114
  v_mul_f32 v115, s58, v115
  v_mul_f32 v116, s58, v116
  v_mul_f32 v117, s58, v117
  v_mul_f32 v118, s58, v118
  v_mul_f32 v119, s58, v119
  v_cvt_pk_bf16_f32 v120, v112, v113
  v_cvt_pk_bf16_f32 v121, v114, v115
  v_cvt_pk_bf16_f32 v122, v116, v117
  v_cvt_pk_bf16_f32 v123, v118, v119
  v_lshlrev_b32 v112, 16, v120
  v_and_b32 v113, 0xffff0000, v120
  v_lshlrev_b32 v114, 16, v121
  v_and_b32 v115, 0xffff0000, v121
  v_lshlrev_b32 v116, 16, v122
  v_and_b32 v117, 0xffff0000, v122
  v_lshlrev_b32 v118, 16, v123
  v_and_b32 v119, 0xffff0000, v123
  v_max3_f32 v124, v112, v113, v114
  v_max3_f32 v125, v115, v116, v117
  v_max3_f32 v124, v124, v118, v119
  v_max_f32 v124, v124, v125
  v_mov_b32 v125, v124
  s_nop 1
  v_permlane16_swap_b32 v124, v125
  v_max_f32 v124, v124, v125
  v_mov_b32 v125, v124
  s_nop 1
  v_permlane32_swap_b32 v124, v125
  v_max_f32 v124, v124, v125
  v_mul_f32 v124, s62, v124
  v_max_f32 v124, v124, v22
  v_sub_f32 v24, v22, v124
  v_exp_f32 v24, v24
  v_mov_b32 v22, v124
  v_fma_f32 v112, v112, s62, -v22
  v_fma_f32 v113, v113, s62, -v22
  v_fma_f32 v114, v114, s62, -v22
  v_fma_f32 v115, v115, s62, -v22
  v_fma_f32 v116, v116, s62, -v22
  v_fma_f32 v117, v117, s62, -v22
  v_fma_f32 v118, v118, s62, -v22
  v_fma_f32 v119, v119, s62, -v22
  v_exp_f32 v112, v112
  v_exp_f32 v113, v113
  v_exp_f32 v114, v114
  v_exp_f32 v115, v115
  v_exp_f32 v116, v116
  v_exp_f32 v117, v117
  v_exp_f32 v118, v118
  v_exp_f32 v119, v119
  v_mul_f32 v23, v23, v24
  v_cvt_pk_bf16_f32 v120, v112, v113
  v_cvt_pk_bf16_f32 v121, v114, v115
  v_cvt_pk_bf16_f32 v122, v116, v117
  v_cvt_pk_bf16_f32 v123, v118, v119
  v_add_f32 v124, v112, v113
  v_add_f32 v125, v114, v115
  v_add_f32 v124, v124, v116
  v_add_f32 v125, v125, v117
  v_add_f32 v124, v124, v118
  v_add_f32 v125, v125, v119
  v_add_f32 v124, v124, v125
  v_add_f32 v23, v23, v124
  v_mul_f32_dpp v48, v24, v48 quad_perm:[0,0,0,0] row_mask:0xf bank_mask:0xf
  v_mul_f32_dpp v49, v24, v49 quad_perm:[1,1,1,1] row_mask:0xf bank_mask:0xf
  v_mul_f32_dpp v50, v24, v50 quad_perm:[2,2,2,2] row_mask:0xf bank_mask:0xf
  v_mul_f32_dpp v51, v24, v51 quad_perm:[3,3,3,3] row_mask:0xf bank_mask:0xf
  v_mul_f32_dpp v52, v24, v52 quad_perm:[0,0,0,0] row_mask:0xf bank_mask:0xf
  v_mul_f32_dpp v53, v24, v53 quad_perm:[1,1,1,1] row_mask:0xf bank_mask:0xf
  v_mul_f32_dpp v54, v24, v54 quad_perm:[2,2,2,2] row_mask:0xf bank_mask:0xf
  v_mul_f32_dpp v55, v24, v55 quad_perm:[3,3,3,3] row_mask:0xf bank_mask:0xf
  v_mul_f32_dpp v56, v24, v56 quad_perm:[0,0,0,0] row_mask:0xf bank_mask:0xf
  v_mul_f32_dpp v57, v24, v57 quad_perm:[1,1,1,1] row_mask:0xf bank_mask:0xf
  v_mul_f32_dpp v58, v24, v58 quad_perm:[2,2,2,2] row_mask:0xf bank_mask:0xf
  v_mul_f32_dpp v59, v24, v59 quad_perm:[3,3,3,3] row_mask:0xf bank_mask:0xf
  v_mul_f32_dpp v60, v24, v60 quad_perm:[0,0,0,0] row_mask:0xf bank_mask:0xf
  v_mul_f32_dpp v61, v24, v61 quad_perm:[1,1,1,1] row_mask:0xf bank_mask:0xf
  v_mul_f32_dpp v62, v24, v62 quad_perm:[2,2,2,2] row_mask:0xf bank_mask:0xf
  v_mul_f32_dpp v63, v24, v63 quad_perm:[3,3,3,3] row_mask:0xf bank_mask:0xf
  v_mul_f32_dpp v64, v24, v64 quad_perm:[0,0,0,0] row_mask:0xf bank_mask:0xf
  v_mul_f32_dpp v65, v24, v65 quad_perm:[1,1,1,1] row_mask:0xf bank_mask:0xf
  v_mul_f32_dpp v66, v24, v66 quad_perm:[2,2,2,2] row_mask:0xf bank_mask:0xf
  v_mul_f32_dpp v67, v24, v67 quad_perm:[3,3,3,3] row_mask:0xf bank_mask:0xf
  v_mul_f32_dpp v68, v24, v68 quad_perm:[0,0,0,0] row_mask:0xf bank_mask:0xf
  v_mul_f32_dpp v69, v24, v69 quad_perm:[1,1,1,1] row_mask:0xf bank_mask:0xf
  v_mul_f32_dpp v70, v24, v70 quad_perm:[2,2,2,2] row_mask:0xf bank_mask:0xf
  v_mul_f32_dpp v71, v24, v71 quad_perm:[3,3,3,3] row_mask:0xf bank_mask:0xf
  v_mul_f32_dpp v72, v24, v72 quad_perm:[0,0,0,0] row_mask:0xf bank_mask:0xf
  v_mul_f32_dpp v73, v24, v73 quad_perm:[1,1,1,1] row_mask:0xf bank_mask:0xf
  v_mul_f32_dpp v74, v24, v74 quad_perm:[2,2,2,2] row_mask:0xf bank_mask:0xf
  v_mul_f32_dpp v75, v24, v75 quad_perm:[3,3,3,3] row_mask:0xf bank_mask:0xf
  v_mul_f32_dpp v76, v24, v76 quad_perm:[0,0,0,0] row_mask:0xf bank_mask:0xf
  v_mul_f32_dpp v77, v24, v77 quad_perm:[1,1,1,1] row_mask:0xf bank_mask:0xf
  v_mul_f32_dpp v78, v24, v78 quad_perm:[2,2,2,2] row_mask:0xf bank_mask:0xf
  v_mul_f32_dpp v79, v24, v79 quad_perm:[3,3,3,3] row_mask:0xf bank_mask:0xf
  s_waitcnt lgkmcnt(0)
  v_mfma_f32_16x16x32_bf16 v[48:51], v[120:123], v[80:83], v[48:51]
  v_mfma_f32_16x16x32_bf16 v[52:55], v[120:123], v[84:87], v[52:55]
  v_mfma_f32_16x16x32_bf16 v[56:59], v[120:123], v[88:91], v[56:59]
  v_mfma_f32_16x16x32_bf16 v[60:63], v[120:123], v[92:95], v[60:63]
  v_mfma_f32_16x16x32_bf16 v[64:67], v[120:123], v[96:99], v[64:67]
  v_mfma_f32_16x16x32_bf16 v[68:71], v[120:123], v[100:103], v[68:71]
  v_mfma_f32_16x16x32_bf16 v[72:75], v[120:123], v[104:107], v[72:75]
  v_mfma_f32_16x16x32_bf16 v[76:79], v[120:123], v[108:111], v[76:79]
  s_add_u32 m0, s47, 24576
  s_nop 0
  global_load_lds_dwordx4 v8, s[36:37] offset:0 nt
  global_load_lds_dwordx4 v9, s[36:37] offset:1024 nt
  global_load_lds_dwordx4 v8, s[36:37] offset:2048 nt
  global_load_lds_dwordx4 v9, s[36:37] offset:3072 nt
  s_add_u32 m0, s47, 28672
  s_nop 0
  global_load_lds_dwordx4 v8, s[38:39] offset:0 nt
  global_load_lds_dwordx4 v9, s[38:39] offset:1024 nt
  global_load_lds_dwordx4 v8, s[38:39] offset:2048 nt
  global_load_lds_dwordx4 v9, s[38:39] offset:3072 nt
  s_waitcnt vmcnt(24)
  ds_read_b128 v[80:83], v10 offset:0
  ds_read_b128 v[84:87], v11 offset:0
  ds_read_b128 v[88:91], v12 offset:0
  ds_read_b128 v[92:95], v13 offset:0
  ds_read_b128 v[96:99], v10 offset:4096
  ds_read_b128 v[100:103], v11 offset:4096
  ds_read_b128 v[104:107], v12 offset:4096
  ds_read_b128 v[108:111], v13 offset:4096
  s_waitcnt lgkmcnt(0)
  s_lshl_b32 s31, s29, 6
  s_add_u32 s31, s31, 28
  s_lshl_b32 s31, s31, 13
  s_add_u32 s31, s31, s68
  s_add_u32 s32, s6, s31
  s_addc_u32 s33, s7, 0
  s_add_u32 s34, s32, 16384
  s_addc_u32 s35, s33, 0
  s_add_u32 s36, s8, s31
  s_addc_u32 s37, s9, 0
  s_add_u32 s38, s36, 16384
  s_addc_u32 s39, s37, 0
  v_mfma_f32_16x16x32_bf16 v[112:115], v[80:83], v[32:35], 0
  v_mfma_f32_16x16x32_bf16 v[112:115], v[84:87], v[36:39], v[112:115]
  v_mfma_f32_16x16x32_bf16 v[112:115], v[88:91], v[40:43], v[112:115]
  v_mfma_f32_16x16x32_bf16 v[112:115], v[92:95], v[44:47], v[112:115]
  v_mfma_f32_16x16x32_bf16 v[116:119], v[96:99], v[32:35], 0
  v_mfma_f32_16x16x32_bf16 v[116:119], v[100:103], v[36:39], v[116:119]
  v_mfma_f32_16x16x32_bf16 v[116:119], v[104:107], v[40:43], v[116:119]
  v_mfma_f32_16x16x32_bf16 v[116:119], v[108:111], v[44:47], v[116:119]
  s_add_u32 m0, s47, 0
  s_nop 0
  global_load_lds_dwordx4 v4, s[32:33] offset:0 nt
  global_load_lds_dwordx4 v5, s[32:33] offset:1024 nt
  global_load_lds_dwordx4 v6, s[32:33] offset:2048 nt
  global_load_lds_dwordx4 v7, s[32:33] offset:3072 nt
  s_add_u32 m0, s47, 4096
  s_nop 0
  global_load_lds_dwordx4 v4, s[34:35] offset:0 nt
  global_load_lds_dwordx4 v5, s[34:35] offset:1024 nt
  global_load_lds_dwordx4 v6, s[34:35] offset:2048 nt
  global_load_lds_dwordx4 v7, s[34:35] offset:3072 nt
  s_waitcnt vmcnt(24)
  ds_read_b64_tr_b16 v[80:81], v14 offset:8192
  ds_read_b64_tr_b16 v[84:85], v15 offset:8192
  ds_read_b64_tr_b16 v[88:89], v16 offset:8192
  ds_read_b64_tr_b16 v[92:93], v17 offset:8192
  ds_read_b64_tr_b16 v[96:97], v18 offset:8192
  ds_read_b64_tr_b16 v[100:101], v19 offset:8192
  ds_read_b64_tr_b16 v[104:105], v20 offset:8192
  ds_read_b64_tr_b16 v[108:109], v21 offset:8192
  ds_read_b64_tr_b16 v[82:83], v14 offset:12288
  ds_read_b64_tr_b16 v[86:87], v15 offset:12288
  ds_read_b64_tr_b16 v[90:91], v16 offset:12288
  ds_read_b64_tr_b16 v[94:95], v17 offset:12288
  ds_read_b64_tr_b16 v[98:99], v18 offset:12288
  ds_read_b64_tr_b16 v[102:103], v19 offset:12288
  ds_read_b64_tr_b16 v[106:107], v20 offset:12288
  ds_read_b64_tr_b16 v[110:111], v21 offset:12288
  v_cvt_pk_bf16_f32 v120, v112, v113
  v_cvt_pk_bf16_f32 v121, v114, v115
  v_cvt_pk_bf16_f32 v122, v116, v117
  v_cvt_pk_bf16_f32 v123, v118, v119
  v_lshlrev_b32 v112, 16, v120
  v_and_b32 v113, 0xffff0000, v120
  v_lshlrev_b32 v114, 16, v121
  v_and_b32 v115, 0xffff0000, v121
  v_lshlrev_b32 v116, 16, v122
  v_and_b32 v117, 0xffff0000, v122
  v_lshlrev_b32 v118, 16, v123
  v_and_b32 v119, 0xffff0000, v123
  v_mul_f32 v112, s58, v112
  v_mul_f32 v113, s58, v113
  v_mul_f32 v114, s58, v114
  v_mul_f32 v115, s58, v115
  v_mul_f32 v116, s58, v116
  v_mul_f32 v117, s58, v117
  v_mul_f32 v118, s58, v118
  v_mul_f32 v119, s58, v119
  v_cvt_pk_bf16_f32 v120, v112, v113
  v_cvt_pk_bf16_f32 v121, v114, v115
  v_cvt_pk_bf16_f32 v122, v116, v117
  v_cvt_pk_bf16_f32 v123, v118, v119
  v_lshlrev_b32 v112, 16, v120
  v_and_b32 v113, 0xffff0000, v120
  v_lshlrev_b32 v114, 16, v121
  v_and_b32 v115, 0xffff0000, v121
  v_lshlrev_b32 v116, 16, v122
  v_and_b32 v117, 0xffff0000, v122
  v_lshlrev_b32 v118, 16, v123
  v_and_b32 v119, 0xffff0000, v123
  v_max3_f32 v124, v112, v113, v114
  v_max3_f32 v125, v115, v116, v117
  v_max3_f32 v124, v124, v118, v119
  v_max_f32 v124, v124, v125
  v_mov_b32 v125, v124
  s_nop 1
  v_permlane16_swap_b32 v124, v125
  v_max_f32 v124, v124, v125
  v_mov_b32 v125, v124
  s_nop 1
  v_permlane32_swap_b32 v124, v125
  v_max_f32 v124, v124, v125
  v_mul_f32 v124, s62, v124
  v_max_f32 v124, v124, v22
  v_sub_f32 v24, v22, v124
  v_exp_f32 v24, v24
  v_mov_b32 v22, v124
  v_fma_f32 v112, v112, s62, -v22
  v_fma_f32 v113, v113, s62, -v22
  v_fma_f32 v114, v114, s62, -v22
  v_fma_f32 v115, v115, s62, -v22
  v_fma_f32 v116, v116, s62, -v22
  v_fma_f32 v117, v117, s62, -v22
  v_fma_f32 v118, v118, s62, -v22
  v_fma_f32 v119, v119, s62, -v22
  v_exp_f32 v112, v112
  v_exp_f32 v113, v113
  v_exp_f32 v114, v114
  v_exp_f32 v115, v115
  v_exp_f32 v116, v116
  v_exp_f32 v117, v117
  v_exp_f32 v118, v118
  v_exp_f32 v119, v119
  v_mul_f32 v23, v23, v24
  v_cvt_pk_bf16_f32 v120, v112, v113
  v_cvt_pk_bf16_f32 v121, v114, v115
  v_cvt_pk_bf16_f32 v122, v116, v117
  v_cvt_pk_bf16_f32 v123, v118, v119
  v_add_f32 v124, v112, v113
  v_add_f32 v125, v114, v115
  v_add_f32 v124, v124, v116
  v_add_f32 v125, v125, v117
  v_add_f32 v124, v124, v118
  v_add_f32 v125, v125, v119
  v_add_f32 v124, v124, v125
  v_add_f32 v23, v23, v124
  v_mul_f32_dpp v48, v24, v48 quad_perm:[0,0,0,0] row_mask:0xf bank_mask:0xf
  v_mul_f32_dpp v49, v24, v49 quad_perm:[1,1,1,1] row_mask:0xf bank_mask:0xf
  v_mul_f32_dpp v50, v24, v50 quad_perm:[2,2,2,2] row_mask:0xf bank_mask:0xf
  v_mul_f32_dpp v51, v24, v51 quad_perm:[3,3,3,3] row_mask:0xf bank_mask:0xf
  v_mul_f32_dpp v52, v24, v52 quad_perm:[0,0,0,0] row_mask:0xf bank_mask:0xf
  v_mul_f32_dpp v53, v24, v53 quad_perm:[1,1,1,1] row_mask:0xf bank_mask:0xf
  v_mul_f32_dpp v54, v24, v54 quad_perm:[2,2,2,2] row_mask:0xf bank_mask:0xf
  v_mul_f32_dpp v55, v24, v55 quad_perm:[3,3,3,3] row_mask:0xf bank_mask:0xf
  v_mul_f32_dpp v56, v24, v56 quad_perm:[0,0,0,0] row_mask:0xf bank_mask:0xf
  v_mul_f32_dpp v57, v24, v57 quad_perm:[1,1,1,1] row_mask:0xf bank_mask:0xf
  v_mul_f32_dpp v58, v24, v58 quad_perm:[2,2,2,2] row_mask:0xf bank_mask:0xf
  v_mul_f32_dpp v59, v24, v59 quad_perm:[3,3,3,3] row_mask:0xf bank_mask:0xf
  v_mul_f32_dpp v60, v24, v60 quad_perm:[0,0,0,0] row_mask:0xf bank_mask:0xf
  v_mul_f32_dpp v61, v24, v61 quad_perm:[1,1,1,1] row_mask:0xf bank_mask:0xf
  v_mul_f32_dpp v62, v24, v62 quad_perm:[2,2,2,2] row_mask:0xf bank_mask:0xf
  v_mul_f32_dpp v63, v24, v63 quad_perm:[3,3,3,3] row_mask:0xf bank_mask:0xf
  v_mul_f32_dpp v64, v24, v64 quad_perm:[0,0,0,0] row_mask:0xf bank_mask:0xf
  v_mul_f32_dpp v65, v24, v65 quad_perm:[1,1,1,1] row_mask:0xf bank_mask:0xf
  v_mul_f32_dpp v66, v24, v66 quad_perm:[2,2,2,2] row_mask:0xf bank_mask:0xf
  v_mul_f32_dpp v67, v24, v67 quad_perm:[3,3,3,3] row_mask:0xf bank_mask:0xf
  v_mul_f32_dpp v68, v24, v68 quad_perm:[0,0,0,0] row_mask:0xf bank_mask:0xf
  v_mul_f32_dpp v69, v24, v69 quad_perm:[1,1,1,1] row_mask:0xf bank_mask:0xf
  v_mul_f32_dpp v70, v24, v70 quad_perm:[2,2,2,2] row_mask:0xf bank_mask:0xf
  v_mul_f32_dpp v71, v24, v71 quad_perm:[3,3,3,3] row_mask:0xf bank_mask:0xf
  v_mul_f32_dpp v72, v24, v72 quad_perm:[0,0,0,0] row_mask:0xf bank_mask:0xf
  v_mul_f32_dpp v73, v24, v73 quad_perm:[1,1,1,1] row_mask:0xf bank_mask:0xf
  v_mul_f32_dpp v74, v24, v74 quad_perm:[2,2,2,2] row_mask:0xf bank_mask:0xf
  v_mul_f32_dpp v75, v24, v75 quad_perm:[3,3,3,3] row_mask:0xf bank_mask:0xf
  v_mul_f32_dpp v76, v24, v76 quad_perm:[0,0,0,0] row_mask:0xf bank_mask:0xf
  v_mul_f32_dpp v77, v24, v77 quad_perm:[1,1,1,1] row_mask:0xf bank_mask:0xf
  v_mul_f32_dpp v78, v24, v78 quad_perm:[2,2,2,2] row_mask:0xf bank_mask:0xf
  v_mul_f32_dpp v79, v24, v79 quad_perm:[3,3,3,3] row_mask:0xf bank_mask:0xf
  s_waitcnt lgkmcnt(0)
  v_mfma_f32_16x16x32_bf16 v[48:51], v[120:123], v[80:83], v[48:51]
  v_mfma_f32_16x16x32_bf16 v[52:55], v[120:123], v[84:87], v[52:55]
  v_mfma_f32_16x16x32_bf16 v[56:59], v[120:123], v[88:91], v[56:59]
  v_mfma_f32_16x16x32_bf16 v[60:63], v[120:123], v[92:95], v[60:63]
  v_mfma_f32_16x16x32_bf16 v[64:67], v[120:123], v[96:99], v[64:67]
  v_mfma_f32_16x16x32_bf16 v[68:71], v[120:123], v[100:103], v[68:71]
  v_mfma_f32_16x16x32_bf16 v[72:75], v[120:123], v[104:107], v[72:75]
  v_mfma_f32_16x16x32_bf16 v[76:79], v[120:123], v[108:111], v[76:79]
  s_add_u32 m0, s47, 8192
  s_nop 0
  global_load_lds_dwordx4 v8, s[36:37] offset:0 nt
  global_load_lds_dwordx4 v9, s[36:37] offset:1024 nt
  global_load_lds_dwordx4 v8, s[36:37] offset:2048 nt
  global_load_lds_dwordx4 v9, s[36:37] offset:3072 nt
  s_add_u32 m0, s47, 12288
  s_nop 0
  global_load_lds_dwordx4 v8, s[38:39] offset:0 nt
  global_load_lds_dwordx4 v9, s[38:39] offset:1024 nt
  global_load_lds_dwordx4 v8, s[38:39] offset:2048 nt
  global_load_lds_dwordx4 v9, s[38:39] offset:3072 nt
  s_waitcnt vmcnt(24)
  ds_read_b128 v[80:83], v10 offset:16384
  ds_read_b128 v[84:87], v11 offset:16384
  ds_read_b128 v[88:91], v12 offset:16384
  ds_read_b128 v[92:95], v13 offset:16384
  ds_read_b128 v[96:99], v10 offset:20480
  ds_read_b128 v[100:103], v11 offset:20480
  ds_read_b128 v[104:107], v12 offset:20480
  ds_read_b128 v[108:111], v13 offset:20480
  s_waitcnt lgkmcnt(0)
  v_mfma_f32_16x16x32_bf16 v[112:115], v[80:83], v[32:35], 0
  v_mfma_f32_16x16x32_bf16 v[112:115], v[84:87], v[36:39], v[112:115]
  v_mfma_f32_16x16x32_bf16 v[112:115], v[88:91], v[40:43], v[112:115]
  v_mfma_f32_16x16x32_bf16 v[112:115], v[92:95], v[44:47], v[112:115]
  v_mfma_f32_16x16x32_bf16 v[116:119], v[96:99], v[32:35], 0
  v_mfma_f32_16x16x32_bf16 v[116:119], v[100:103], v[36:39], v[116:119]
  v_mfma_f32_16x16x32_bf16 v[116:119], v[104:107], v[40:43], v[116:119]
  v_mfma_f32_16x16x32_bf16 v[116:119], v[108:111], v[44:47], v[116:119]
  s_waitcnt vmcnt(16)
  ds_read_b64_tr_b16 v[80:81], v14 offset:24576
  ds_read_b64_tr_b16 v[84:85], v15 offset:24576
  ds_read_b64_tr_b16 v[88:89], v16 offset:24576
  ds_read_b64_tr_b16 v[92:93], v17 offset:24576
  ds_read_b64_tr_b16 v[96:97], v18 offset:24576
  ds_read_b64_tr_b16 v[100:101], v19 offset:24576
  ds_read_b64_tr_b16 v[104:105], v20 offset:24576
  ds_read_b64_tr_b16 v[108:109], v21 offset:24576
  ds_read_b64_tr_b16 v[82:83], v14 offset:28672
  ds_read_b64_tr_b16 v[86:87], v15 offset:28672
  ds_read_b64_tr_b16 v[90:91], v16 offset:28672
  ds_read_b64_tr_b16 v[94:95], v17 offset:28672
  ds_read_b64_tr_b16 v[98:99], v18 offset:28672
  ds_read_b64_tr_b16 v[102:103], v19 offset:28672
  ds_read_b64_tr_b16 v[106:107], v20 offset:28672
  ds_read_b64_tr_b16 v[110:111], v21 offset:28672
  v_cvt_pk_bf16_f32 v120, v112, v113
  v_cvt_pk_bf16_f32 v121, v114, v115
  v_cvt_pk_bf16_f32 v122, v116, v117
  v_cvt_pk_bf16_f32 v123, v118, v119
  v_lshlrev_b32 v112, 16, v120
  v_and_b32 v113, 0xffff0000, v120
  v_lshlrev_b32 v114, 16, v121
  v_and_b32 v115, 0xffff0000, v121
  v_lshlrev_b32 v116, 16, v122
  v_and_b32 v117, 0xffff0000, v122
  v_lshlrev_b32 v118, 16, v123
  v_and_b32 v119, 0xffff0000, v123
  v_mul_f32 v112, s58, v112
  v_mul_f32 v113, s58, v113
  v_mul_f32 v114, s58, v114
  v_mul_f32 v115, s58, v115
  v_mul_f32 v116, s58, v116
  v_mul_f32 v117, s58, v117
  v_mul_f32 v118, s58, v118
  v_mul_f32 v119, s58, v119
  v_cvt_pk_bf16_f32 v120, v112, v113
  v_cvt_pk_bf16_f32 v121, v114, v115
  v_cvt_pk_bf16_f32 v122, v116, v117
  v_cvt_pk_bf16_f32 v123, v118, v119
  v_lshlrev_b32 v112, 16, v120
  v_and_b32 v113, 0xffff0000, v120
  v_lshlrev_b32 v114, 16, v121
  v_and_b32 v115, 0xffff0000, v121
  v_lshlrev_b32 v116, 16, v122
  v_and_b32 v117, 0xffff0000, v122
  v_lshlrev_b32 v118, 16, v123
  v_and_b32 v119, 0xffff0000, v123
  v_max3_f32 v124, v112, v113, v114
  v_max3_f32 v125, v115, v116, v117
  v_max3_f32 v124, v124, v118, v119
  v_max_f32 v124, v124, v125
  v_mov_b32 v125, v124
  s_nop 1
  v_permlane16_swap_b32 v124, v125
  v_max_f32 v124, v124, v125
  v_mov_b32 v125, v124
  s_nop 1
  v_permlane32_swap_b32 v124, v125
  v_max_f32 v124, v124, v125
  v_mul_f32 v124, s62, v124
  v_max_f32 v124, v124, v22
  v_sub_f32 v24, v22, v124
  v_exp_f32 v24, v24
  v_mov_b32 v22, v124
  v_fma_f32 v112, v112, s62, -v22
  v_fma_f32 v113, v113, s62, -v22
  v_fma_f32 v114, v114, s62, -v22
  v_fma_f32 v115, v115, s62, -v22
  v_fma_f32 v116, v116, s62, -v22
  v_fma_f32 v117, v117, s62, -v22
  v_fma_f32 v118, v118, s62, -v22
  v_fma_f32 v119, v119, s62, -v22
  v_exp_f32 v112, v112
  v_exp_f32 v113, v113
  v_exp_f32 v114, v114
  v_exp_f32 v115, v115
  v_exp_f32 v116, v116
  v_exp_f32 v117, v117
  v_exp_f32 v118, v118
  v_exp_f32 v119, v119
  v_mul_f32 v23, v23, v24
  v_cvt_pk_bf16_f32 v120, v112, v113
  v_cvt_pk_bf16_f32 v121, v114, v115
  v_cvt_pk_bf16_f32 v122, v116, v117
  v_cvt_pk_bf16_f32 v123, v118, v119
  v_add_f32 v124, v112, v113
  v_add_f32 v125, v114, v115
  v_add_f32 v124, v124, v116
  v_add_f32 v125, v125, v117
  v_add_f32 v124, v124, v118
  v_add_f32 v125, v125, v119
  v_add_f32 v124, v124, v125
  v_add_f32 v23, v23, v124
  v_mul_f32_dpp v48, v24, v48 quad_perm:[0,0,0,0] row_mask:0xf bank_mask:0xf
  v_mul_f32_dpp v49, v24, v49 quad_perm:[1,1,1,1] row_mask:0xf bank_mask:0xf
  v_mul_f32_dpp v50, v24, v50 quad_perm:[2,2,2,2] row_mask:0xf bank_mask:0xf
  v_mul_f32_dpp v51, v24, v51 quad_perm:[3,3,3,3] row_mask:0xf bank_mask:0xf
  v_mul_f32_dpp v52, v24, v52 quad_perm:[0,0,0,0] row_mask:0xf bank_mask:0xf
  v_mul_f32_dpp v53, v24, v53 quad_perm:[1,1,1,1] row_mask:0xf bank_mask:0xf
  v_mul_f32_dpp v54, v24, v54 quad_perm:[2,2,2,2] row_mask:0xf bank_mask:0xf
  v_mul_f32_dpp v55, v24, v55 quad_perm:[3,3,3,3] row_mask:0xf bank_mask:0xf
  v_mul_f32_dpp v56, v24, v56 quad_perm:[0,0,0,0] row_mask:0xf bank_mask:0xf
  v_mul_f32_dpp v57, v24, v57 quad_perm:[1,1,1,1] row_mask:0xf bank_mask:0xf
  v_mul_f32_dpp v58, v24, v58 quad_perm:[2,2,2,2] row_mask:0xf bank_mask:0xf
  v_mul_f32_dpp v59, v24, v59 quad_perm:[3,3,3,3] row_mask:0xf bank_mask:0xf
  v_mul_f32_dpp v60, v24, v60 quad_perm:[0,0,0,0] row_mask:0xf bank_mask:0xf
  v_mul_f32_dpp v61, v24, v61 quad_perm:[1,1,1,1] row_mask:0xf bank_mask:0xf
  v_mul_f32_dpp v62, v24, v62 quad_perm:[2,2,2,2] row_mask:0xf bank_mask:0xf
  v_mul_f32_dpp v63, v24, v63 quad_perm:[3,3,3,3] row_mask:0xf bank_mask:0xf
  v_mul_f32_dpp v64, v24, v64 quad_perm:[0,0,0,0] row_mask:0xf bank_mask:0xf
  v_mul_f32_dpp v65, v24, v65 quad_perm:[1,1,1,1] row_mask:0xf bank_mask:0xf
  v_mul_f32_dpp v66, v24, v66 quad_perm:[2,2,2,2] row_mask:0xf bank_mask:0xf
  v_mul_f32_dpp v67, v24, v67 quad_perm:[3,3,3,3] row_mask:0xf bank_mask:0xf
  v_mul_f32_dpp v68, v24, v68 quad_perm:[0,0,0,0] row_mask:0xf bank_mask:0xf
  v_mul_f32_dpp v69, v24, v69 quad_perm:[1,1,1,1] row_mask:0xf bank_mask:0xf
  v_mul_f32_dpp v70, v24, v70 quad_perm:[2,2,2,2] row_mask:0xf bank_mask:0xf
  v_mul_f32_dpp v71, v24, v71 quad_perm:[3,3,3,3] row_mask:0xf bank_mask:0xf
  v_mul_f32_dpp v72, v24, v72 quad_perm:[0,0,0,0] row_mask:0xf bank_mask:0xf
  v_mul_f32_dpp v73, v24, v73 quad_perm:[1,1,1,1] row_mask:0xf bank_mask:0xf
  v_mul_f32_dpp v74, v24, v74 quad_perm:[2,2,2,2] row_mask:0xf bank_mask:0xf
  v_mul_f32_dpp v75, v24, v75 quad_perm:[3,3,3,3] row_mask:0xf bank_mask:0xf
  v_mul_f32_dpp v76, v24, v76 quad_perm:[0,0,0,0] row_mask:0xf bank_mask:0xf
  v_mul_f32_dpp v77, v24, v77 quad_perm:[1,1,1,1] row_mask:0xf bank_mask:0xf
  v_mul_f32_dpp v78, v24, v78 quad_perm:[2,2,2,2] row_mask:0xf bank_mask:0xf
  v_mul_f32_dpp v79, v24, v79 quad_perm:[3,3,3,3] row_mask:0xf bank_mask:0xf
  s_waitcnt lgkmcnt(0)
  v_mfma_f32_16x16x32_bf16 v[48:51], v[120:123], v[80:83], v[48:51]
  v_mfma_f32_16x16x32_bf16 v[52:55], v[120:123], v[84:87], v[52:55]
  v_mfma_f32_16x16x32_bf16 v[56:59], v[120:123], v[88:91], v[56:59]
  v_mfma_f32_16x16x32_bf16 v[60:63], v[120:123], v[92:95], v[60:63]
  v_mfma_f32_16x16x32_bf16 v[64:67], v[120:123], v[96:99], v[64:67]
  v_mfma_f32_16x16x32_bf16 v[68:71], v[120:123], v[100:103], v[68:71]
  v_mfma_f32_16x16x32_bf16 v[72:75], v[120:123], v[104:107], v[72:75]
  v_mfma_f32_16x16x32_bf16 v[76:79], v[120:123], v[108:111], v[76:79]
  s_waitcnt vmcnt(8)
  ds_read_b128 v[80:83], v10 offset:0
  ds_read_b128 v[84:87], v11 offset:0
  ds_read_b128 v[88:91], v12 offset:0
  ds_read_b128 v[92:95], v13 offset:0
  ds_read_b128 v[96:99], v10 offset:4096
  ds_read_b128 v[100:103], v11 offset:4096
  ds_read_b128 v[104:107], v12 offset:4096
  ds_read_b128 v[108:111], v13 offset:4096
  s_waitcnt lgkmcnt(0)
  v_mfma_f32_16x16x32_bf16 v[112:115], v[80:83], v[32:35], 0
  v_mfma_f32_16x16x32_bf16 v[112:115], v[84:87], v[36:39], v[112:115]
  v_mfma_f32_16x16x32_bf16 v[112:115], v[88:91], v[40:43], v[112:115]
  v_mfma_f32_16x16x32_bf16 v[112:115], v[92:95], v[44:47], v[112:115]
  v_mfma_f32_16x16x32_bf16 v[116:119], v[96:99], v[32:35], 0
  v_mfma_f32_16x16x32_bf16 v[116:119], v[100:103], v[36:39], v[116:119]
  v_mfma_f32_16x16x32_bf16 v[116:119], v[104:107], v[40:43], v[116:119]
  v_mfma_f32_16x16x32_bf16 v[116:119], v[108:111], v[44:47], v[116:119]
  s_waitcnt vmcnt(0)
  ds_read_b64_tr_b16 v[80:81], v14 offset:8192
  ds_read_b64_tr_b16 v[84:85], v15 offset:8192
  ds_read_b64_tr_b16 v[88:89], v16 offset:8192
  ds_read_b64_tr_b16 v[92:93], v17 offset:8192
  ds_read_b64_tr_b16 v[96:97], v18 offset:8192
  ds_read_b64_tr_b16 v[100:101], v19 offset:8192
  ds_read_b64_tr_b16 v[104:105], v20 offset:8192
  ds_read_b64_tr_b16 v[108:109], v21 offset:8192
  ds_read_b64_tr_b16 v[82:83], v14 offset:12288
  ds_read_b64_tr_b16 v[86:87], v15 offset:12288
  ds_read_b64_tr_b16 v[90:91], v16 offset:12288
  ds_read_b64_tr_b16 v[94:95], v17 offset:12288
  ds_read_b64_tr_b16 v[98:99], v18 offset:12288
  ds_read_b64_tr_b16 v[102:103], v19 offset:12288
  ds_read_b64_tr_b16 v[106:107], v20 offset:12288
  ds_read_b64_tr_b16 v[110:111], v21 offset:12288
  v_cvt_pk_bf16_f32 v120, v112, v113
  v_cvt_pk_bf16_f32 v121, v114, v115
  v_cvt_pk_bf16_f32 v122, v116, v117
  v_cvt_pk_bf16_f32 v123, v118, v119
  v_lshlrev_b32 v112, 16, v120
  v_and_b32 v113, 0xffff0000, v120
  v_lshlrev_b32 v114, 16, v121
  v_and_b32 v115, 0xffff0000, v121
  v_lshlrev_b32 v116, 16, v122
  v_and_b32 v117, 0xffff0000, v122
  v_lshlrev_b32 v118, 16, v123
  v_and_b32 v119, 0xffff0000, v123
  v_mul_f32 v112, s58, v112
  v_mul_f32 v113, s58, v113
  v_mul_f32 v114, s58, v114
  v_mul_f32 v115, s58, v115
  v_mul_f32 v116, s58, v116
  v_mul_f32 v117, s58, v117
  v_mul_f32 v118, s58, v118
  v_mul_f32 v119, s58, v119
  v_cvt_pk_bf16_f32 v120, v112, v113
  v_cvt_pk_bf16_f32 v121, v114, v115
  v_cvt_pk_bf16_f32 v122, v116, v117
  v_cvt_pk_bf16_f32 v123, v118, v119
  v_lshlrev_b32 v112, 16, v120
  v_and_b32 v113, 0xffff0000, v120
  v_lshlrev_b32 v114, 16, v121
  v_and_b32 v115, 0xffff0000, v121
  v_lshlrev_b32 v116, 16, v122
  v_and_b32 v117, 0xffff0000, v122
  v_lshlrev_b32 v118, 16, v123
  v_and_b32 v119, 0xffff0000, v123
  v_max3_f32 v124, v112, v113, v114
  v_max3_f32 v125, v115, v116, v117
  v_max3_f32 v124, v124, v118, v119
  v_max_f32 v124, v124, v125
  v_mov_b32 v125, v124
  s_nop 1
  v_permlane16_swap_b32 v124, v125
  v_max_f32 v124, v124, v125
  v_mov_b32 v125, v124
  s_nop 1
  v_permlane32_swap_b32 v124, v125
  v_max_f32 v124, v124, v125
  v_mul_f32 v124, s62, v124
  v_max_f32 v124, v124, v22
  v_sub_f32 v24, v22, v124
  v_exp_f32 v24, v24
  v_mov_b32 v22, v124
  v_fma_f32 v112, v112, s62, -v22
  v_fma_f32 v113, v113, s62, -v22
  v_fma_f32 v114, v114, s62, -v22
  v_fma_f32 v115, v115, s62, -v22
  v_fma_f32 v116, v116, s62, -v22
  v_fma_f32 v117, v117, s62, -v22
  v_fma_f32 v118, v118, s62, -v22
  v_fma_f32 v119, v119, s62, -v22
  v_exp_f32 v112, v112
  v_exp_f32 v113, v113
  v_exp_f32 v114, v114
  v_exp_f32 v115, v115
  v_exp_f32 v116, v116
  v_exp_f32 v117, v117
  v_exp_f32 v118, v118
  v_exp_f32 v119, v119
  v_mul_f32 v23, v23, v24
  v_cvt_pk_bf16_f32 v120, v112, v113
  v_cvt_pk_bf16_f32 v121, v114, v115
  v_cvt_pk_bf16_f32 v122, v116, v117
  v_cvt_pk_bf16_f32 v123, v118, v119
  v_add_f32 v124, v112, v113
  v_add_f32 v125, v114, v115
  v_add_f32 v124, v124, v116
  v_add_f32 v125, v125, v117
  v_add_f32 v124, v124, v118
  v_add_f32 v125, v125, v119
  v_add_f32 v124, v124, v125
  v_add_f32 v23, v23, v124
  v_mul_f32_dpp v48, v24, v48 quad_perm:[0,0,0,0] row_mask:0xf bank_mask:0xf
  v_mul_f32_dpp v49, v24, v49 quad_perm:[1,1,1,1] row_mask:0xf bank_mask:0xf
  v_mul_f32_dpp v50, v24, v50 quad_perm:[2,2,2,2] row_mask:0xf bank_mask:0xf
  v_mul_f32_dpp v51, v24, v51 quad_perm:[3,3,3,3] row_mask:0xf bank_mask:0xf
  v_mul_f32_dpp v52, v24, v52 quad_perm:[0,0,0,0] row_mask:0xf bank_mask:0xf
  v_mul_f32_dpp v53, v24, v53 quad_perm:[1,1,1,1] row_mask:0xf bank_mask:0xf
  v_mul_f32_dpp v54, v24, v54 quad_perm:[2,2,2,2] row_mask:0xf bank_mask:0xf
  v_mul_f32_dpp v55, v24, v55 quad_perm:[3,3,3,3] row_mask:0xf bank_mask:0xf
  v_mul_f32_dpp v56, v24, v56 quad_perm:[0,0,0,0] row_mask:0xf bank_mask:0xf
  v_mul_f32_dpp v57, v24, v57 quad_perm:[1,1,1,1] row_mask:0xf bank_mask:0xf
  v_mul_f32_dpp v58, v24, v58 quad_perm:[2,2,2,2] row_mask:0xf bank_mask:0xf
  v_mul_f32_dpp v59, v24, v59 quad_perm:[3,3,3,3] row_mask:0xf bank_mask:0xf
  v_mul_f32_dpp v60, v24, v60 quad_perm:[0,0,0,0] row_mask:0xf bank_mask:0xf
  v_mul_f32_dpp v61, v24, v61 quad_perm:[1,1,1,1] row_mask:0xf bank_mask:0xf
  v_mul_f32_dpp v62, v24, v62 quad_perm:[2,2,2,2] row_mask:0xf bank_mask:0xf
  v_mul_f32_dpp v63, v24, v63 quad_perm:[3,3,3,3] row_mask:0xf bank_mask:0xf
  v_mul_f32_dpp v64, v24, v64 quad_perm:[0,0,0,0] row_mask:0xf bank_mask:0xf
  v_mul_f32_dpp v65, v24, v65 quad_perm:[1,1,1,1] row_mask:0xf bank_mask:0xf
  v_mul_f32_dpp v66, v24, v66 quad_perm:[2,2,2,2] row_mask:0xf bank_mask:0xf
  v_mul_f32_dpp v67, v24, v67 quad_perm:[3,3,3,3] row_mask:0xf bank_mask:0xf
  v_mul_f32_dpp v68, v24, v68 quad_perm:[0,0,0,0] row_mask:0xf bank_mask:0xf
  v_mul_f32_dpp v69, v24, v69 quad_perm:[1,1,1,1] row_mask:0xf bank_mask:0xf
  v_mul_f32_dpp v70, v24, v70 quad_perm:[2,2,2,2] row_mask:0xf bank_mask:0xf
  v_mul_f32_dpp v71, v24, v71 quad_perm:[3,3,3,3] row_mask:0xf bank_mask:0xf
  v_mul_f32_dpp v72, v24, v72 quad_perm:[0,0,0,0] row_mask:0xf bank_mask:0xf
  v_mul_f32_dpp v73, v24, v73 quad_perm:[1,1,1,1] row_mask:0xf bank_mask:0xf
  v_mul_f32_dpp v74, v24, v74 quad_perm:[2,2,2,2] row_mask:0xf bank_mask:0xf
  v_mul_f32_dpp v75, v24, v75 quad_perm:[3,3,3,3] row_mask:0xf bank_mask:0xf
  v_mul_f32_dpp v76, v24, v76 quad_perm:[0,0,0,0] row_mask:0xf bank_mask:0xf
  v_mul_f32_dpp v77, v24, v77 quad_perm:[1,1,1,1] row_mask:0xf bank_mask:0xf
  v_mul_f32_dpp v78, v24, v78 quad_perm:[2,2,2,2] row_mask:0xf bank_mask:0xf
  v_mul_f32_dpp v79, v24, v79 quad_perm:[3,3,3,3] row_mask:0xf bank_mask:0xf
  s_waitcnt lgkmcnt(0)
  v_mfma_f32_16x16x32_bf16 v[48:51], v[120:123], v[80:83], v[48:51]
  v_mfma_f32_16x16x32_bf16 v[52:55], v[120:123], v[84:87], v[52:55]
  v_mfma_f32_16x16x32_bf16 v[56:59], v[120:123], v[88:91], v[56:59]
  v_mfma_f32_16x16x32_bf16 v[60:63], v[120:123], v[92:95], v[60:63]
  v_mfma_f32_16x16x32_bf16 v[64:67], v[120:123], v[96:99], v[64:67]
  v_mfma_f32_16x16x32_bf16 v[68:71], v[120:123], v[100:103], v[68:71]
  v_mfma_f32_16x16x32_bf16 v[72:75], v[120:123], v[104:107], v[72:75]
  v_mfma_f32_16x16x32_bf16 v[76:79], v[120:123], v[108:111], v[76:79]
  s_nop 7
  s_branch L_ddone_11
L_dt1_10:
  s_lshl_b32 s31, s29, 6
  s_add_u32 s31, s31, 24
  s_lshl_b32 s31, s31, 13
  s_add_u32 s31, s31, s68
  s_add_u32 s32, s6, s31
  s_addc_u32 s33, s7, 0
  s_add_u32 s34, s32, 16384
  s_addc_u32 s35, s33, 0
  s_add_u32 s36, s8, s31
  s_addc_u32 s37, s9, 0
  s_add_u32 s38, s36, 16384
  s_addc_u32 s39, s37, 0
  v_mfma_f32_16x16x32_bf16 v[112:115], v[80:83], v[32:35], 0
  v_mfma_f32_16x16x32_bf16 v[112:115], v[84:87], v[36:39], v[112:115]
  v_mfma_f32_16x16x32_bf16 v[112:115], v[88:91], v[40:43], v[112:115]
  v_mfma_f32_16x16x32_bf16 v[112:115], v[92:95], v[44:47], v[112:115]
  v_mfma_f32_16x16x32_bf16 v[116:119], v[96:99], v[32:35], 0
  v_mfma_f32_16x16x32_bf16 v[116:119], v[100:103], v[36:39], v[116:119]
  v_mfma_f32_16x16x32_bf16 v[116:119], v[104:107], v[40:43], v[116:119]
  v_mfma_f32_16x16x32_bf16 v[116:119], v[108:111], v[44:47], v[116:119]
  s_add_u32 m0, s47, 0
  s_nop 0
  global_load_lds_dwordx4 v4, s[32:33] offset:0 nt
  global_load_lds_dwordx4 v5, s[32:33] offset:1024 nt
  global_load_lds_dwordx4 v6, s[32:33] offset:2048 nt
  global_load_lds_dwordx4 v7, s[32:33] offset:3072 nt
  s_add_u32 m0, s47, 4096
  s_nop 0
  global_load_lds_dwordx4 v4, s[34:35] offset:0 nt
  global_load_lds_dwordx4 v5, s[34:35] offset:1024 nt
  global_load_lds_dwordx4 v6, s[34:35] offset:2048 nt
  global_load_lds_dwordx4 v7, s[34:35] offset:3072 nt
  s_waitcnt vmcnt(24)
  ds_read_b64_tr_b16 v[80:81], v14 offset:8192
  ds_read_b64_tr_b16 v[84:85], v15 offset:8192
  ds_read_b64_tr_b16 v[88:89], v16 offset:8192
  ds_read_b64_tr_b16 v[92:93], v17 offset:8192
  ds_read_b64_tr_b16 v[96:97], v18 offset:8192
  ds_read_b64_tr_b16 v[100:101], v19 offset:8192
  ds_read_b64_tr_b16 v[104:105], v20 offset:8192
  ds_read_b64_tr_b16 v[108:109], v21 offset:8192
  ds_read_b64_tr_b16 v[82:83], v14 offset:12288
  ds_read_b64_tr_b16 v[86:87], v15 offset:12288
  ds_read_b64_tr_b16 v[90:91], v16 offset:12288
  ds_read_b64_tr_b16 v[94:95], v17 offset:12288
  ds_read_b64_tr_b16 v[98:99], v18 offset:12288
  ds_read_b64_tr_b16 v[102:103], v19 offset:12288
  ds_read_b64_tr_b16 v[106:107], v20 offset:12288
  ds_read_b64_tr_b16 v[110:111], v21 offset:12288
  v_cvt_pk_bf16_f32 v120, v112, v113
  v_cvt_pk_bf16_f32 v121, v114, v115
  v_cvt_pk_bf16_f32 v122, v116, v117
  v_cvt_pk_bf16_f32 v123, v118, v119
  v_lshlrev_b32 v112, 16, v120
  v_and_b32 v113, 0xffff0000, v120
  v_lshlrev_b32 v114, 16, v121
  v_and_b32 v115, 0xffff0000, v121
  v_lshlrev_b32 v116, 16, v122
  v_and_b32 v117, 0xffff0000, v122
  v_lshlrev_b32 v118, 16, v123
  v_and_b32 v119, 0xffff0000, v123
  v_mul_f32 v112, s58, v112
  v_mul_f32 v113, s58, v113
  v_mul_f32 v114, s58, v114
  v_mul_f32 v115, s58, v115
  v_mul_f32 v116, s58, v116
  v_mul_f32 v117, s58, v117
  v_mul_f32 v118, s58, v118
  v_mul_f32 v119, s58, v119
  v_cvt_pk_bf16_f32 v120, v112, v113
  v_cvt_pk_bf16_f32 v121, v114, v115
  v_cvt_pk_bf16_f32 v122, v116, v117
  v_cvt_pk_bf16_f32 v123, v118, v119
  v_lshlrev_b32 v112, 16, v120
  v_and_b32 v113, 0xffff0000, v120
  v_lshlrev_b32 v114, 16, v121
  v_and_b32 v115, 0xffff0000, v121
  v_lshlrev_b32 v116, 16, v122
  v_and_b32 v117, 0xffff0000, v122
  v_lshlrev_b32 v118, 16, v123
  v_and_b32 v119, 0xffff0000, v123
  v_max3_f32 v124, v112, v113, v114
  v_max3_f32 v125, v115, v116, v117
  v_max3_f32 v124, v124, v118, v119
  v_max_f32 v124, v124, v125
  v_mov_b32 v125, v124
  s_nop 1
  v_permlane16_swap_b32 v124, v125
  v_max_f32 v124, v124, v125
  v_mov_b32 v125, v124
  s_nop 1
  v_permlane32_swap_b32 v124, v125
  v_max_f32 v124, v124, v125
  v_mul_f32 v124, s62, v124
  v_max_f32 v124, v124, v22
  v_sub_f32 v24, v22, v124
  v_exp_f32 v24, v24
  v_mov_b32 v22, v124
  v_fma_f32 v112, v112, s62, -v22
  v_fma_f32 v113, v113, s62, -v22
  v_fma_f32 v114, v114, s62, -v22
  v_fma_f32 v115, v115, s62, -v22
  v_fma_f32 v116, v116, s62, -v22
  v_fma_f32 v117, v117, s62, -v22
  v_fma_f32 v118, v118, s62, -v22
  v_fma_f32 v119, v119, s62, -v22
  v_exp_f32 v112, v112
  v_exp_f32 v113, v113
  v_exp_f32 v114, v114
  v_exp_f32 v115, v115
  v_exp_f32 v116, v116
  v_exp_f32 v117, v117
  v_exp_f32 v118, v118
  v_exp_f32 v119, v119
  v_mul_f32 v23, v23, v24
  v_cvt_pk_bf16_f32 v120, v112, v113
  v_cvt_pk_bf16_f32 v121, v114, v115
  v_cvt_pk_bf16_f32 v122, v116, v117
  v_cvt_pk_bf16_f32 v123, v118, v119
  v_add_f32 v124, v112, v113
  v_add_f32 v125, v114, v115
  v_add_f32 v124, v124, v116
  v_add_f32 v125, v125, v117
  v_add_f32 v124, v124, v118
  v_add_f32 v125, v125, v119
  v_add_f32 v124, v124, v125
  v_add_f32 v23, v23, v124
  v_mul_f32_dpp v48, v24, v48 quad_perm:[0,0,0,0] row_mask:0xf bank_mask:0xf
  v_mul_f32_dpp v49, v24, v49 quad_perm:[1,1,1,1] row_mask:0xf bank_mask:0xf
  v_mul_f32_dpp v50, v24, v50 quad_perm:[2,2,2,2] row_mask:0xf bank_mask:0xf
  v_mul_f32_dpp v51, v24, v51 quad_perm:[3,3,3,3] row_mask:0xf bank_mask:0xf
  v_mul_f32_dpp v52, v24, v52 quad_perm:[0,0,0,0] row_mask:0xf bank_mask:0xf
  v_mul_f32_dpp v53, v24, v53 quad_perm:[1,1,1,1] row_mask:0xf bank_mask:0xf
  v_mul_f32_dpp v54, v24, v54 quad_perm:[2,2,2,2] row_mask:0xf bank_mask:0xf
  v_mul_f32_dpp v55, v24, v55 quad_perm:[3,3,3,3] row_mask:0xf bank_mask:0xf
  v_mul_f32_dpp v56, v24, v56 quad_perm:[0,0,0,0] row_mask:0xf bank_mask:0xf
  v_mul_f32_dpp v57, v24, v57 quad_perm:[1,1,1,1] row_mask:0xf bank_mask:0xf
  v_mul_f32_dpp v58, v24, v58 quad_perm:[2,2,2,2] row_mask:0xf bank_mask:0xf
  v_mul_f32_dpp v59, v24, v59 quad_perm:[3,3,3,3] row_mask:0xf bank_mask:0xf
  v_mul_f32_dpp v60, v24, v60 quad_perm:[0,0,0,0] row_mask:0xf bank_mask:0xf
  v_mul_f32_dpp v61, v24, v61 quad_perm:[1,1,1,1] row_mask:0xf bank_mask:0xf
  v_mul_f32_dpp v62, v24, v62 quad_perm:[2,2,2,2] row_mask:0xf bank_mask:0xf
  v_mul_f32_dpp v63, v24, v63 quad_perm:[3,3,3,3] row_mask:0xf bank_mask:0xf
  v_mul_f32_dpp v64, v24, v64 quad_perm:[0,0,0,0] row_mask:0xf bank_mask:0xf
  v_mul_f32_dpp v65, v24, v65 quad_perm:[1,1,1,1] row_mask:0xf bank_mask:0xf
  v_mul_f32_dpp v66, v24, v66 quad_perm:[2,2,2,2] row_mask:0xf bank_mask:0xf
  v_mul_f32_dpp v67, v24, v67 quad_perm:[3,3,3,3] row_mask:0xf bank_mask:0xf
  v_mul_f32_dpp v68, v24, v68 quad_perm:[0,0,0,0] row_mask:0xf bank_mask:0xf
  v_mul_f32_dpp v69, v24, v69 quad_perm:[1,1,1,1] row_mask:0xf bank_mask:0xf
  v_mul_f32_dpp v70, v24, v70 quad_perm:[2,2,2,2] row_mask:0xf bank_mask:0xf
  v_mul_f32_dpp v71, v24, v71 quad_perm:[3,3,3,3] row_mask:0xf bank_mask:0xf
  v_mul_f32_dpp v72, v24, v72 quad_perm:[0,0,0,0] row_mask:0xf bank_mask:0xf
  v_mul_f32_dpp v73, v24, v73 quad_perm:[1,1,1,1] row_mask:0xf bank_mask:0xf
  v_mul_f32_dpp v74, v24, v74 quad_perm:[2,2,2,2] row_mask:0xf bank_mask:0xf
  v_mul_f32_dpp v75, v24, v75 quad_perm:[3,3,3,3] row_mask:0xf bank_mask:0xf
  v_mul_f32_dpp v76, v24, v76 quad_perm:[0,0,0,0] row_mask:0xf bank_mask:0xf
  v_mul_f32_dpp v77, v24, v77 quad_perm:[1,1,1,1] row_mask:0xf bank_mask:0xf
  v_mul_f32_dpp v78, v24, v78 quad_perm:[2,2,2,2] row_mask:0xf bank_mask:0xf
  v_mul_f32_dpp v79, v24, v79 quad_perm:[3,3,3,3] row_mask:0xf bank_mask:0xf
  s_waitcnt lgkmcnt(0)
  v_mfma_f32_16x16x32_bf16 v[48:51], v[120:123], v[80:83], v[48:51]
  v_mfma_f32_16x16x32_bf16 v[52:55], v[120:123], v[84:87], v[52:55]
  v_mfma_f32_16x16x32_bf16 v[56:59], v[120:123], v[88:91], v[56:59]
  v_mfma_f32_16x16x32_bf16 v[60:63], v[120:123], v[92:95], v[60:63]
  v_mfma_f32_16x16x32_bf16 v[64:67], v[120:123], v[96:99], v[64:67]
  v_mfma_f32_16x16x32_bf16 v[68:71], v[120:123], v[100:103], v[68:71]
  v_mfma_f32_16x16x32_bf16 v[72:75], v[120:123], v[104:107], v[72:75]
  v_mfma_f32_16x16x32_bf16 v[76:79], v[120:123], v[108:111], v[76:79]
  s_add_u32 m0, s47, 8192
  s_nop 0
  global_load_lds_dwordx4 v8, s[36:37] offset:0 nt
  global_load_lds_dwordx4 v9, s[36:37] offset:1024 nt
  global_load_lds_dwordx4 v8, s[36:37] offset:2048 nt
  global_load_lds_dwordx4 v9, s[36:37] offset:3072 nt
  s_add_u32 m0, s47, 12288
  s_nop 0
  global_load_lds_dwordx4 v8, s[38:39] offset:0 nt
  global_load_lds_dwordx4 v9, s[38:39] offset:1024 nt
  global_load_lds_dwordx4 v8, s[38:39] offset:2048 nt
  global_load_lds_dwordx4 v9, s[38:39] offset:3072 nt
  s_waitcnt vmcnt(24)
  ds_read_b128 v[80:83], v10 offset:16384
  ds_read_b128 v[84:87], v11 offset:16384
  ds_read_b128 v[88:91], v12 offset:16384
  ds_read_b128 v[92:95], v13 offset:16384
  ds_read_b128 v[96:99], v10 offset:20480
  ds_read_b128 v[100:103], v11 offset:20480
  ds_read_b128 v[104:107], v12 offset:20480
  ds_read_b128 v[108:111], v13 offset:20480
  s_waitcnt lgkmcnt(0)
  s_lshl_b32 s31, s29, 6
  s_add_u32 s31, s31, 28
  s_lshl_b32 s31, s31, 13
  s_add_u32 s31, s31, s68
  s_add_u32 s32, s6, s31
  s_addc_u32 s33, s7, 0
  s_add_u32 s34, s32, 16384
  s_addc_u32 s35, s33, 0
  s_add_u32 s36, s8, s31
  s_addc_u32 s37, s9, 0
  s_add_u32 s38, s36, 16384
  s_addc_u32 s39, s37, 0
  v_mfma_f32_16x16x32_bf16 v[112:115], v[80:83], v[32:35], 0
  v_mfma_f32_16x16x32_bf16 v[112:115], v[84:87], v[36:39], v[112:115]
  v_mfma_f32_16x16x32_bf16 v[112:115], v[88:91], v[40:43], v[112:115]
  v_mfma_f32_16x16x32_bf16 v[112:115], v[92:95], v[44:47], v[112:115]
  v_mfma_f32_16x16x32_bf16 v[116:119], v[96:99], v[32:35], 0
  v_mfma_f32_16x16x32_bf16 v[116:119], v[100:103], v[36:39], v[116:119]
  v_mfma_f32_16x16x32_bf16 v[116:119], v[104:107], v[40:43], v[116:119]
  v_mfma_f32_16x16x32_bf16 v[116:119], v[108:111], v[44:47], v[116:119]
  s_add_u32 m0, s47, 16384
  s_nop 0
  global_load_lds_dwordx4 v4, s[32:33] offset:0 nt
  global_load_lds_dwordx4 v5, s[32:33] offset:1024 nt
  global_load_lds_dwordx4 v6, s[32:33] offset:2048 nt
  global_load_lds_dwordx4 v7, s[32:33] offset:3072 nt
  s_add_u32 m0, s47, 20480
  s_nop 0
  global_load_lds_dwordx4 v4, s[34:35] offset:0 nt
  global_load_lds_dwordx4 v5, s[34:35] offset:1024 nt
  global_load_lds_dwordx4 v6, s[34:35] offset:2048 nt
  global_load_lds_dwordx4 v7, s[34:35] offset:3072 nt
  s_waitcnt vmcnt(24)
  ds_read_b64_tr_b16 v[80:81], v14 offset:24576
  ds_read_b64_tr_b16 v[84:85], v15 offset:24576
  ds_read_b64_tr_b16 v[88:89], v16 offset:24576
  ds_read_b64_tr_b16 v[92:93], v17 offset:24576
  ds_read_b64_tr_b16 v[96:97], v18 offset:24576
  ds_read_b64_tr_b16 v[100:101], v19 offset:24576
  ds_read_b64_tr_b16 v[104:105], v20 offset:24576
  ds_read_b64_tr_b16 v[108:109], v21 offset:24576
  ds_read_b64_tr_b16 v[82:83], v14 offset:28672
  ds_read_b64_tr_b16 v[86:87], v15 offset:28672
  ds_read_b64_tr_b16 v[90:91], v16 offset:28672
  ds_read_b64_tr_b16 v[94:95], v17 offset:28672
  ds_read_b64_tr_b16 v[98:99], v18 offset:28672
  ds_read_b64_tr_b16 v[102:103], v19 offset:28672
  ds_read_b64_tr_b16 v[106:107], v20 offset:28672
  ds_read_b64_tr_b16 v[110:111], v21 offset:28672
  v_cvt_pk_bf16_f32 v120, v112, v113
  v_cvt_pk_bf16_f32 v121, v114, v115
  v_cvt_pk_bf16_f32 v122, v116, v117
  v_cvt_pk_bf16_f32 v123, v118, v119
  v_lshlrev_b32 v112, 16, v120
  v_and_b32 v113, 0xffff0000, v120
  v_lshlrev_b32 v114, 16, v121
  v_and_b32 v115, 0xffff0000, v121
  v_lshlrev_b32 v116, 16, v122
  v_and_b32 v117, 0xffff0000, v122
  v_lshlrev_b32 v118, 16, v123
  v_and_b32 v119, 0xffff0000, v123
  v_mul_f32 v112, s58, v112
  v_mul_f32 v113, s58, v113
  v_mul_f32 v114, s58, v114
  v_mul_f32 v115, s58, v115
  v_mul_f32 v116, s58, v116
  v_mul_f32 v117, s58, v117
  v_mul_f32 v118, s58, v118
  v_mul_f32 v119, s58, v119
  v_cvt_pk_bf16_f32 v120, v112, v113
  v_cvt_pk_bf16_f32 v121, v114, v115
  v_cvt_pk_bf16_f32 v122, v116, v117
  v_cvt_pk_bf16_f32 v123, v118, v119
  v_lshlrev_b32 v112, 16, v120
  v_and_b32 v113, 0xffff0000, v120
  v_lshlrev_b32 v114, 16, v121
  v_and_b32 v115, 0xffff0000, v121
  v_lshlrev_b32 v116, 16, v122
  v_and_b32 v117, 0xffff0000, v122
  v_lshlrev_b32 v118, 16, v123
  v_and_b32 v119, 0xffff0000, v123
  v_max3_f32 v124, v112, v113, v114
  v_max3_f32 v125, v115, v116, v117
  v_max3_f32 v124, v124, v118, v119
  v_max_f32 v124, v124, v125
  v_mov_b32 v125, v124
  s_nop 1
  v_permlane16_swap_b32 v124, v125
  v_max_f32 v124, v124, v125
  v_mov_b32 v125, v124
  s_nop 1
  v_permlane32_swap_b32 v124, v125
  v_max_f32 v124, v124, v125
  v_mul_f32 v124, s62, v124
  v_max_f32 v124, v124, v22
  v_sub_f32 v24, v22, v124
  v_exp_f32 v24, v24
  v_mov_b32 v22, v124
  v_fma_f32 v112, v112, s62, -v22
  v_fma_f32 v113, v113, s62, -v22
  v_fma_f32 v114, v114, s62, -v22
  v_fma_f32 v115, v115, s62, -v22
  v_fma_f32 v116, v116, s62, -v22
  v_fma_f32 v117, v117, s62, -v22
  v_fma_f32 v118, v118, s62, -v22
  v_fma_f32 v119, v119, s62, -v22
  v_exp_f32 v112, v112
  v_exp_f32 v113, v113
  v_exp_f32 v114, v114
  v_exp_f32 v115, v115
  v_exp_f32 v116, v116
  v_exp_f32 v117, v117
  v_exp_f32 v118, v118
  v_exp_f32 v119, v119
  v_mul_f32 v23, v23, v24
  v_cvt_pk_bf16_f32 v120, v112, v113
  v_cvt_pk_bf16_f32 v121, v114, v115
  v_cvt_pk_bf16_f32 v122, v116, v117
  v_cvt_pk_bf16_f32 v123, v118, v119
  v_add_f32 v124, v112, v113
  v_add_f32 v125, v114, v115
  v_add_f32 v124, v124, v116
  v_add_f32 v125, v125, v117
  v_add_f32 v124, v124, v118
  v_add_f32 v125, v125, v119
  v_add_f32 v124, v124, v125
  v_add_f32 v23, v23, v124
  v_mul_f32_dpp v48, v24, v48 quad_perm:[0,0,0,0] row_mask:0xf bank_mask:0xf
  v_mul_f32_dpp v49, v24, v49 quad_perm:[1,1,1,1] row_mask:0xf bank_mask:0xf
  v_mul_f32_dpp v50, v24, v50 quad_perm:[2,2,2,2] row_mask:0xf bank_mask:0xf
  v_mul_f32_dpp v51, v24, v51 quad_perm:[3,3,3,3] row_mask:0xf bank_mask:0xf
  v_mul_f32_dpp v52, v24, v52 quad_perm:[0,0,0,0] row_mask:0xf bank_mask:0xf
  v_mul_f32_dpp v53, v24, v53 quad_perm:[1,1,1,1] row_mask:0xf bank_mask:0xf
  v_mul_f32_dpp v54, v24, v54 quad_perm:[2,2,2,2] row_mask:0xf bank_mask:0xf
  v_mul_f32_dpp v55, v24, v55 quad_perm:[3,3,3,3] row_mask:0xf bank_mask:0xf
  v_mul_f32_dpp v56, v24, v56 quad_perm:[0,0,0,0] row_mask:0xf bank_mask:0xf
  v_mul_f32_dpp v57, v24, v57 quad_perm:[1,1,1,1] row_mask:0xf bank_mask:0xf
  v_mul_f32_dpp v58, v24, v58 quad_perm:[2,2,2,2] row_mask:0xf bank_mask:0xf
  v_mul_f32_dpp v59, v24, v59 quad_perm:[3,3,3,3] row_mask:0xf bank_mask:0xf
  v_mul_f32_dpp v60, v24, v60 quad_perm:[0,0,0,0] row_mask:0xf bank_mask:0xf
  v_mul_f32_dpp v61, v24, v61 quad_perm:[1,1,1,1] row_mask:0xf bank_mask:0xf
  v_mul_f32_dpp v62, v24, v62 quad_perm:[2,2,2,2] row_mask:0xf bank_mask:0xf
  v_mul_f32_dpp v63, v24, v63 quad_perm:[3,3,3,3] row_mask:0xf bank_mask:0xf
  v_mul_f32_dpp v64, v24, v64 quad_perm:[0,0,0,0] row_mask:0xf bank_mask:0xf
  v_mul_f32_dpp v65, v24, v65 quad_perm:[1,1,1,1] row_mask:0xf bank_mask:0xf
  v_mul_f32_dpp v66, v24, v66 quad_perm:[2,2,2,2] row_mask:0xf bank_mask:0xf
  v_mul_f32_dpp v67, v24, v67 quad_perm:[3,3,3,3] row_mask:0xf bank_mask:0xf
  v_mul_f32_dpp v68, v24, v68 quad_perm:[0,0,0,0] row_mask:0xf bank_mask:0xf
  v_mul_f32_dpp v69, v24, v69 quad_perm:[1,1,1,1] row_mask:0xf bank_mask:0xf
  v_mul_f32_dpp v70, v24, v70 quad_perm:[2,2,2,2] row_mask:0xf bank_mask:0xf
  v_mul_f32_dpp v71, v24, v71 quad_perm:[3,3,3,3] row_mask:0xf bank_mask:0xf
  v_mul_f32_dpp v72, v24, v72 quad_perm:[0,0,0,0] row_mask:0xf bank_mask:0xf
  v_mul_f32_dpp v73, v24, v73 quad_perm:[1,1,1,1] row_mask:0xf bank_mask:0xf
  v_mul_f32_dpp v74, v24, v74 quad_perm:[2,2,2,2] row_mask:0xf bank_mask:0xf
  v_mul_f32_dpp v75, v24, v75 quad_perm:[3,3,3,3] row_mask:0xf bank_mask:0xf
  v_mul_f32_dpp v76, v24, v76 quad_perm:[0,0,0,0] row_mask:0xf bank_mask:0xf
  v_mul_f32_dpp v77, v24, v77 quad_perm:[1,1,1,1] row_mask:0xf bank_mask:0xf
  v_mul_f32_dpp v78, v24, v78 quad_perm:[2,2,2,2] row_mask:0xf bank_mask:0xf
  v_mul_f32_dpp v79, v24, v79 quad_perm:[3,3,3,3] row_mask:0xf bank_mask:0xf
  s_waitcnt lgkmcnt(0)
  v_mfma_f32_16x16x32_bf16 v[48:51], v[120:123], v[80:83], v[48:51]
  v_mfma_f32_16x16x32_bf16 v[52:55], v[120:123], v[84:87], v[52:55]
  v_mfma_f32_16x16x32_bf16 v[56:59], v[120:123], v[88:91], v[56:59]
  v_mfma_f32_16x16x32_bf16 v[60:63], v[120:123], v[92:95], v[60:63]
  v_mfma_f32_16x16x32_bf16 v[64:67], v[120:123], v[96:99], v[64:67]
  v_mfma_f32_16x16x32_bf16 v[68:71], v[120:123], v[100:103], v[68:71]
  v_mfma_f32_16x16x32_bf16 v[72:75], v[120:123], v[104:107], v[72:75]
  v_mfma_f32_16x16x32_bf16 v[76:79], v[120:123], v[108:111], v[76:79]
  s_add_u32 m0, s47, 24576
  s_nop 0
  global_load_lds_dwordx4 v8, s[36:37] offset:0 nt
  global_load_lds_dwordx4 v9, s[36:37] offset:1024 nt
  global_load_lds_dwordx4 v8, s[36:37] offset:2048 nt
  global_load_lds_dwordx4 v9, s[36:37] offset:3072 nt
  s_add_u32 m0, s47, 28672
  s_nop 0
  global_load_lds_dwordx4 v8, s[38:39] offset:0 nt
  global_load_lds_dwordx4 v9, s[38:39] offset:1024 nt
  global_load_lds_dwordx4 v8, s[38:39] offset:2048 nt
  global_load_lds_dwordx4 v9, s[38:39] offset:3072 nt
  s_waitcnt vmcnt(24)
  ds_read_b128 v[80:83], v10 offset:0
  ds_read_b128 v[84:87], v11 offset:0
  ds_read_b128 v[88:91], v12 offset:0
  ds_read_b128 v[92:95], v13 offset:0
  ds_read_b128 v[96:99], v10 offset:4096
  ds_read_b128 v[100:103], v11 offset:4096
  ds_read_b128 v[104:107], v12 offset:4096
  ds_read_b128 v[108:111], v13 offset:4096
  s_waitcnt lgkmcnt(0)
  v_mfma_f32_16x16x32_bf16 v[112:115], v[80:83], v[32:35], 0
  v_mfma_f32_16x16x32_bf16 v[112:115], v[84:87], v[36:39], v[112:115]
  v_mfma_f32_16x16x32_bf16 v[112:115], v[88:91], v[40:43], v[112:115]
  v_mfma_f32_16x16x32_bf16 v[112:115], v[92:95], v[44:47], v[112:115]
  v_mfma_f32_16x16x32_bf16 v[116:119], v[96:99], v[32:35], 0
  v_mfma_f32_16x16x32_bf16 v[116:119], v[100:103], v[36:39], v[116:119]
  v_mfma_f32_16x16x32_bf16 v[116:119], v[104:107], v[40:43], v[116:119]
  v_mfma_f32_16x16x32_bf16 v[116:119], v[108:111], v[44:47], v[116:119]
  s_waitcnt vmcnt(16)
  ds_read_b64_tr_b16 v[80:81], v14 offset:8192
  ds_read_b64_tr_b16 v[84:85], v15 offset:8192
  ds_read_b64_tr_b16 v[88:89], v16 offset:8192
  ds_read_b64_tr_b16 v[92:93], v17 offset:8192
  ds_read_b64_tr_b16 v[96:97], v18 offset:8192
  ds_read_b64_tr_b16 v[100:101], v19 offset:8192
  ds_read_b64_tr_b16 v[104:105], v20 offset:8192
  ds_read_b64_tr_b16 v[108:109], v21 offset:8192
  ds_read_b64_tr_b16 v[82:83], v14 offset:12288
  ds_read_b64_tr_b16 v[86:87], v15 offset:12288
  ds_read_b64_tr_b16 v[90:91], v16 offset:12288
  ds_read_b64_tr_b16 v[94:95], v17 offset:12288
  ds_read_b64_tr_b16 v[98:99], v18 offset:12288
  ds_read_b64_tr_b16 v[102:103], v19 offset:12288
  ds_read_b64_tr_b16 v[106:107], v20 offset:12288
  ds_read_b64_tr_b16 v[110:111], v21 offset:12288
  v_cvt_pk_bf16_f32 v120, v112, v113
  v_cvt_pk_bf16_f32 v121, v114, v115
  v_cvt_pk_bf16_f32 v122, v116, v117
  v_cvt_pk_bf16_f32 v123, v118, v119
  v_lshlrev_b32 v112, 16, v120
  v_and_b32 v113, 0xffff0000, v120
  v_lshlrev_b32 v114, 16, v121
  v_and_b32 v115, 0xffff0000, v121
  v_lshlrev_b32 v116, 16, v122
  v_and_b32 v117, 0xffff0000, v122
  v_lshlrev_b32 v118, 16, v123
  v_and_b32 v119, 0xffff0000, v123
  v_mul_f32 v112, s58, v112
  v_mul_f32 v113, s58, v113
  v_mul_f32 v114, s58, v114
  v_mul_f32 v115, s58, v115
  v_mul_f32 v116, s58, v116
  v_mul_f32 v117, s58, v117
  v_mul_f32 v118, s58, v118
  v_mul_f32 v119, s58, v119
  v_cvt_pk_bf16_f32 v120, v112, v113
  v_cvt_pk_bf16_f32 v121, v114, v115
  v_cvt_pk_bf16_f32 v122, v116, v117
  v_cvt_pk_bf16_f32 v123, v118, v119
  v_lshlrev_b32 v112, 16, v120
  v_and_b32 v113, 0xffff0000, v120
  v_lshlrev_b32 v114, 16, v121
  v_and_b32 v115, 0xffff0000, v121
  v_lshlrev_b32 v116, 16, v122
  v_and_b32 v117, 0xffff0000, v122
  v_lshlrev_b32 v118, 16, v123
  v_and_b32 v119, 0xffff0000, v123
  v_max3_f32 v124, v112, v113, v114
  v_max3_f32 v125, v115, v116, v117
  v_max3_f32 v124, v124, v118, v119
  v_max_f32 v124, v124, v125
  v_mov_b32 v125, v124
  s_nop 1
  v_permlane16_swap_b32 v124, v125
  v_max_f32 v124, v124, v125
  v_mov_b32 v125, v124
  s_nop 1
  v_permlane32_swap_b32 v124, v125
  v_max_f32 v124, v124, v125
  v_mul_f32 v124, s62, v124
  v_max_f32 v124, v124, v22
  v_sub_f32 v24, v22, v124
  v_exp_f32 v24, v24
  v_mov_b32 v22, v124
  v_fma_f32 v112, v112, s62, -v22
  v_fma_f32 v113, v113, s62, -v22
  v_fma_f32 v114, v114, s62, -v22
  v_fma_f32 v115, v115, s62, -v22
  v_fma_f32 v116, v116, s62, -v22
  v_fma_f32 v117, v117, s62, -v22
  v_fma_f32 v118, v118, s62, -v22
  v_fma_f32 v119, v119, s62, -v22
  v_exp_f32 v112, v112
  v_exp_f32 v113, v113
  v_exp_f32 v114, v114
  v_exp_f32 v115, v115
  v_exp_f32 v116, v116
  v_exp_f32 v117, v117
  v_exp_f32 v118, v118
  v_exp_f32 v119, v119
  v_mul_f32 v23, v23, v24
  v_cvt_pk_bf16_f32 v120, v112, v113
  v_cvt_pk_bf16_f32 v121, v114, v115
  v_cvt_pk_bf16_f32 v122, v116, v117
  v_cvt_pk_bf16_f32 v123, v118, v119
  v_add_f32 v124, v112, v113
  v_add_f32 v125, v114, v115
  v_add_f32 v124, v124, v116
  v_add_f32 v125, v125, v117
  v_add_f32 v124, v124, v118
  v_add_f32 v125, v125, v119
  v_add_f32 v124, v124, v125
  v_add_f32 v23, v23, v124
  v_mul_f32_dpp v48, v24, v48 quad_perm:[0,0,0,0] row_mask:0xf bank_mask:0xf
  v_mul_f32_dpp v49, v24, v49 quad_perm:[1,1,1,1] row_mask:0xf bank_mask:0xf
  v_mul_f32_dpp v50, v24, v50 quad_perm:[2,2,2,2] row_mask:0xf bank_mask:0xf
  v_mul_f32_dpp v51, v24, v51 quad_perm:[3,3,3,3] row_mask:0xf bank_mask:0xf
  v_mul_f32_dpp v52, v24, v52 quad_perm:[0,0,0,0] row_mask:0xf bank_mask:0xf
  v_mul_f32_dpp v53, v24, v53 quad_perm:[1,1,1,1] row_mask:0xf bank_mask:0xf
  v_mul_f32_dpp v54, v24, v54 quad_perm:[2,2,2,2] row_mask:0xf bank_mask:0xf
  v_mul_f32_dpp v55, v24, v55 quad_perm:[3,3,3,3] row_mask:0xf bank_mask:0xf
  v_mul_f32_dpp v56, v24, v56 quad_perm:[0,0,0,0] row_mask:0xf bank_mask:0xf
  v_mul_f32_dpp v57, v24, v57 quad_perm:[1,1,1,1] row_mask:0xf bank_mask:0xf
  v_mul_f32_dpp v58, v24, v58 quad_perm:[2,2,2,2] row_mask:0xf bank_mask:0xf
  v_mul_f32_dpp v59, v24, v59 quad_perm:[3,3,3,3] row_mask:0xf bank_mask:0xf
  v_mul_f32_dpp v60, v24, v60 quad_perm:[0,0,0,0] row_mask:0xf bank_mask:0xf
  v_mul_f32_dpp v61, v24, v61 quad_perm:[1,1,1,1] row_mask:0xf bank_mask:0xf
  v_mul_f32_dpp v62, v24, v62 quad_perm:[2,2,2,2] row_mask:0xf bank_mask:0xf
  v_mul_f32_dpp v63, v24, v63 quad_perm:[3,3,3,3] row_mask:0xf bank_mask:0xf
  v_mul_f32_dpp v64, v24, v64 quad_perm:[0,0,0,0] row_mask:0xf bank_mask:0xf
  v_mul_f32_dpp v65, v24, v65 quad_perm:[1,1,1,1] row_mask:0xf bank_mask:0xf
  v_mul_f32_dpp v66, v24, v66 quad_perm:[2,2,2,2] row_mask:0xf bank_mask:0xf
  v_mul_f32_dpp v67, v24, v67 quad_perm:[3,3,3,3] row_mask:0xf bank_mask:0xf
  v_mul_f32_dpp v68, v24, v68 quad_perm:[0,0,0,0] row_mask:0xf bank_mask:0xf
  v_mul_f32_dpp v69, v24, v69 quad_perm:[1,1,1,1] row_mask:0xf bank_mask:0xf
  v_mul_f32_dpp v70, v24, v70 quad_perm:[2,2,2,2] row_mask:0xf bank_mask:0xf
  v_mul_f32_dpp v71, v24, v71 quad_perm:[3,3,3,3] row_mask:0xf bank_mask:0xf
  v_mul_f32_dpp v72, v24, v72 quad_perm:[0,0,0,0] row_mask:0xf bank_mask:0xf
  v_mul_f32_dpp v73, v24, v73 quad_perm:[1,1,1,1] row_mask:0xf bank_mask:0xf
  v_mul_f32_dpp v74, v24, v74 quad_perm:[2,2,2,2] row_mask:0xf bank_mask:0xf
  v_mul_f32_dpp v75, v24, v75 quad_perm:[3,3,3,3] row_mask:0xf bank_mask:0xf
  v_mul_f32_dpp v76, v24, v76 quad_perm:[0,0,0,0] row_mask:0xf bank_mask:0xf
  v_mul_f32_dpp v77, v24, v77 quad_perm:[1,1,1,1] row_mask:0xf bank_mask:0xf
  v_mul_f32_dpp v78, v24, v78 quad_perm:[2,2,2,2] row_mask:0xf bank_mask:0xf
  v_mul_f32_dpp v79, v24, v79 quad_perm:[3,3,3,3] row_mask:0xf bank_mask:0xf
  s_waitcnt lgkmcnt(0)
  v_mfma_f32_16x16x32_bf16 v[48:51], v[120:123], v[80:83], v[48:51]
  v_mfma_f32_16x16x32_bf16 v[52:55], v[120:123], v[84:87], v[52:55]
  v_mfma_f32_16x16x32_bf16 v[56:59], v[120:123], v[88:91], v[56:59]
  v_mfma_f32_16x16x32_bf16 v[60:63], v[120:123], v[92:95], v[60:63]
  v_mfma_f32_16x16x32_bf16 v[64:67], v[120:123], v[96:99], v[64:67]
  v_mfma_f32_16x16x32_bf16 v[68:71], v[120:123], v[100:103], v[68:71]
  v_mfma_f32_16x16x32_bf16 v[72:75], v[120:123], v[104:107], v[72:75]
  v_mfma_f32_16x16x32_bf16 v[76:79], v[120:123], v[108:111], v[76:79]
  s_waitcnt vmcnt(8)
  ds_read_b128 v[80:83], v10 offset:16384
  ds_read_b128 v[84:87], v11 offset:16384
  ds_read_b128 v[88:91], v12 offset:16384
  ds_read_b128 v[92:95], v13 offset:16384
  ds_read_b128 v[96:99], v10 offset:20480
  ds_read_b128 v[100:103], v11 offset:20480
  ds_read_b128 v[104:107], v12 offset:20480
  ds_read_b128 v[108:111], v13 offset:20480
  s_waitcnt lgkmcnt(0)
  v_mfma_f32_16x16x32_bf16 v[112:115], v[80:83], v[32:35], 0
  v_mfma_f32_16x16x32_bf16 v[112:115], v[84:87], v[36:39], v[112:115]
  v_mfma_f32_16x16x32_bf16 v[112:115], v[88:91], v[40:43], v[112:115]
  v_mfma_f32_16x16x32_bf16 v[112:115], v[92:95], v[44:47], v[112:115]
  v_mfma_f32_16x16x32_bf16 v[116:119], v[96:99], v[32:35], 0
  v_mfma_f32_16x16x32_bf16 v[116:119], v[100:103], v[36:39], v[116:119]
  v_mfma_f32_16x16x32_bf16 v[116:119], v[104:107], v[40:43], v[116:119]
  v_mfma_f32_16x16x32_bf16 v[116:119], v[108:111], v[44:47], v[116:119]
  s_waitcnt vmcnt(0)
  ds_read_b64_tr_b16 v[80:81], v14 offset:24576
  ds_read_b64_tr_b16 v[84:85], v15 offset:24576
  ds_read_b64_tr_b16 v[88:89], v16 offset:24576
  ds_read_b64_tr_b16 v[92:93], v17 offset:24576
  ds_read_b64_tr_b16 v[96:97], v18 offset:24576
  ds_read_b64_tr_b16 v[100:101], v19 offset:24576
  ds_read_b64_tr_b16 v[104:105], v20 offset:24576
  ds_read_b64_tr_b16 v[108:109], v21 offset:24576
  ds_read_b64_tr_b16 v[82:83], v14 offset:28672
  ds_read_b64_tr_b16 v[86:87], v15 offset:28672
  ds_read_b64_tr_b16 v[90:91], v16 offset:28672
  ds_read_b64_tr_b16 v[94:95], v17 offset:28672
  ds_read_b64_tr_b16 v[98:99], v18 offset:28672
  ds_read_b64_tr_b16 v[102:103], v19 offset:28672
  ds_read_b64_tr_b16 v[106:107], v20 offset:28672
  ds_read_b64_tr_b16 v[110:111], v21 offset:28672
  v_cvt_pk_bf16_f32 v120, v112, v113
  v_cvt_pk_bf16_f32 v121, v114, v115
  v_cvt_pk_bf16_f32 v122, v116, v117
  v_cvt_pk_bf16_f32 v123, v118, v119
  v_lshlrev_b32 v112, 16, v120
  v_and_b32 v113, 0xffff0000, v120
  v_lshlrev_b32 v114, 16, v121
  v_and_b32 v115, 0xffff0000, v121
  v_lshlrev_b32 v116, 16, v122
  v_and_b32 v117, 0xffff0000, v122
  v_lshlrev_b32 v118, 16, v123
  v_and_b32 v119, 0xffff0000, v123
  v_mul_f32 v112, s58, v112
  v_mul_f32 v113, s58, v113
  v_mul_f32 v114, s58, v114
  v_mul_f32 v115, s58, v115
  v_mul_f32 v116, s58, v116
  v_mul_f32 v117, s58, v117
  v_mul_f32 v118, s58, v118
  v_mul_f32 v119, s58, v119
  v_cvt_pk_bf16_f32 v120, v112, v113
  v_cvt_pk_bf16_f32 v121, v114, v115
  v_cvt_pk_bf16_f32 v122, v116, v117
  v_cvt_pk_bf16_f32 v123, v118, v119
  v_lshlrev_b32 v112, 16, v120
  v_and_b32 v113, 0xffff0000, v120
  v_lshlrev_b32 v114, 16, v121
  v_and_b32 v115, 0xffff0000, v121
  v_lshlrev_b32 v116, 16, v122
  v_and_b32 v117, 0xffff0000, v122
  v_lshlrev_b32 v118, 16, v123
  v_and_b32 v119, 0xffff0000, v123
  v_max3_f32 v124, v112, v113, v114
  v_max3_f32 v125, v115, v116, v117
  v_max3_f32 v124, v124, v118, v119
  v_max_f32 v124, v124, v125
  v_mov_b32 v125, v124
  s_nop 1
  v_permlane16_swap_b32 v124, v125
  v_max_f32 v124, v124, v125
  v_mov_b32 v125, v124
  s_nop 1
  v_permlane32_swap_b32 v124, v125
  v_max_f32 v124, v124, v125
  v_mul_f32 v124, s62, v124
  v_max_f32 v124, v124, v22
  v_sub_f32 v24, v22, v124
  v_exp_f32 v24, v24
  v_mov_b32 v22, v124
  v_fma_f32 v112, v112, s62, -v22
  v_fma_f32 v113, v113, s62, -v22
  v_fma_f32 v114, v114, s62, -v22
  v_fma_f32 v115, v115, s62, -v22
  v_fma_f32 v116, v116, s62, -v22
  v_fma_f32 v117, v117, s62, -v22
  v_fma_f32 v118, v118, s62, -v22
  v_fma_f32 v119, v119, s62, -v22
  v_exp_f32 v112, v112
  v_exp_f32 v113, v113
  v_exp_f32 v114, v114
  v_exp_f32 v115, v115
  v_exp_f32 v116, v116
  v_exp_f32 v117, v117
  v_exp_f32 v118, v118
  v_exp_f32 v119, v119
  v_mul_f32 v23, v23, v24
  v_cvt_pk_bf16_f32 v120, v112, v113
  v_cvt_pk_bf16_f32 v121, v114, v115
  v_cvt_pk_bf16_f32 v122, v116, v117
  v_cvt_pk_bf16_f32 v123, v118, v119
  v_add_f32 v124, v112, v113
  v_add_f32 v125, v114, v115
  v_add_f32 v124, v124, v116
  v_add_f32 v125, v125, v117
  v_add_f32 v124, v124, v118
  v_add_f32 v125, v125, v119
  v_add_f32 v124, v124, v125
  v_add_f32 v23, v23, v124
  v_mul_f32_dpp v48, v24, v48 quad_perm:[0,0,0,0] row_mask:0xf bank_mask:0xf
  v_mul_f32_dpp v49, v24, v49 quad_perm:[1,1,1,1] row_mask:0xf bank_mask:0xf
  v_mul_f32_dpp v50, v24, v50 quad_perm:[2,2,2,2] row_mask:0xf bank_mask:0xf
  v_mul_f32_dpp v51, v24, v51 quad_perm:[3,3,3,3] row_mask:0xf bank_mask:0xf
  v_mul_f32_dpp v52, v24, v52 quad_perm:[0,0,0,0] row_mask:0xf bank_mask:0xf
  v_mul_f32_dpp v53, v24, v53 quad_perm:[1,1,1,1] row_mask:0xf bank_mask:0xf
  v_mul_f32_dpp v54, v24, v54 quad_perm:[2,2,2,2] row_mask:0xf bank_mask:0xf
  v_mul_f32_dpp v55, v24, v55 quad_perm:[3,3,3,3] row_mask:0xf bank_mask:0xf
  v_mul_f32_dpp v56, v24, v56 quad_perm:[0,0,0,0] row_mask:0xf bank_mask:0xf
  v_mul_f32_dpp v57, v24, v57 quad_perm:[1,1,1,1] row_mask:0xf bank_mask:0xf
  v_mul_f32_dpp v58, v24, v58 quad_perm:[2,2,2,2] row_mask:0xf bank_mask:0xf
  v_mul_f32_dpp v59, v24, v59 quad_perm:[3,3,3,3] row_mask:0xf bank_mask:0xf
  v_mul_f32_dpp v60, v24, v60 quad_perm:[0,0,0,0] row_mask:0xf bank_mask:0xf
  v_mul_f32_dpp v61, v24, v61 quad_perm:[1,1,1,1] row_mask:0xf bank_mask:0xf
  v_mul_f32_dpp v62, v24, v62 quad_perm:[2,2,2,2] row_mask:0xf bank_mask:0xf
  v_mul_f32_dpp v63, v24, v63 quad_perm:[3,3,3,3] row_mask:0xf bank_mask:0xf
  v_mul_f32_dpp v64, v24, v64 quad_perm:[0,0,0,0] row_mask:0xf bank_mask:0xf
  v_mul_f32_dpp v65, v24, v65 quad_perm:[1,1,1,1] row_mask:0xf bank_mask:0xf
  v_mul_f32_dpp v66, v24, v66 quad_perm:[2,2,2,2] row_mask:0xf bank_mask:0xf
  v_mul_f32_dpp v67, v24, v67 quad_perm:[3,3,3,3] row_mask:0xf bank_mask:0xf
  v_mul_f32_dpp v68, v24, v68 quad_perm:[0,0,0,0] row_mask:0xf bank_mask:0xf
  v_mul_f32_dpp v69, v24, v69 quad_perm:[1,1,1,1] row_mask:0xf bank_mask:0xf
  v_mul_f32_dpp v70, v24, v70 quad_perm:[2,2,2,2] row_mask:0xf bank_mask:0xf
  v_mul_f32_dpp v71, v24, v71 quad_perm:[3,3,3,3] row_mask:0xf bank_mask:0xf
  v_mul_f32_dpp v72, v24, v72 quad_perm:[0,0,0,0] row_mask:0xf bank_mask:0xf
  v_mul_f32_dpp v73, v24, v73 quad_perm:[1,1,1,1] row_mask:0xf bank_mask:0xf
  v_mul_f32_dpp v74, v24, v74 quad_perm:[2,2,2,2] row_mask:0xf bank_mask:0xf
  v_mul_f32_dpp v75, v24, v75 quad_perm:[3,3,3,3] row_mask:0xf bank_mask:0xf
  v_mul_f32_dpp v76, v24, v76 quad_perm:[0,0,0,0] row_mask:0xf bank_mask:0xf
  v_mul_f32_dpp v77, v24, v77 quad_perm:[1,1,1,1] row_mask:0xf bank_mask:0xf
  v_mul_f32_dpp v78, v24, v78 quad_perm:[2,2,2,2] row_mask:0xf bank_mask:0xf
  v_mul_f32_dpp v79, v24, v79 quad_perm:[3,3,3,3] row_mask:0xf bank_mask:0xf
  s_waitcnt lgkmcnt(0)
  v_mfma_f32_16x16x32_bf16 v[48:51], v[120:123], v[80:83], v[48:51]
  v_mfma_f32_16x16x32_bf16 v[52:55], v[120:123], v[84:87], v[52:55]
  v_mfma_f32_16x16x32_bf16 v[56:59], v[120:123], v[88:91], v[56:59]
  v_mfma_f32_16x16x32_bf16 v[60:63], v[120:123], v[92:95], v[60:63]
  v_mfma_f32_16x16x32_bf16 v[64:67], v[120:123], v[96:99], v[64:67]
  v_mfma_f32_16x16x32_bf16 v[68:71], v[120:123], v[100:103], v[68:71]
  v_mfma_f32_16x16x32_bf16 v[72:75], v[120:123], v[104:107], v[72:75]
  v_mfma_f32_16x16x32_bf16 v[76:79], v[120:123], v[108:111], v[76:79]
  s_nop 7
L_ddone_11:
  s_add_u32 s92, s92, 16384
  s_addc_u32 s93, s93, 0
  v_mov_b32 v124, v23
  s_nop 1
  v_permlane16_swap_b32 v23, v124
  v_add_f32 v23, v23, v124
  v_mov_b32 v124, v23
  s_nop 1
  v_permlane32_swap_b32 v23, v124
  v_add_f32 v23, v23, v124
  s_lshl_b32 s31, s3, 11
  v_lshl_add_u32 v124, v2, 4, s31
  ds_write_b128 v124, v[48:51] offset:0
  ds_write_b128 v124, v[52:55] offset:256
  ds_write_b128 v124, v[56:59] offset:512
  ds_write_b128 v124, v[60:63] offset:768
  ds_write_b128 v124, v[64:67] offset:1024
  ds_write_b128 v124, v[68:71] offset:1280
  ds_write_b128 v124, v[72:75] offset:1536
  ds_write_b128 v124, v[76:79] offset:1792
  v_and_b32 v125, 3, v2
  s_lshl_b32 s31, s3, 5
  v_lshl_add_u32 v125, v125, 3, s31
  ds_write_b64 v125, v[22:23] offset:8192
  s_waitcnt lgkmcnt(0)
  s_barrier
  v_lshrrev_b32 v104, 3, v1
  v_and_b32 v105, 7, v1
  v_lshlrev_b32 v106, 8, v104
  v_lshl_add_u32 v106, v105, 5, v106
  s_lshl_b32 s31, s3, 2
  v_add_u32 v106, s31, v106
  ds_read_b32 v108, v106 offset:0
  ds_read_b32 v109, v106 offset:16
  ds_read_b32 v110, v106 offset:2048
  ds_read_b32 v111, v106 offset:2064
  ds_read_b32 v112, v106 offset:4096
  ds_read_b32 v113, v106 offset:4112
  ds_read_b32 v114, v106 offset:6144
  ds_read_b32 v115, v106 offset:6160
  s_lshl_b32 s31, s3, 3
  v_mov_b32 v107, s31
  ds_read_b64 v[116:117], v107 offset:8192
  ds_read_b64 v[118:119], v107 offset:8224
  ds_read_b64 v[120:121], v107 offset:8256
  ds_read_b64 v[122:123], v107 offset:8288
  s_waitcnt lgkmcnt(0)
  v_max3_f32 v124, v116, v118, v120
  v_max_f32 v124, v124, v122
  v_sub_f32 v116, v116, v124
  v_sub_f32 v118, v118, v124
  v_sub_f32 v120, v120, v124
  v_sub_f32 v122, v122, v124
  v_exp_f32 v116, v116
  v_exp_f32 v118, v118
  v_exp_f32 v120, v120
  v_exp_f32 v122, v122
  v_mul_f32 v125, v116, v117
  v_mul_f32 v126, v116, v108
  v_mul_f32 v127, v116, v109
  v_fmac_f32 v125, v118, v119
  v_fmac_f32 v126, v118, v110
  v_fmac_f32 v127, v118, v111
  v_fmac_f32 v125, v120, v121
  v_fmac_f32 v126, v120, v112
  v_fmac_f32 v127, v120, v113
  v_fmac_f32 v125, v122, v123
  v_fmac_f32 v126, v122, v114
  v_fmac_f32 v127, v122, v115
  v_min_u32 v124, s63, v124
  v_min_u32 v125, s63, v125
  v_min_u32 v126, s63, v126
  v_min_u32 v127, s63, v127
  v_lshlrev_b32 v104, 7, v104
  s_lshl_b32 s31, s3, 10
  s_add_u32 s31, s31, 0
  v_add_u32 v104, s31, v104
  v_lshl_add_u32 v105, v105, 3, v104
  global_store_dwordx2 v105, v[126:127], s[40:41] sc1
  global_store_dwordx2 v104, v[124:125], s[40:41] offset:64 sc1
  v_lshlrev_b32 v124, 2, v0
  v_add_u32 v124, 49152, v124
  v_lshlrev_b32 v125, 2, v0
  v_add_u32 v125, 86016, v125
  v_lshlrev_b32 v126, 2, v0
  v_add_u32 v126, 122880, v126
  v_lshlrev_b32 v127, 2, v0
  v_add_u32 v127, 159744, v127
  ds_read_b32 v80, v124 offset:0
  ds_read_b32 v81, v124 offset:1024
  ds_read_b32 v82, v124 offset:2048
  ds_read_b32 v83, v124 offset:3072
  ds_read_b32 v84, v125 offset:0
  ds_read_b32 v85, v125 offset:1024
  ds_read_b32 v86, v125 offset:2048
  ds_read_b32 v87, v125 offset:3072
  ds_read_b32 v88, v126 offset:0
  ds_read_b32 v89, v126 offset:1024
  ds_read_b32 v90, v126 offset:2048
  ds_read_b32 v91, v126 offset:3072
  ds_read_b32 v92, v127 offset:0
  ds_read_b32 v93, v127 offset:1024
  ds_read_b32 v94, v127 offset:2048
  ds_read_b32 v95, v127 offset:3072
  s_waitcnt lgkmcnt(0)
  v_perm_b32 v31, v81, v80, s60
  v_perm_b32 v81, v81, v80, s61
  v_mov_b32 v80, v31
  v_perm_b32 v31, v83, v82, s60
  v_perm_b32 v83, v83, v82, s61
  v_mov_b32 v82, v31
  v_perm_b32 v31, v85, v84, s60
  v_perm_b32 v85, v85, v84, s61
  v_mov_b32 v84, v31
  v_perm_b32 v31, v87, v86, s60
  v_perm_b32 v87, v87, v86, s61
  v_mov_b32 v86, v31
  v_perm_b32 v31, v89, v88, s60
  v_perm_b32 v89, v89, v88, s61
  v_mov_b32 v88, v31
  v_perm_b32 v31, v91, v90, s60
  v_perm_b32 v91, v91, v90, s61
  v_mov_b32 v90, v31
  v_perm_b32 v31, v93, v92, s60
  v_perm_b32 v93, v93, v92, s61
  v_mov_b32 v92, v31
  v_perm_b32 v31, v95, v94, s60
  v_perm_b32 v95, v95, v94, s61
  v_mov_b32 v94, v31
  s_cmp_lg_u32 s3, 0
  s_cbranch_scc0 L_if_12
  s_cmp_lt_u32 s2, 224
  s_cbranch_scc0 L_if_13
  s_lshl_b32 s31, s3, 7
  v_lshl_add_u32 v31, v3, 3, s31
  s_movk_i32 s31, 3584
  v_mul_lo_u32 v31, v31, s31
  v_and_b32 v124, 7, v2
  v_lshl_add_u32 v31, v124, 1, v31
  s_lshl_b32 s31, s65, 4
  s_add_u32 s42, s16, s31
  s_addc_u32 s43, s17, 0
  s_mov_b32 exec_lo, 0x00ff00ff
  s_mov_b32 exec_hi, 0x00ff00ff
  global_load_ushort v48, v31, s[42:43]
  s_add_u32 s42, s42, 3584
  s_addc_u32 s43, s43, 0
  global_load_ushort v49, v31, s[42:43]
  s_add_u32 s42, s42, 3584
  s_addc_u32 s43, s43, 0
  global_load_ushort v50, v31, s[42:43]
  s_add_u32 s42, s42, 3584
  s_addc_u32 s43, s43, 0
  global_load_ushort v51, v31, s[42:43]
  s_add_u32 s42, s42, 3584
  s_addc_u32 s43, s43, 0
  global_load_ushort v52, v31, s[42:43]
  s_add_u32 s42, s42, 3584
  s_addc_u32 s43, s43, 0
  global_load_ushort v53, v31, s[42:43]
  s_add_u32 s42, s42, 3584
  s_addc_u32 s43, s43, 0
  global_load_ushort v54, v31, s[42:43]
  s_add_u32 s42, s42, 3584
  s_addc_u32 s43, s43, 0
  global_load_ushort v55, v31, s[42:43]
  s_add_u32 s42, s42, 89600
  s_addc_u32 s43, s43, 0
  global_load_ushort v56, v31, s[42:43]
  s_add_u32 s42, s42, 3584
  s_addc_u32 s43, s43, 0
  global_load_ushort v57, v31, s[42:43]
  s_add_u32 s42, s42, 3584
  s_addc_u32 s43, s43, 0
  global_load_ushort v58, v31, s[42:43]
  s_add_u32 s42, s42, 3584
  s_addc_u32 s43, s43, 0
  global_load_ushort v59, v31, s[42:43]
  s_add_u32 s42, s42, 3584
  s_addc_u32 s43, s43, 0
  global_load_ushort v60, v31, s[42:43]
  s_add_u32 s42, s42, 3584
  s_addc_u32 s43, s43, 0
  global_load_ushort v61, v31, s[42:43]
  s_add_u32 s42, s42, 3584
  s_addc_u32 s43, s43, 0
  global_load_ushort v62, v31, s[42:43]
  s_add_u32 s42, s42, 3584
  s_addc_u32 s43, s43, 0
  global_load_ushort v63, v31, s[42:43]
  s_add_u32 s42, s42, 89600
  s_addc_u32 s43, s43, 0
  global_load_ushort v64, v31, s[42:43]
  s_add_u32 s42, s42, 3584
  s_addc_u32 s43, s43, 0
  global_load_ushort v65, v31, s[42:43]
  s_add_u32 s42, s42, 3584
  s_addc_u32 s43, s43, 0
  global_load_ushort v66, v31, s[42:43]
  s_add_u32 s42, s42, 3584
  s_addc_u32 s43, s43, 0
  global_load_ushort v67, v31, s[42:43]
  s_add_u32 s42, s42, 3584
  s_addc_u32 s43, s43, 0
  global_load_ushort v68, v31, s[42:43]
  s_add_u32 s42, s42, 3584
  s_addc_u32 s43, s43, 0
  global_load_ushort v69, v31, s[42:43]
  s_add_u32 s42, s42, 3584
  s_addc_u32 s43, s43, 0
  global_load_ushort v70, v31, s[42:43]
  s_add_u32 s42, s42, 3584
  s_addc_u32 s43, s43, 0
  global_load_ushort v71, v31, s[42:43]
  s_add_u32 s42, s42, 89600
  s_addc_u32 s43, s43, 0
  global_load_ushort v72, v31, s[42:43]
  s_add_u32 s42, s42, 3584
  s_addc_u32 s43, s43, 0
  global_load_ushort v73, v31, s[42:43]
  s_add_u32 s42, s42, 3584
  s_addc_u32 s43, s43, 0
  global_load_ushort v74, v31, s[42:43]
  s_add_u32 s42, s42, 3584
  s_addc_u32 s43, s43, 0
  global_load_ushort v75, v31, s[42:43]
  s_add_u32 s42, s42, 3584
  s_addc_u32 s43, s43, 0
  global_load_ushort v76, v31, s[42:43]
  s_add_u32 s42, s42, 3584
  s_addc_u32 s43, s43, 0
  global_load_ushort v77, v31, s[42:43]
  s_add_u32 s42, s42, 3584
  s_addc_u32 s43, s43, 0
  global_load_ushort v78, v31, s[42:43]
  s_add_u32 s42, s42, 3584
  s_addc_u32 s43, s43, 0
  global_load_ushort v79, v31, s[42:43]
  s_add_u32 s42, s42, 89600
  s_addc_u32 s43, s43, 0
  s_add_u32 s42, s18, s31
  s_addc_u32 s43, s19, 0
  s_mov_b32 exec_lo, 0xff00ff00
  s_mov_b32 exec_hi, 0xff00ff00
  global_load_ushort v48, v31, s[42:43]
  s_add_u32 s42, s42, 3584
  s_addc_u32 s43, s43, 0
  global_load_ushort v49, v31, s[42:43]
  s_add_u32 s42, s42, 3584
  s_addc_u32 s43, s43, 0
  global_load_ushort v50, v31, s[42:43]
  s_add_u32 s42, s42, 3584
  s_addc_u32 s43, s43, 0
  global_load_ushort v51, v31, s[42:43]
  s_add_u32 s42, s42, 3584
  s_addc_u32 s43, s43, 0
  global_load_ushort v52, v31, s[42:43]
  s_add_u32 s42, s42, 3584
  s_addc_u32 s43, s43, 0
  global_load_ushort v53, v31, s[42:43]
  s_add_u32 s42, s42, 3584
  s_addc_u32 s43, s43, 0
  global_load_ushort v54, v31, s[42:43]
  s_add_u32 s42, s42, 3584
  s_addc_u32 s43, s43, 0
  global_load_ushort v55, v31, s[42:43]
  s_add_u32 s42, s42, 89600
  s_addc_u32 s43, s43, 0
  global_load_ushort v56, v31, s[42:43]
  s_add_u32 s42, s42, 3584
  s_addc_u32 s43, s43, 0
  global_load_ushort v57, v31, s[42:43]
  s_add_u32 s42, s42, 3584
  s_addc_u32 s43, s43, 0
  global_load_ushort v58, v31, s[42:43]
  s_add_u32 s42, s42, 3584
  s_addc_u32 s43, s43, 0
  global_load_ushort v59, v31, s[42:43]
  s_add_u32 s42, s42, 3584
  s_addc_u32 s43, s43, 0
  global_load_ushort v60, v31, s[42:43]
  s_add_u32 s42, s42, 3584
  s_addc_u32 s43, s43, 0
  global_load_ushort v61, v31, s[42:43]
  s_add_u32 s42, s42, 3584
  s_addc_u32 s43, s43, 0
  global_load_ushort v62, v31, s[42:43]
  s_add_u32 s42, s42, 3584
  s_addc_u32 s43, s43, 0
  global_load_ushort v63, v31, s[42:43]
  s_add_u32 s42, s42, 89600
  s_addc_u32 s43, s43, 0
  global_load_ushort v64, v31, s[42:43]
  s_add_u32 s42, s42, 3584
  s_addc_u32 s43, s43, 0
  global_load_ushort v65, v31, s[42:43]
  s_add_u32 s42, s42, 3584
  s_addc_u32 s43, s43, 0
  global_load_ushort v66, v31, s[42:43]
  s_add_u32 s42, s42, 3584
  s_addc_u32 s43, s43, 0
  global_load_ushort v67, v31, s[42:43]
  s_add_u32 s42, s42, 3584
  s_addc_u32 s43, s43, 0
  global_load_ushort v68, v31, s[42:43]
  s_add_u32 s42, s42, 3584
  s_addc_u32 s43, s43, 0
  global_load_ushort v69, v31, s[42:43]
  s_add_u32 s42, s42, 3584
  s_addc_u32 s43, s43, 0
  global_load_ushort v70, v31, s[42:43]
  s_add_u32 s42, s42, 3584
  s_addc_u32 s43, s43, 0
  global_load_ushort v71, v31, s[42:43]
  s_add_u32 s42, s42, 89600
  s_addc_u32 s43, s43, 0
  global_load_ushort v72, v31, s[42:43]
  s_add_u32 s42, s42, 3584
  s_addc_u32 s43, s43, 0
  global_load_ushort v73, v31, s[42:43]
  s_add_u32 s42, s42, 3584
  s_addc_u32 s43, s43, 0
  global_load_ushort v74, v31, s[42:43]
  s_add_u32 s42, s42, 3584
  s_addc_u32 s43, s43, 0
  global_load_ushort v75, v31, s[42:43]
  s_add_u32 s42, s42, 3584
  s_addc_u32 s43, s43, 0
  global_load_ushort v76, v31, s[42:43]
  s_add_u32 s42, s42, 3584
  s_addc_u32 s43, s43, 0
  global_load_ushort v77, v31, s[42:43]
  s_add_u32 s42, s42, 3584
  s_addc_u32 s43, s43, 0
  global_load_ushort v78, v31, s[42:43]
  s_add_u32 s42, s42, 3584
  s_addc_u32 s43, s43, 0
  global_load_ushort v79, v31, s[42:43]
  s_add_u32 s42, s42, 89600
  s_addc_u32 s43, s43, 0
  s_mov_b64 exec, -1
  s_lshl_b32 s31, s65, 13
  s_add_u32 s42, s20, s31
  s_addc_u32 s43, s21, 0
  v_lshlrev_b32 v31, 2, v0
  global_load_dword v96, v31, s[42:43] offset:0
  global_load_dword v97, v31, s[42:43] offset:1024
  global_load_dword v98, v31, s[42:43] offset:2048
  global_load_dword v99, v31, s[42:43] offset:3072
  s_add_u32 s42, s42, 4096
  s_addc_u32 s43, s43, 0
  global_load_dword v100, v31, s[42:43] offset:0
  global_load_dword v101, v31, s[42:43] offset:1024
  global_load_dword v102, v31, s[42:43] offset:2048
  global_load_dword v103, v31, s[42:43] offset:3072
L_if_13:
L_if_12:
  s_cmp_eq_u32 s3, 0
  s_cbranch_scc0 L_if_14
  v_and_b32 v104, 31, v1
  v_lshlrev_b32 v104, 14, v104
  s_lshl_b32 s31, s28, 19
  s_lshl_b32 s66, s29, 7
  s_add_u32 s31, s31, s66
  s_add_u32 s31, s31, 131072
  v_add_u32 v104, s31, v104
  v_lshrrev_b32 v105, 5, v1
  v_lshl_add_u32 v106, v105, 5, v104
  v_lshlrev_b32 v105, 4, v105
  s_nop 1
L_pl_15:
  global_load_dwordx4 v[108:111], v106, s[26:27] sc1
  global_load_dwordx4 v[112:115], v106, s[26:27] offset:16 sc1
  global_load_dwordx2 v[116:117], v104, s[26:27] offset:64 sc1
  s_waitcnt vmcnt(0)
  v_max3_u32 v107, v108, v109, v110
  v_max3_u32 v107, v107, v111, v112
  v_max3_u32 v107, v107, v113, v114
  v_max3_u32 v107, v107, v115, v116
  v_max_u32 v107, v107, v117
  v_cmp_eq_u32 vcc, -1, v107
  s_sub_u32 s30, s30, 1
  s_cselect_b32 s30, 0, s30
  s_cbranch_scc1 L_pd_16
  s_cbranch_vccnz L_pl_15
L_pd_16:
  v_mov_b32 v118, v116
  s_nop 1
  v_max_f32_dpp v118, v118, v118 quad_perm:[1,0,3,2] row_mask:0xf bank_mask:0xf
  s_nop 1
  v_max_f32_dpp v118, v118, v118 quad_perm:[2,3,0,1] row_mask:0xf bank_mask:0xf
  s_nop 1
  v_max_f32_dpp v118, v118, v118 row_half_mirror row_mask:0xf bank_mask:0xf
  s_nop 1
  v_max_f32_dpp v118, v118, v118 row_mirror row_mask:0xf bank_mask:0xf
  v_mov_b32 v119, v118
  s_nop 1
  v_permlane16_swap_b32 v118, v119
  v_max_f32 v118, v118, v119
  v_sub_f32 v119, v116, v118
  v_exp_f32 v119, v119
  s_nop 0
  v_mul_f32 v117, v119, v117
  v_mul_f32 v108, v119, v108
  v_mul_f32 v109, v119, v109
  v_mul_f32 v110, v119, v110
  v_mul_f32 v111, v119, v111
  v_mul_f32 v112, v119, v112
  v_mul_f32 v113, v119, v113
  v_mul_f32 v114, v119, v114
  v_mul_f32 v115, v119, v115
  v_add_f32_dpp v108, v108, v108 quad_perm:[1,0,3,2] row_mask:0xf bank_mask:0xf
  v_add_f32_dpp v109, v109, v109 quad_perm:[1,0,3,2] row_mask:0xf bank_mask:0xf
  v_add_f32_dpp v110, v110, v110 quad_perm:[1,0,3,2] row_mask:0xf bank_mask:0xf
  v_add_f32_dpp v111, v111, v111 quad_perm:[1,0,3,2] row_mask:0xf bank_mask:0xf
  v_add_f32_dpp v112, v112, v112 quad_perm:[1,0,3,2] row_mask:0xf bank_mask:0xf
  v_add_f32_dpp v113, v113, v113 quad_perm:[1,0,3,2] row_mask:0xf bank_mask:0xf
  v_add_f32_dpp v114, v114, v114 quad_perm:[1,0,3,2] row_mask:0xf bank_mask:0xf
  v_add_f32_dpp v115, v115, v115 quad_perm:[1,0,3,2] row_mask:0xf bank_mask:0xf
  v_add_f32_dpp v117, v117, v117 quad_perm:[1,0,3,2] row_mask:0xf bank_mask:0xf
  v_add_f32_dpp v108, v108, v108 quad_perm:[2,3,0,1] row_mask:0xf bank_mask:0xf
  v_add_f32_dpp v109, v109, v109 quad_perm:[2,3,0,1] row_mask:0xf bank_mask:0xf
  v_add_f32_dpp v110, v110, v110 quad_perm:[2,3,0,1] row_mask:0xf bank_mask:0xf
  v_add_f32_dpp v111, v111, v111 quad_perm:[2,3,0,1] row_mask:0xf bank_mask:0xf
  v_add_f32_dpp v112, v112, v112 quad_perm:[2,3,0,1] row_mask:0xf bank_mask:0xf
  v_add_f32_dpp v113, v113, v113 quad_perm:[2,3,0,1] row_mask:0xf bank_mask:0xf
  v_add_f32_dpp v114, v114, v114 quad_perm:[2,3,0,1] row_mask:0xf bank_mask:0xf
  v_add_f32_dpp v115, v115, v115 quad_perm:[2,3,0,1] row_mask:0xf bank_mask:0xf
  v_add_f32_dpp v117, v117, v117 quad_perm:[2,3,0,1] row_mask:0xf bank_mask:0xf
  v_add_f32_dpp v108, v108, v108 row_half_mirror row_mask:0xf bank_mask:0xf
  v_add_f32_dpp v109, v109, v109 row_half_mirror row_mask:0xf bank_mask:0xf
  v_add_f32_dpp v110, v110, v110 row_half_mirror row_mask:0xf bank_mask:0xf
  v_add_f32_dpp v111, v111, v111 row_half_mirror row_mask:0xf bank_mask:0xf
  v_add_f32_dpp v112, v112, v112 row_half_mirror row_mask:0xf bank_mask:0xf
  v_add_f32_dpp v113, v113, v113 row_half_mirror row_mask:0xf bank_mask:0xf
  v_add_f32_dpp v114, v114, v114 row_half_mirror row_mask:0xf bank_mask:0xf
  v_add_f32_dpp v115, v115, v115 row_half_mirror row_mask:0xf bank_mask:0xf
  v_add_f32_dpp v117, v117, v117 row_half_mirror row_mask:0xf bank_mask:0xf
  v_add_f32_dpp v108, v108, v108 row_mirror row_mask:0xf bank_mask:0xf
  v_add_f32_dpp v109, v109, v109 row_mirror row_mask:0xf bank_mask:0xf
  v_add_f32_dpp v110, v110, v110 row_mirror row_mask:0xf bank_mask:0xf
  v_add_f32_dpp v111, v111, v111 row_mirror row_mask:0xf bank_mask:0xf
  v_add_f32_dpp v112, v112, v112 row_mirror row_mask:0xf bank_mask:0xf
  v_add_f32_dpp v113, v113, v113 row_mirror row_mask:0xf bank_mask:0xf
  v_add_f32_dpp v114, v114, v114 row_mirror row_mask:0xf bank_mask:0xf
  v_add_f32_dpp v115, v115, v115 row_mirror row_mask:0xf bank_mask:0xf
  v_add_f32_dpp v117, v117, v117 row_mirror row_mask:0xf bank_mask:0xf
  v_mov_b32 v118, v108
  v_mov_b32 v119, v109
  v_mov_b32 v120, v110
  v_mov_b32 v121, v111
  v_mov_b32 v122, v112
  v_mov_b32 v123, v113
  v_mov_b32 v124, v114
  v_mov_b32 v125, v115
  v_mov_b32 v126, v117
  v_permlane16_swap_b32 v108, v118
  v_permlane16_swap_b32 v109, v119
  v_permlane16_swap_b32 v110, v120
  v_permlane16_swap_b32 v111, v121
  v_permlane16_swap_b32 v112, v122
  v_permlane16_swap_b32 v113, v123
  v_permlane16_swap_b32 v114, v124
  v_permlane16_swap_b32 v115, v125
  v_permlane16_swap_b32 v117, v126
  v_add_f32 v108, v108, v118
  v_add_f32 v109, v109, v119
  v_add_f32 v110, v110, v120
  v_add_f32 v111, v111, v121
  v_add_f32 v112, v112, v122
  v_add_f32 v113, v113, v123
  v_add_f32 v114, v114, v124
  v_add_f32 v115, v115, v125
  v_add_f32 v117, v117, v126
  v_rcp_f32 v117, v117
  s_nop 0
  v_mul_f32 v108, v108, v117
  v_mul_f32 v109, v109, v117
  v_mul_f32 v110, v110, v117
  v_mul_f32 v111, v111, v117
  v_mul_f32 v112, v112, v117
  v_mul_f32 v113, v113, v117
  v_mul_f32 v114, v114, v117
  v_mul_f32 v115, v115, v117
  v_cvt_pk_bf16_f32 v108, v108, v109
  v_cvt_pk_bf16_f32 v109, v110, v111
  v_cvt_pk_bf16_f32 v110, v112, v113
  v_cvt_pk_bf16_f32 v111, v114, v115
  ds_write_b128 v105, v[108:111] offset:10496
  s_waitcnt lgkmcnt(0)
L_if_14:
  s_cmp_ge_u32 s2, 32
  s_cbranch_scc0 L_if_17
  s_cmp_lg_u32 s3, 0
  s_cbranch_scc0 L_if_18
L_if_18:
L_if_17:
  s_barrier
  v_mov_b32 v104, 0
  ds_read_b128 v[108:111], v104 offset:10496
  ds_read_b128 v[112:115], v104 offset:10512
  v_mov_b32 v116, 0
  v_mov_b32 v117, 0
  v_lshlrev_b32 v104, 3, v0
  v_add_u32 v104, 8192, v104
  s_waitcnt lgkmcnt(0)
  v_dot2_f32_bf16 v116, v108, v80, v116
  v_dot2_f32_bf16 v117, v108, v81, v117
  v_dot2_f32_bf16 v116, v109, v82, v116
  v_dot2_f32_bf16 v117, v109, v83, v117
  v_dot2_f32_bf16 v116, v110, v84, v116
  v_dot2_f32_bf16 v117, v110, v85, v117
  v_dot2_f32_bf16 v116, v111, v86, v116
  v_dot2_f32_bf16 v117, v111, v87, v117
  v_dot2_f32_bf16 v116, v112, v88, v116
  v_dot2_f32_bf16 v117, v112, v89, v117
  v_dot2_f32_bf16 v116, v113, v90, v116
  v_dot2_f32_bf16 v117, v113, v91, v117
  v_dot2_f32_bf16 v116, v114, v92, v116
  v_dot2_f32_bf16 v117, v114, v93, v117
  v_dot2_f32_bf16 v116, v115, v94, v116
  v_dot2_f32_bf16 v117, v115, v95, v117
  s_nop 1
  v_min_u32 v116, s63, v116
  v_min_u32 v117, s63, v117
  global_store_dwordx2 v104, v[116:117], s[40:41] sc1
  s_cmp_lt_u32 s2, 32
  s_cbranch_scc0 L_if_19
  v_lshrrev_b32 v104, 2, v0
  v_lshlrev_b32 v104, 14, v104
  v_and_b32 v105, 3, v0
  v_lshl_add_u32 v104, v105, 4, v104
  s_lshl_b32 s31, s2, 6
  s_add_u32 s31, s31, 139264
  v_add_u32 v104, s31, v104
  v_add_u32 v106, 1048576, v104
  v_add_u32 v107, 2097152, v104
  v_add_u32 v108, 3145728, v104
  s_nop 1
L_pl_20:
  global_load_dwordx4 v[112:115], v104, s[26:27] sc1
  global_load_dwordx4 v[116:119], v106, s[26:27] sc1
  global_load_dwordx4 v[120:123], v107, s[26:27] sc1
  global_load_dwordx4 v[124:127], v108, s[26:27] sc1
  s_waitcnt vmcnt(0)
  v_max3_u32 v109, v112, v113, v114
  v_max3_u32 v109, v109, v115, v116
  v_max3_u32 v109, v109, v117, v118
  v_max3_u32 v109, v109, v119, v120
  v_max3_u32 v109, v109, v121, v122
  v_max3_u32 v109, v109, v123, v124
  v_max3_u32 v109, v109, v125, v126
  v_max_u32 v109, v109, v127
  v_cmp_eq_u32 vcc, -1, v109
  s_sub_u32 s30, s30, 1
  s_cselect_b32 s30, 0, s30
  s_cbranch_scc1 L_pd_21
  s_cbranch_vccnz L_pl_20
L_pd_21:
  v_add_f32 v112, v112, v116
  v_add_f32 v120, v120, v124
  v_add_f32 v113, v113, v117
  v_add_f32 v121, v121, v125
  v_add_f32 v114, v114, v118
  v_add_f32 v122, v122, v126
  v_add_f32 v115, v115, v119
  v_add_f32 v123, v123, v127
  v_add_f32 v112, v112, v120
  v_add_f32 v113, v113, v121
  v_add_f32 v114, v114, v122
  v_add_f32 v115, v115, v123
  v_add_f32_dpp v112, v112, v112 row_ror:4 row_mask:0xf bank_mask:0xf
  v_add_f32_dpp v113, v113, v113 row_ror:4 row_mask:0xf bank_mask:0xf
  v_add_f32_dpp v114, v114, v114 row_ror:4 row_mask:0xf bank_mask:0xf
  v_add_f32_dpp v115, v115, v115 row_ror:4 row_mask:0xf bank_mask:0xf
  v_add_f32_dpp v112, v112, v112 row_ror:8 row_mask:0xf bank_mask:0xf
  v_add_f32_dpp v113, v113, v113 row_ror:8 row_mask:0xf bank_mask:0xf
  v_add_f32_dpp v114, v114, v114 row_ror:8 row_mask:0xf bank_mask:0xf
  v_add_f32_dpp v115, v115, v115 row_ror:8 row_mask:0xf bank_mask:0xf
  v_mov_b32 v116, v112
  v_mov_b32 v117, v113
  v_mov_b32 v118, v114
  v_mov_b32 v119, v115
  v_permlane16_swap_b32 v112, v116
  v_permlane16_swap_b32 v113, v117
  v_permlane16_swap_b32 v114, v118
  v_permlane16_swap_b32 v115, v119
  v_add_f32 v112, v112, v116
  v_add_f32 v113, v113, v117
  v_add_f32 v114, v114, v118
  v_add_f32 v115, v115, v119
  v_mov_b32 v116, v112
  v_mov_b32 v117, v113
  v_mov_b32 v118, v114
  v_mov_b32 v119, v115
  v_permlane32_swap_b32 v112, v116
  v_permlane32_swap_b32 v113, v117
  v_permlane32_swap_b32 v114, v118
  v_permlane32_swap_b32 v115, v119
  v_add_f32 v112, v112, v116
  v_add_f32 v113, v113, v117
  v_add_f32 v114, v114, v118
  v_add_f32 v115, v115, v119
  s_lshl_b32 s31, s3, 6
  v_lshl_add_u32 v109, v105, 4, s31
  ds_write_b128 v109, v[112:115] offset:8704
  v_lshlrev_b32 v109, 4, v105
  s_waitcnt lgkmcnt(0)
  s_barrier
  ds_read_b128 v[112:115], v109 offset:8704
  ds_read_b128 v[116:119], v109 offset:8768
  ds_read_b128 v[120:123], v109 offset:8832
  ds_read_b128 v[124:127], v109 offset:8896
  s_waitcnt lgkmcnt(0)
  v_add_f32 v112, v112, v116
  v_add_f32 v120, v120, v124
  v_add_f32 v113, v113, v117
  v_add_f32 v121, v121, v125
  v_add_f32 v114, v114, v118
  v_add_f32 v122, v122, v126
  v_add_f32 v115, v115, v119
  v_add_f32 v123, v123, v127
  v_add_f32 v112, v112, v120
  v_add_f32 v113, v113, v121
  v_add_f32 v114, v114, v122
  v_add_f32 v115, v115, v123
  v_cvt_pk_bf16_f32 v116, v112, v113
  v_cvt_pk_bf16_f32 v117, v114, v115
  v_lshlrev_b32 v112, 16, v116
  v_and_b32 v113, 0xffff0000, v116
  v_lshlrev_b32 v120, 16, v26
  v_and_b32 v121, 0xffff0000, v26
  v_lshlrev_b32 v114, 16, v117
  v_and_b32 v115, 0xffff0000, v117
  v_lshlrev_b32 v122, 16, v27
  v_and_b32 v123, 0xffff0000, v27
  v_add_f32 v112, v112, v120
  v_add_f32 v113, v113, v121
  v_add_f32 v114, v114, v122
  v_add_f32 v115, v115, v123
  v_cvt_pk_bf16_f32 v26, v112, v113
  v_cvt_pk_bf16_f32 v27, v114, v115
  s_cmp_eq_u32 s3, 0
  s_cbranch_scc0 L_if_22
  s_lshl_b32 s31, s2, 7
  s_add_u32 s31, s31, 65536
  v_lshl_add_u32 v109, v105, 3, s31
  v_min_u32 v112, s63, v26
  v_min_u32 v113, s63, v27
  global_store_dwordx2 v109, v[112:113], s[26:27] sc1
L_if_22:
L_if_19:
  s_cmp_eq_u32 s3, 0
  s_cbranch_scc0 L_if_23
  s_cmp_lt_u32 s2, 224
  s_cbranch_scc0 L_if_24
  s_lshl_b32 s31, s3, 7
  v_lshl_add_u32 v31, v3, 3, s31
  s_movk_i32 s31, 3584
  v_mul_lo_u32 v31, v31, s31
  v_and_b32 v124, 7, v2
  v_lshl_add_u32 v31, v124, 1, v31
  s_lshl_b32 s31, s65, 4
  s_add_u32 s42, s16, s31
  s_addc_u32 s43, s17, 0
  s_mov_b32 exec_lo, 0x00ff00ff
  s_mov_b32 exec_hi, 0x00ff00ff
  global_load_ushort v48, v31, s[42:43]
  s_add_u32 s42, s42, 3584
  s_addc_u32 s43, s43, 0
  global_load_ushort v49, v31, s[42:43]
  s_add_u32 s42, s42, 3584
  s_addc_u32 s43, s43, 0
  global_load_ushort v50, v31, s[42:43]
  s_add_u32 s42, s42, 3584
  s_addc_u32 s43, s43, 0
  global_load_ushort v51, v31, s[42:43]
  s_add_u32 s42, s42, 3584
  s_addc_u32 s43, s43, 0
  global_load_ushort v52, v31, s[42:43]
  s_add_u32 s42, s42, 3584
  s_addc_u32 s43, s43, 0
  global_load_ushort v53, v31, s[42:43]
  s_add_u32 s42, s42, 3584
  s_addc_u32 s43, s43, 0
  global_load_ushort v54, v31, s[42:43]
  s_add_u32 s42, s42, 3584
  s_addc_u32 s43, s43, 0
  global_load_ushort v55, v31, s[42:43]
  s_add_u32 s42, s42, 89600
  s_addc_u32 s43, s43, 0
  global_load_ushort v56, v31, s[42:43]
  s_add_u32 s42, s42, 3584
  s_addc_u32 s43, s43, 0
  global_load_ushort v57, v31, s[42:43]
  s_add_u32 s42, s42, 3584
  s_addc_u32 s43, s43, 0
  global_load_ushort v58, v31, s[42:43]
  s_add_u32 s42, s42, 3584
  s_addc_u32 s43, s43, 0
  global_load_ushort v59, v31, s[42:43]
  s_add_u32 s42, s42, 3584
  s_addc_u32 s43, s43, 0
  global_load_ushort v60, v31, s[42:43]
  s_add_u32 s42, s42, 3584
  s_addc_u32 s43, s43, 0
  global_load_ushort v61, v31, s[42:43]
  s_add_u32 s42, s42, 3584
  s_addc_u32 s43, s43, 0
  global_load_ushort v62, v31, s[42:43]
  s_add_u32 s42, s42, 3584
  s_addc_u32 s43, s43, 0
  global_load_ushort v63, v31, s[42:43]
  s_add_u32 s42, s42, 89600
  s_addc_u32 s43, s43, 0
  global_load_ushort v64, v31, s[42:43]
  s_add_u32 s42, s42, 3584
  s_addc_u32 s43, s43, 0
  global_load_ushort v65, v31, s[42:43]
  s_add_u32 s42, s42, 3584
  s_addc_u32 s43, s43, 0
  global_load_ushort v66, v31, s[42:43]
  s_add_u32 s42, s42, 3584
  s_addc_u32 s43, s43, 0
  global_load_ushort v67, v31, s[42:43]
  s_add_u32 s42, s42, 3584
  s_addc_u32 s43, s43, 0
  global_load_ushort v68, v31, s[42:43]
  s_add_u32 s42, s42, 3584
  s_addc_u32 s43, s43, 0
  global_load_ushort v69, v31, s[42:43]
  s_add_u32 s42, s42, 3584
  s_addc_u32 s43, s43, 0
  global_load_ushort v70, v31, s[42:43]
  s_add_u32 s42, s42, 3584
  s_addc_u32 s43, s43, 0
  global_load_ushort v71, v31, s[42:43]
  s_add_u32 s42, s42, 89600
  s_addc_u32 s43, s43, 0
  global_load_ushort v72, v31, s[42:43]
  s_add_u32 s42, s42, 3584
  s_addc_u32 s43, s43, 0
  global_load_ushort v73, v31, s[42:43]
  s_add_u32 s42, s42, 3584
  s_addc_u32 s43, s43, 0
  global_load_ushort v74, v31, s[42:43]
  s_add_u32 s42, s42, 3584
  s_addc_u32 s43, s43, 0
  global_load_ushort v75, v31, s[42:43]
  s_add_u32 s42, s42, 3584
  s_addc_u32 s43, s43, 0
  global_load_ushort v76, v31, s[42:43]
  s_add_u32 s42, s42, 3584
  s_addc_u32 s43, s43, 0
  global_load_ushort v77, v31, s[42:43]
  s_add_u32 s42, s42, 3584
  s_addc_u32 s43, s43, 0
  global_load_ushort v78, v31, s[42:43]
  s_add_u32 s42, s42, 3584
  s_addc_u32 s43, s43, 0
  global_load_ushort v79, v31, s[42:43]
  s_add_u32 s42, s42, 89600
  s_addc_u32 s43, s43, 0
  s_add_u32 s42, s18, s31
  s_addc_u32 s43, s19, 0
  s_mov_b32 exec_lo, 0xff00ff00
  s_mov_b32 exec_hi, 0xff00ff00
  global_load_ushort v48, v31, s[42:43]
  s_add_u32 s42, s42, 3584
  s_addc_u32 s43, s43, 0
  global_load_ushort v49, v31, s[42:43]
  s_add_u32 s42, s42, 3584
  s_addc_u32 s43, s43, 0
  global_load_ushort v50, v31, s[42:43]
  s_add_u32 s42, s42, 3584
  s_addc_u32 s43, s43, 0
  global_load_ushort v51, v31, s[42:43]
  s_add_u32 s42, s42, 3584
  s_addc_u32 s43, s43, 0
  global_load_ushort v52, v31, s[42:43]
  s_add_u32 s42, s42, 3584
  s_addc_u32 s43, s43, 0
  global_load_ushort v53, v31, s[42:43]
  s_add_u32 s42, s42, 3584
  s_addc_u32 s43, s43, 0
  global_load_ushort v54, v31, s[42:43]
  s_add_u32 s42, s42, 3584
  s_addc_u32 s43, s43, 0
  global_load_ushort v55, v31, s[42:43]
  s_add_u32 s42, s42, 89600
  s_addc_u32 s43, s43, 0
  global_load_ushort v56, v31, s[42:43]
  s_add_u32 s42, s42, 3584
  s_addc_u32 s43, s43, 0
  global_load_ushort v57, v31, s[42:43]
  s_add_u32 s42, s42, 3584
  s_addc_u32 s43, s43, 0
  global_load_ushort v58, v31, s[42:43]
  s_add_u32 s42, s42, 3584
  s_addc_u32 s43, s43, 0
  global_load_ushort v59, v31, s[42:43]
  s_add_u32 s42, s42, 3584
  s_addc_u32 s43, s43, 0
  global_load_ushort v60, v31, s[42:43]
  s_add_u32 s42, s42, 3584
  s_addc_u32 s43, s43, 0
  global_load_ushort v61, v31, s[42:43]
  s_add_u32 s42, s42, 3584
  s_addc_u32 s43, s43, 0
  global_load_ushort v62, v31, s[42:43]
  s_add_u32 s42, s42, 3584
  s_addc_u32 s43, s43, 0
  global_load_ushort v63, v31, s[42:43]
  s_add_u32 s42, s42, 89600
  s_addc_u32 s43, s43, 0
  global_load_ushort v64, v31, s[42:43]
  s_add_u32 s42, s42, 3584
  s_addc_u32 s43, s43, 0
  global_load_ushort v65, v31, s[42:43]
  s_add_u32 s42, s42, 3584
  s_addc_u32 s43, s43, 0
  global_load_ushort v66, v31, s[42:43]
  s_add_u32 s42, s42, 3584
  s_addc_u32 s43, s43, 0
  global_load_ushort v67, v31, s[42:43]
  s_add_u32 s42, s42, 3584
  s_addc_u32 s43, s43, 0
  global_load_ushort v68, v31, s[42:43]
  s_add_u32 s42, s42, 3584
  s_addc_u32 s43, s43, 0
  global_load_ushort v69, v31, s[42:43]
  s_add_u32 s42, s42, 3584
  s_addc_u32 s43, s43, 0
  global_load_ushort v70, v31, s[42:43]
  s_add_u32 s42, s42, 3584
  s_addc_u32 s43, s43, 0
  global_load_ushort v71, v31, s[42:43]
  s_add_u32 s42, s42, 89600
  s_addc_u32 s43, s43, 0
  global_load_ushort v72, v31, s[42:43]
  s_add_u32 s42, s42, 3584
  s_addc_u32 s43, s43, 0
  global_load_ushort v73, v31, s[42:43]
  s_add_u32 s42, s42, 3584
  s_addc_u32 s43, s43, 0
  global_load_ushort v74, v31, s[42:43]
  s_add_u32 s42, s42, 3584
  s_addc_u32 s43, s43, 0
  global_load_ushort v75, v31, s[42:43]
  s_add_u32 s42, s42, 3584
  s_addc_u32 s43, s43, 0
  global_load_ushort v76, v31, s[42:43]
  s_add_u32 s42, s42, 3584
  s_addc_u32 s43, s43, 0
  global_load_ushort v77, v31, s[42:43]
  s_add_u32 s42, s42, 3584
  s_addc_u32 s43, s43, 0
  global_load_ushort v78, v31, s[42:43]
  s_add_u32 s42, s42, 3584
  s_addc_u32 s43, s43, 0
  global_load_ushort v79, v31, s[42:43]
  s_add_u32 s42, s42, 89600
  s_addc_u32 s43, s43, 0
  s_mov_b64 exec, -1
  s_lshl_b32 s31, s65, 13
  s_add_u32 s42, s20, s31
  s_addc_u32 s43, s21, 0
  v_lshlrev_b32 v31, 2, v0
  global_load_dword v96, v31, s[42:43] offset:0
  global_load_dword v97, v31, s[42:43] offset:1024
  global_load_dword v98, v31, s[42:43] offset:2048
  global_load_dword v99, v31, s[42:43] offset:3072
  s_add_u32 s42, s42, 4096
  s_addc_u32 s43, s43, 0
  global_load_dword v100, v31, s[42:43] offset:0
  global_load_dword v101, v31, s[42:43] offset:1024
  global_load_dword v102, v31, s[42:43] offset:2048
  global_load_dword v103, v31, s[42:43] offset:3072
L_if_24:
L_if_23:
  s_cmp_lt_u32 s2, 224
  s_cbranch_scc0 L_if_25
  s_add_u32 s44, s26, 65536
  s_addc_u32 s45, s27, 0
  s_waitcnt vmcnt(0)
  v_lshl_or_b32 v32, v49, 16, v48
  v_lshl_or_b32 v33, v51, 16, v50
  v_lshl_or_b32 v34, v53, 16, v52
  v_lshl_or_b32 v35, v55, 16, v54
  v_lshl_or_b32 v36, v57, 16, v56
  v_lshl_or_b32 v37, v59, 16, v58
  v_lshl_or_b32 v38, v61, 16, v60
  v_lshl_or_b32 v39, v63, 16, v62
  v_lshl_or_b32 v40, v65, 16, v64
  v_lshl_or_b32 v41, v67, 16, v66
  v_lshl_or_b32 v42, v69, 16, v68
  v_lshl_or_b32 v43, v71, 16, v70
  v_lshl_or_b32 v44, v73, 16, v72
  v_lshl_or_b32 v45, v75, 16, v74
  v_lshl_or_b32 v46, v77, 16, v76
  v_lshl_or_b32 v47, v79, 16, v78
  v_perm_b32 v31, v97, v96, s60
  v_perm_b32 v97, v97, v96, s61
  v_mov_b32 v96, v31
  v_perm_b32 v31, v99, v98, s60
  v_perm_b32 v99, v99, v98, s61
  v_mov_b32 v98, v31
  v_perm_b32 v31, v101, v100, s60
  v_perm_b32 v101, v101, v100, s61
  v_mov_b32 v100, v31
  v_perm_b32 v31, v103, v102, s60
  v_perm_b32 v103, v103, v102, s61
  v_mov_b32 v102, v31
  s_lshl_b32 s31, s3, 7
  v_lshl_add_u32 v31, v3, 3, s31
  v_lshlrev_b32 v31, 13, v31
  v_lshl_add_u32 v31, v2, 1, v31
  s_lshl_b32 s31, s64, 5
  s_add_u32 s42, s10, s31
  s_addc_u32 s43, s11, 0
  global_load_ushort v48, v31, s[42:43]
  s_add_u32 s42, s42, 8192
  s_addc_u32 s43, s43, 0
  global_load_ushort v49, v31, s[42:43]
  s_add_u32 s42, s42, 8192
  s_addc_u32 s43, s43, 0
  global_load_ushort v50, v31, s[42:43]
  s_add_u32 s42, s42, 8192
  s_addc_u32 s43, s43, 0
  global_load_ushort v51, v31, s[42:43]
  s_add_u32 s42, s42, 8192
  s_addc_u32 s43, s43, 0
  global_load_ushort v52, v31, s[42:43]
  s_add_u32 s42, s42, 8192
  s_addc_u32 s43, s43, 0
  global_load_ushort v53, v31, s[42:43]
  s_add_u32 s42, s42, 8192
  s_addc_u32 s43, s43, 0
  global_load_ushort v54, v31, s[42:43]
  s_add_u32 s42, s42, 8192
  s_addc_u32 s43, s43, 0
  global_load_ushort v55, v31, s[42:43]
  s_add_u32 s42, s42, 204800
  s_addc_u32 s43, s43, 0
  global_load_ushort v56, v31, s[42:43]
  s_add_u32 s42, s42, 8192
  s_addc_u32 s43, s43, 0
  global_load_ushort v57, v31, s[42:43]
  s_add_u32 s42, s42, 8192
  s_addc_u32 s43, s43, 0
  global_load_ushort v58, v31, s[42:43]
  s_add_u32 s42, s42, 8192
  s_addc_u32 s43, s43, 0
  global_load_ushort v59, v31, s[42:43]
  s_add_u32 s42, s42, 8192
  s_addc_u32 s43, s43, 0
  global_load_ushort v60, v31, s[42:43]
  s_add_u32 s42, s42, 8192
  s_addc_u32 s43, s43, 0
  global_load_ushort v61, v31, s[42:43]
  s_add_u32 s42, s42, 8192
  s_addc_u32 s43, s43, 0
  global_load_ushort v62, v31, s[42:43]
  s_add_u32 s42, s42, 8192
  s_addc_u32 s43, s43, 0
  global_load_ushort v63, v31, s[42:43]
  s_add_u32 s42, s42, 204800
  s_addc_u32 s43, s43, 0
  global_load_ushort v64, v31, s[42:43]
  s_add_u32 s42, s42, 8192
  s_addc_u32 s43, s43, 0
  global_load_ushort v65, v31, s[42:43]
  s_add_u32 s42, s42, 8192
  s_addc_u32 s43, s43, 0
  global_load_ushort v66, v31, s[42:43]
  s_add_u32 s42, s42, 8192
  s_addc_u32 s43, s43, 0
  global_load_ushort v67, v31, s[42:43]
  s_add_u32 s42, s42, 8192
  s_addc_u32 s43, s43, 0
  global_load_ushort v68, v31, s[42:43]
  s_add_u32 s42, s42, 8192
  s_addc_u32 s43, s43, 0
  global_load_ushort v69, v31, s[42:43]
  s_add_u32 s42, s42, 8192
  s_addc_u32 s43, s43, 0
  global_load_ushort v70, v31, s[42:43]
  s_add_u32 s42, s42, 8192
  s_addc_u32 s43, s43, 0
  global_load_ushort v71, v31, s[42:43]
  s_add_u32 s42, s42, 204800
  s_addc_u32 s43, s43, 0
  global_load_ushort v72, v31, s[42:43]
  s_add_u32 s42, s42, 8192
  s_addc_u32 s43, s43, 0
  global_load_ushort v73, v31, s[42:43]
  s_add_u32 s42, s42, 8192
  s_addc_u32 s43, s43, 0
  global_load_ushort v74, v31, s[42:43]
  s_add_u32 s42, s42, 8192
  s_addc_u32 s43, s43, 0
  global_load_ushort v75, v31, s[42:43]
  s_add_u32 s42, s42, 8192
  s_addc_u32 s43, s43, 0
  global_load_ushort v76, v31, s[42:43]
  s_add_u32 s42, s42, 8192
  s_addc_u32 s43, s43, 0
  global_load_ushort v77, v31, s[42:43]
  s_add_u32 s42, s42, 8192
  s_addc_u32 s43, s43, 0
  global_load_ushort v78, v31, s[42:43]
  s_add_u32 s42, s42, 8192
  s_addc_u32 s43, s43, 0
  global_load_ushort v79, v31, s[42:43]
  s_add_u32 s42, s42, 204800
  s_addc_u32 s43, s43, 0
  s_cmp_eq_u32 s3, 0
  s_cbranch_scc0 L_if_26
  v_lshlrev_b32 v116, 4, v1
  s_nop 1
L_pl_27:
  global_load_dwordx4 v[120:123], v25, s[44:45] sc1
  s_waitcnt vmcnt(0)
  v_max3_u32 v117, v120, v121, v122
  v_max_u32 v117, v117, v123
  v_cmp_eq_u32 vcc, -1, v117
  s_sub_u32 s30, s30, 1
  s_cselect_b32 s30, 0, s30
  s_cbranch_scc1 L_pd_28
  s_cbranch_vccnz L_pl_27
L_pd_28:
  v_lshlrev_b32 v108, 16, v120
  v_and_b32 v109, 0xffff0000, v120
  v_lshlrev_b32 v110, 16, v121
  v_and_b32 v111, 0xffff0000, v121
  v_lshlrev_b32 v112, 16, v122
  v_and_b32 v113, 0xffff0000, v122
  v_lshlrev_b32 v114, 16, v123
  v_and_b32 v115, 0xffff0000, v123
  v_readfirstlane_b32 s67, v108
  s_nop 1
  v_subrev_f32 v104, s67, v108
  v_subrev_f32 v105, s67, v109
  v_add_f32 v117, v104, v105
  v_mul_f32 v118, v104, v104
  v_mul_f32 v119, v105, v105
  v_subrev_f32 v104, s67, v110
  v_subrev_f32 v105, s67, v111
  v_add_f32 v117, v117, v104
  v_fmac_f32 v118, v104, v104
  v_add_f32 v117, v117, v105
  v_fmac_f32 v119, v105, v105
  v_subrev_f32 v104, s67, v112
  v_subrev_f32 v105, s67, v113
  v_add_f32 v117, v117, v104
  v_fmac_f32 v118, v104, v104
  v_add_f32 v117, v117, v105
  v_fmac_f32 v119, v105, v105
  v_subrev_f32 v104, s67, v114
  v_subrev_f32 v105, s67, v115
  v_add_f32 v117, v117, v104
  v_fmac_f32 v118, v104, v104
  v_add_f32 v117, v117, v105
  v_fmac_f32 v119, v105, v105
  v_add_f32 v118, v118, v119
  v_add_f32_dpp v117, v117, v117 quad_perm:[1,0,3,2] row_mask:0xf bank_mask:0xf
  s_nop 0
  v_add_f32_dpp v118, v118, v118 quad_perm:[1,0,3,2] row_mask:0xf bank_mask:0xf
  v_add_f32_dpp v117, v117, v117 quad_perm:[2,3,0,1] row_mask:0xf bank_mask:0xf
  s_nop 0
  v_add_f32_dpp v118, v118, v118 quad_perm:[2,3,0,1] row_mask:0xf bank_mask:0xf
  v_add_f32_dpp v117, v117, v117 row_half_mirror row_mask:0xf bank_mask:0xf
  s_nop 0
  v_add_f32_dpp v118, v118, v118 row_half_mirror row_mask:0xf bank_mask:0xf
  v_add_f32_dpp v117, v117, v117 row_mirror row_mask:0xf bank_mask:0xf
  s_nop 0
  v_add_f32_dpp v118, v118, v118 row_mirror row_mask:0xf bank_mask:0xf
  v_mov_b32 v106, v117
  v_mov_b32 v107, v118
  s_nop 0
  v_permlane16_swap_b32 v117, v106
  v_permlane16_swap_b32 v118, v107
  v_add_f32 v117, v117, v106
  v_add_f32 v118, v118, v107
  v_mov_b32 v106, v117
  v_mov_b32 v107, v118
  s_nop 0
  v_permlane32_swap_b32 v117, v106
  v_permlane32_swap_b32 v118, v107
  v_add_f32 v117, v117, v106
  v_add_f32 v118, v118, v107
  v_mul_f32 v117, 0x3b000000, v117
  v_mul_f32 v118, 0x3b000000, v118
  v_fma_f32 v118, -v117, v117, v118
  v_max_f32 v118, 0, v118
  v_add_f32 v117, s67, v117
  v_cvt_pk_bf16_f32 v119, v117, v118
  v_lshlrev_b32 v117, 16, v119
  v_and_b32 v118, 0xffff0000, v119
  v_add_f32 v118, 0x3727c5ac, v118
  v_cvt_pk_bf16_f32 v118, v118, v118
  v_lshlrev_b32 v118, 16, v118
  v_sqrt_f32 v118, v118
  v_sub_f32 v108, v108, v117
  v_sub_f32 v109, v109, v117
  v_sub_f32 v110, v110, v117
  v_sub_f32 v111, v111, v117
  v_sub_f32 v112, v112, v117
  v_sub_f32 v113, v113, v117
  v_sub_f32 v114, v114, v117
  v_sub_f32 v115, v115, v117
  v_cvt_pk_bf16_f32 v118, v118, v118
  v_lshlrev_b32 v118, 16, v118
  v_rcp_f32 v118, v118
  v_cvt_pk_bf16_f32 v104, v108, v109
  v_cvt_pk_bf16_f32 v105, v110, v111
  v_cvt_pk_bf16_f32 v106, v112, v113
  v_cvt_pk_bf16_f32 v107, v114, v115
  v_lshlrev_b32 v108, 16, v104
  v_and_b32 v109, 0xffff0000, v104
  v_lshlrev_b32 v110, 16, v105
  v_and_b32 v111, 0xffff0000, v105
  v_lshlrev_b32 v112, 16, v106
  v_and_b32 v113, 0xffff0000, v106
  v_lshlrev_b32 v114, 16, v107
  v_and_b32 v115, 0xffff0000, v107
  v_mul_f32 v108, v108, v118
  v_mul_f32 v109, v109, v118
  v_mul_f32 v110, v110, v118
  v_mul_f32 v111, v111, v118
  v_mul_f32 v112, v112, v118
  v_mul_f32 v113, v113, v118
  v_mul_f32 v114, v114, v118
  v_mul_f32 v115, v115, v118
  v_cvt_pk_bf16_f32 v104, v108, v109
  v_cvt_pk_bf16_f32 v105, v110, v111
  v_cvt_pk_bf16_f32 v106, v112, v113
  v_cvt_pk_bf16_f32 v107, v114, v115
  ds_write_b128 v116, v[104:107] offset:12288
  s_waitcnt lgkmcnt(0)
L_if_26:
  s_barrier
  s_lshl_b32 s31, s3, 8
  v_lshl_add_u32 v31, v3, 4, s31
  ds_read_b128 v[104:107], v31 offset:12288
  ds_read_b128 v[108:111], v31 offset:12352
  ds_read_b128 v[112:115], v31 offset:12416
  ds_read_b128 v[116:119], v31 offset:12480
  s_lshl_b32 s31, s3, 6
  v_lshl_add_u32 v31, v2, 2, s31
  s_waitcnt lgkmcnt(0)
  v_mfma_f32_16x16x32_bf16 v[80:83], v[104:107], v[32:35], 0
  v_mfma_f32_16x16x32_bf16 v[80:83], v[108:111], v[36:39], v[80:83]
  v_mfma_f32_16x16x32_bf16 v[80:83], v[112:115], v[40:43], v[80:83]
  v_mfma_f32_16x16x32_bf16 v[80:83], v[116:119], v[44:47], v[80:83]
  s_nop 7
  ds_write_b32 v31, v80 offset:8960
  s_waitcnt lgkmcnt(0)
  s_barrier
  v_lshlrev_b32 v31, 2, v2
  ds_read_b32 v104, v31 offset:8960
  ds_read_b32 v105, v31 offset:9024
  ds_read_b32 v106, v31 offset:9088
  ds_read_b32 v107, v31 offset:9152
  s_waitcnt lgkmcnt(0)
  v_add_f32 v104, v104, v105
  v_add_f32 v106, v106, v107
  v_add_f32 v108, v104, v106
  v_cvt_pk_bf16_f32 v109, v108, v108
  v_lshlrev_b32 v109, 16, v109
  s_nop 1
  v_mov_b32_dpp v110, v109 row_ror:8 row_mask:0xf bank_mask:0xf
  v_mul_f32 v111, 0xbfb8aa3b, v109
  v_exp_f32 v111, v111
  s_nop 0
  v_add_f32 v111, 1.0, v111
  v_rcp_f32 v111, v111
  s_nop 0
  v_mul_f32 v111, v109, v111
  v_cvt_pk_bf16_f32 v111, v111, v111
  v_lshlrev_b32 v111, 16, v111
  v_mul_f32 v111, v111, v110
  s_nop 1
  v_mov_b32_dpp v112, v111 quad_perm:[0,0,2,2] row_mask:0xf bank_mask:0xf
  v_mov_b32_dpp v113, v111 quad_perm:[1,1,3,3] row_mask:0xf bank_mask:0xf
  v_cvt_pk_bf16_f32 v112, v112, v113
  s_nop 0
  v_readlane_b32 s48, v112, 0
  v_readlane_b32 s49, v112, 2
  v_readlane_b32 s50, v112, 4
  v_readlane_b32 s51, v112, 6
  v_mov_b32 v114, 0
  v_mov_b32 v115, 0
  v_dot2_f32_bf16 v114, s48, v96, v114
  v_dot2_f32_bf16 v115, s48, v97, v115
  v_dot2_f32_bf16 v114, s49, v98, v114
  v_dot2_f32_bf16 v115, s49, v99, v115
  v_dot2_f32_bf16 v114, s50, v100, v114
  v_dot2_f32_bf16 v115, s50, v101, v115
  v_dot2_f32_bf16 v114, s51, v102, v114
  v_dot2_f32_bf16 v115, s51, v103, v115
  s_nop 1
  v_min_u32 v114, s63, v114
  v_min_u32 v115, s63, v115
  v_lshlrev_b32 v104, 3, v0
  v_add_u32 v104, 12288, v104
  global_store_dwordx2 v104, v[114:115], s[40:41] sc1
L_if_25:
  s_cmp_ge_u32 s2, 224
  s_cbranch_scc0 L_if_29
  s_lshl_b32 s31, s3, 7
  v_lshl_add_u32 v31, v3, 3, s31
  v_lshlrev_b32 v31, 13, v31
  v_lshl_add_u32 v31, v2, 1, v31
  s_lshl_b32 s31, s64, 5
  s_add_u32 s42, s10, s31
  s_addc_u32 s43, s11, 0
  global_load_ushort v48, v31, s[42:43]
  s_add_u32 s42, s42, 8192
  s_addc_u32 s43, s43, 0
  global_load_ushort v49, v31, s[42:43]
  s_add_u32 s42, s42, 8192
  s_addc_u32 s43, s43, 0
  global_load_ushort v50, v31, s[42:43]
  s_add_u32 s42, s42, 8192
  s_addc_u32 s43, s43, 0
  global_load_ushort v51, v31, s[42:43]
  s_add_u32 s42, s42, 8192
  s_addc_u32 s43, s43, 0
  global_load_ushort v52, v31, s[42:43]
  s_add_u32 s42, s42, 8192
  s_addc_u32 s43, s43, 0
  global_load_ushort v53, v31, s[42:43]
  s_add_u32 s42, s42, 8192
  s_addc_u32 s43, s43, 0
  global_load_ushort v54, v31, s[42:43]
  s_add_u32 s42, s42, 8192
  s_addc_u32 s43, s43, 0
  global_load_ushort v55, v31, s[42:43]
  s_add_u32 s42, s42, 204800
  s_addc_u32 s43, s43, 0
  global_load_ushort v56, v31, s[42:43]
  s_add_u32 s42, s42, 8192
  s_addc_u32 s43, s43, 0
  global_load_ushort v57, v31, s[42:43]
  s_add_u32 s42, s42, 8192
  s_addc_u32 s43, s43, 0
  global_load_ushort v58, v31, s[42:43]
  s_add_u32 s42, s42, 8192
  s_addc_u32 s43, s43, 0
  global_load_ushort v59, v31, s[42:43]
  s_add_u32 s42, s42, 8192
  s_addc_u32 s43, s43, 0
  global_load_ushort v60, v31, s[42:43]
  s_add_u32 s42, s42, 8192
  s_addc_u32 s43, s43, 0
  global_load_ushort v61, v31, s[42:43]
  s_add_u32 s42, s42, 8192
  s_addc_u32 s43, s43, 0
  global_load_ushort v62, v31, s[42:43]
  s_add_u32 s42, s42, 8192
  s_addc_u32 s43, s43, 0
  global_load_ushort v63, v31, s[42:43]
  s_add_u32 s42, s42, 204800
  s_addc_u32 s43, s43, 0
  global_load_ushort v64, v31, s[42:43]
  s_add_u32 s42, s42, 8192
  s_addc_u32 s43, s43, 0
  global_load_ushort v65, v31, s[42:43]
  s_add_u32 s42, s42, 8192
  s_addc_u32 s43, s43, 0
  global_load_ushort v66, v31, s[42:43]
  s_add_u32 s42, s42, 8192
  s_addc_u32 s43, s43, 0
  global_load_ushort v67, v31, s[42:43]
  s_add_u32 s42, s42, 8192
  s_addc_u32 s43, s43, 0
  global_load_ushort v68, v31, s[42:43]
  s_add_u32 s42, s42, 8192
  s_addc_u32 s43, s43, 0
  global_load_ushort v69, v31, s[42:43]
  s_add_u32 s42, s42, 8192
  s_addc_u32 s43, s43, 0
  global_load_ushort v70, v31, s[42:43]
  s_add_u32 s42, s42, 8192
  s_addc_u32 s43, s43, 0
  global_load_ushort v71, v31, s[42:43]
  s_add_u32 s42, s42, 204800
  s_addc_u32 s43, s43, 0
  global_load_ushort v72, v31, s[42:43]
  s_add_u32 s42, s42, 8192
  s_addc_u32 s43, s43, 0
  global_load_ushort v73, v31, s[42:43]
  s_add_u32 s42, s42, 8192
  s_addc_u32 s43, s43, 0
  global_load_ushort v74, v31, s[42:43]
  s_add_u32 s42, s42, 8192
  s_addc_u32 s43, s43, 0
  global_load_ushort v75, v31, s[42:43]
  s_add_u32 s42, s42, 8192
  s_addc_u32 s43, s43, 0
  global_load_ushort v76, v31, s[42:43]
  s_add_u32 s42, s42, 8192
  s_addc_u32 s43, s43, 0
  global_load_ushort v77, v31, s[42:43]
  s_add_u32 s42, s42, 8192
  s_addc_u32 s43, s43, 0
  global_load_ushort v78, v31, s[42:43]
  s_add_u32 s42, s42, 8192
  s_addc_u32 s43, s43, 0
  global_load_ushort v79, v31, s[42:43]
  s_add_u32 s42, s42, 204800
  s_addc_u32 s43, s43, 0
L_if_29:
  s_cmp_lt_u32 s2, 32
  s_cbranch_scc0 L_if_30
  v_lshrrev_b32 v104, 2, v0
  v_lshlrev_b32 v104, 14, v104
  v_and_b32 v105, 3, v0
  v_lshl_add_u32 v104, v105, 4, v104
  s_lshl_b32 s31, s2, 6
  s_add_u32 s31, s31, 143360
  v_add_u32 v104, s31, v104
  v_add_u32 v106, 1048576, v104
  v_add_u32 v107, 2097152, v104
  v_add_u32 v108, 3145728, v104
  s_nop 1
L_pl_31:
  global_load_dwordx4 v[112:115], v104, s[26:27] sc1
  global_load_dwordx4 v[116:119], v106, s[26:27] sc1
  global_load_dwordx4 v[120:123], v107, s[26:27] sc1
  global_load_dwordx4 v[124:127], v108, s[26:27] sc1
  s_waitcnt vmcnt(0)
  v_max3_u32 v109, v112, v113, v114
  v_max3_u32 v109, v109, v115, v116
  v_max3_u32 v109, v109, v117, v118
  v_max3_u32 v109, v109, v119, v120
  v_max3_u32 v109, v109, v121, v122
  v_max3_u32 v109, v109, v123, v124
  v_max3_u32 v109, v109, v125, v126
  v_max_u32 v109, v109, v127
  v_cmp_eq_u32 vcc, -1, v109
  s_sub_u32 s30, s30, 1
  s_cselect_b32 s30, 0, s30
  s_cbranch_scc1 L_pd_32
  s_cbranch_vccnz L_pl_31
L_pd_32:
  v_add_f32 v112, v112, v116
  v_add_f32 v120, v120, v124
  v_add_f32 v113, v113, v117
  v_add_f32 v121, v121, v125
  v_add_f32 v114, v114, v118
  v_add_f32 v122, v122, v126
  v_add_f32 v115, v115, v119
  v_add_f32 v123, v123, v127
  v_add_f32 v112, v112, v120
  v_add_f32 v113, v113, v121
  v_add_f32 v114, v114, v122
  v_add_f32 v115, v115, v123
  v_add_f32_dpp v112, v112, v112 row_ror:4 row_mask:0xf bank_mask:0xf
  v_add_f32_dpp v113, v113, v113 row_ror:4 row_mask:0xf bank_mask:0xf
  v_add_f32_dpp v114, v114, v114 row_ror:4 row_mask:0xf bank_mask:0xf
  v_add_f32_dpp v115, v115, v115 row_ror:4 row_mask:0xf bank_mask:0xf
  v_add_f32_dpp v112, v112, v112 row_ror:8 row_mask:0xf bank_mask:0xf
  v_add_f32_dpp v113, v113, v113 row_ror:8 row_mask:0xf bank_mask:0xf
  v_add_f32_dpp v114, v114, v114 row_ror:8 row_mask:0xf bank_mask:0xf
  v_add_f32_dpp v115, v115, v115 row_ror:8 row_mask:0xf bank_mask:0xf
  v_mov_b32 v116, v112
  v_mov_b32 v117, v113
  v_mov_b32 v118, v114
  v_mov_b32 v119, v115
  v_permlane16_swap_b32 v112, v116
  v_permlane16_swap_b32 v113, v117
  v_permlane16_swap_b32 v114, v118
  v_permlane16_swap_b32 v115, v119
  v_add_f32 v112, v112, v116
  v_add_f32 v113, v113, v117
  v_add_f32 v114, v114, v118
  v_add_f32 v115, v115, v119
  v_mov_b32 v116, v112
  v_mov_b32 v117, v113
  v_mov_b32 v118, v114
  v_mov_b32 v119, v115
  v_permlane32_swap_b32 v112, v116
  v_permlane32_swap_b32 v113, v117
  v_permlane32_swap_b32 v114, v118
  v_permlane32_swap_b32 v115, v119
  v_add_f32 v112, v112, v116
  v_add_f32 v113, v113, v117
  v_add_f32 v114, v114, v118
  v_add_f32 v115, v115, v119
  s_lshl_b32 s31, s3, 6
  v_lshl_add_u32 v109, v105, 4, s31
  ds_write_b128 v109, v[112:115] offset:9216
  v_lshlrev_b32 v109, 4, v105
  s_waitcnt lgkmcnt(0)
  s_barrier
  ds_read_b128 v[112:115], v109 offset:9216
  ds_read_b128 v[116:119], v109 offset:9280
  ds_read_b128 v[120:123], v109 offset:9344
  ds_read_b128 v[124:127], v109 offset:9408
  s_waitcnt lgkmcnt(0)
  v_add_f32 v112, v112, v116
  v_add_f32 v120, v120, v124
  v_add_f32 v113, v113, v117
  v_add_f32 v121, v121, v125
  v_add_f32 v114, v114, v118
  v_add_f32 v122, v122, v126
  v_add_f32 v115, v115, v119
  v_add_f32 v123, v123, v127
  v_add_f32 v112, v112, v120
  v_add_f32 v113, v113, v121
  v_add_f32 v114, v114, v122
  v_add_f32 v115, v115, v123
  v_cvt_pk_bf16_f32 v116, v112, v113
  v_cvt_pk_bf16_f32 v117, v114, v115
  v_lshlrev_b32 v112, 16, v116
  v_and_b32 v113, 0xffff0000, v116
  v_lshlrev_b32 v120, 16, v26
  v_and_b32 v121, 0xffff0000, v26
  v_lshlrev_b32 v114, 16, v117
  v_and_b32 v115, 0xffff0000, v117
  v_lshlrev_b32 v122, 16, v27
  v_and_b32 v123, 0xffff0000, v27
  v_add_f32 v112, v112, v120
  v_add_f32 v113, v113, v121
  v_add_f32 v114, v114, v122
  v_add_f32 v115, v115, v123
  v_cvt_pk_bf16_f32 v26, v112, v113
  v_cvt_pk_bf16_f32 v27, v114, v115
  s_cmp_eq_u32 s3, 0
  s_cbranch_scc0 L_if_33
  s_lshl_b32 s31, s2, 7
  s_add_u32 s31, s31, 73728
  v_lshl_add_u32 v109, v105, 3, s31
  v_min_u32 v112, s63, v26
  v_min_u32 v113, s63, v27
  global_store_dwordx2 v109, v[112:113], s[26:27] sc1
L_if_33:
L_if_30:
  s_waitcnt vmcnt(0)
  v_lshl_or_b32 v80, v49, 16, v48
  v_lshl_or_b32 v81, v51, 16, v50
  v_lshl_or_b32 v82, v53, 16, v52
  v_lshl_or_b32 v83, v55, 16, v54
  v_lshl_or_b32 v84, v57, 16, v56
  v_lshl_or_b32 v85, v59, 16, v58
  v_lshl_or_b32 v86, v61, 16, v60
  v_lshl_or_b32 v87, v63, 16, v62
  v_lshl_or_b32 v88, v65, 16, v64
  v_lshl_or_b32 v89, v67, 16, v66
  v_lshl_or_b32 v90, v69, 16, v68
  v_lshl_or_b32 v91, v71, 16, v70
  v_lshl_or_b32 v92, v73, 16, v72
  v_lshl_or_b32 v93, v75, 16, v74
  v_lshl_or_b32 v94, v77, 16, v76
  v_lshl_or_b32 v95, v79, 16, v78
  v_mov_b32 v22, 0xf149f2ca
  v_mov_b32 v23, 0
  v_mov_b32 v48, 0
  v_mov_b32 v49, 0
  v_mov_b32 v50, 0
  v_mov_b32 v51, 0
  v_mov_b32 v52, 0
  v_mov_b32 v53, 0
  v_mov_b32 v54, 0
  v_mov_b32 v55, 0
  v_mov_b32 v56, 0
  v_mov_b32 v57, 0
  v_mov_b32 v58, 0
  v_mov_b32 v59, 0
  v_mov_b32 v60, 0
  v_mov_b32 v61, 0
  v_mov_b32 v62, 0
  v_mov_b32 v63, 0
  v_mov_b32 v64, 0
  v_mov_b32 v65, 0
  v_mov_b32 v66, 0
  v_mov_b32 v67, 0
  v_mov_b32 v68, 0
  v_mov_b32 v69, 0
  v_mov_b32 v70, 0
  v_mov_b32 v71, 0
  v_mov_b32 v72, 0
  v_mov_b32 v73, 0
  v_mov_b32 v74, 0
  v_mov_b32 v75, 0
  v_mov_b32 v76, 0
  v_mov_b32 v77, 0
  v_mov_b32 v78, 0
  v_mov_b32 v79, 0
  v_and_b32 v28, 3, v2
  v_lshlrev_b32 v28, 8, v28
  v_lshl_add_u32 v28, v3, 4, v28
  s_cmp_lt_u32 s2, 32
  s_cbranch_scc0 L_if_34
  s_cmp_lg_u32 s3, 0
  s_cbranch_scc0 L_if_35
L_if_35:
L_if_34:
  s_add_u32 s44, s26, 73728
  s_addc_u32 s45, s27, 0
  s_cmp_eq_u32 s3, 0
  s_cbranch_scc0 L_if_36
  v_lshlrev_b32 v116, 4, v1
  s_nop 1
L_pl_37:
  global_load_dwordx4 v[120:123], v25, s[44:45] sc1
  s_waitcnt vmcnt(0)
  v_max3_u32 v117, v120, v121, v122
  v_max_u32 v117, v117, v123
  v_cmp_eq_u32 vcc, -1, v117
  s_sub_u32 s30, s30, 1
  s_cselect_b32 s30, 0, s30
  s_cbranch_scc1 L_pd_38
  s_cbranch_vccnz L_pl_37
L_pd_38:
  v_lshlrev_b32 v108, 16, v120
  v_and_b32 v109, 0xffff0000, v120
  v_lshlrev_b32 v110, 16, v121
  v_and_b32 v111, 0xffff0000, v121
  v_lshlrev_b32 v112, 16, v122
  v_and_b32 v113, 0xffff0000, v122
  v_lshlrev_b32 v114, 16, v123
  v_and_b32 v115, 0xffff0000, v123
  v_readfirstlane_b32 s67, v108
  s_nop 1
  v_subrev_f32 v104, s67, v108
  v_subrev_f32 v105, s67, v109
  v_add_f32 v117, v104, v105
  v_mul_f32 v118, v104, v104
  v_mul_f32 v119, v105, v105
  v_subrev_f32 v104, s67, v110
  v_subrev_f32 v105, s67, v111
  v_add_f32 v117, v117, v104
  v_fmac_f32 v118, v104, v104
  v_add_f32 v117, v117, v105
  v_fmac_f32 v119, v105, v105
  v_subrev_f32 v104, s67, v112
  v_subrev_f32 v105, s67, v113
  v_add_f32 v117, v117, v104
  v_fmac_f32 v118, v104, v104
  v_add_f32 v117, v117, v105
  v_fmac_f32 v119, v105, v105
  v_subrev_f32 v104, s67, v114
  v_subrev_f32 v105, s67, v115
  v_add_f32 v117, v117, v104
  v_fmac_f32 v118, v104, v104
  v_add_f32 v117, v117, v105
  v_fmac_f32 v119, v105, v105
  v_add_f32 v118, v118, v119
  v_add_f32_dpp v117, v117, v117 quad_perm:[1,0,3,2] row_mask:0xf bank_mask:0xf
  s_nop 0
  v_add_f32_dpp v118, v118, v118 quad_perm:[1,0,3,2] row_mask:0xf bank_mask:0xf
  v_add_f32_dpp v117, v117, v117 quad_perm:[2,3,0,1] row_mask:0xf bank_mask:0xf
  s_nop 0
  v_add_f32_dpp v118, v118, v118 quad_perm:[2,3,0,1] row_mask:0xf bank_mask:0xf
  v_add_f32_dpp v117, v117, v117 row_half_mirror row_mask:0xf bank_mask:0xf
  s_nop 0
  v_add_f32_dpp v118, v118, v118 row_half_mirror row_mask:0xf bank_mask:0xf
  v_add_f32_dpp v117, v117, v117 row_mirror row_mask:0xf bank_mask:0xf
  s_nop 0
  v_add_f32_dpp v118, v118, v118 row_mirror row_mask:0xf bank_mask:0xf
  v_mov_b32 v106, v117
  v_mov_b32 v107, v118
  s_nop 0
  v_permlane16_swap_b32 v117, v106
  v_permlane16_swap_b32 v118, v107
  v_add_f32 v117, v117, v106
  v_add_f32 v118, v118, v107
  v_mov_b32 v106, v117
  v_mov_b32 v107, v118
  s_nop 0
  v_permlane32_swap_b32 v117, v106
  v_permlane32_swap_b32 v118, v107
  v_add_f32 v117, v117, v106
  v_add_f32 v118, v118, v107
  v_mul_f32 v117, 0x3b000000, v117
  v_mul_f32 v118, 0x3b000000, v118
  v_fma_f32 v118, -v117, v117, v118
  v_max_f32 v118, 0, v118
  v_add_f32 v117, s67, v117
  v_cvt_pk_bf16_f32 v119, v117, v118
  v_lshlrev_b32 v117, 16, v119
  v_and_b32 v118, 0xffff0000, v119
  v_add_f32 v118, 0x3727c5ac, v118
  v_cvt_pk_bf16_f32 v118, v118, v118
  v_lshlrev_b32 v118, 16, v118
  v_sqrt_f32 v118, v118
  v_sub_f32 v108, v108, v117
  v_sub_f32 v109, v109, v117
  v_sub_f32 v110, v110, v117
  v_sub_f32 v111, v111, v117
  v_sub_f32 v112, v112, v117
  v_sub_f32 v113, v113, v117
  v_sub_f32 v114, v114, v117
  v_sub_f32 v115, v115, v117
  v_cvt_pk_bf16_f32 v118, v118, v118
  v_lshlrev_b32 v118, 16, v118
  v_rcp_f32 v118, v118
  v_cvt_pk_bf16_f32 v104, v108, v109
  v_cvt_pk_bf16_f32 v105, v110, v111
  v_cvt_pk_bf16_f32 v106, v112, v113
  v_cvt_pk_bf16_f32 v107, v114, v115
  v_lshlrev_b32 v108, 16, v104
  v_and_b32 v109, 0xffff0000, v104
  v_lshlrev_b32 v110, 16, v105
  v_and_b32 v111, 0xffff0000, v105
  v_lshlrev_b32 v112, 16, v106
  v_and_b32 v113, 0xffff0000, v106
  v_lshlrev_b32 v114, 16, v107
  v_and_b32 v115, 0xffff0000, v107
  v_mul_f32 v108, v108, v118
  v_mul_f32 v109, v109, v118
  v_mul_f32 v110, v110, v118
  v_mul_f32 v111, v111, v118
  v_mul_f32 v112, v112, v118
  v_mul_f32 v113, v113, v118
  v_mul_f32 v114, v114, v118
  v_mul_f32 v115, v115, v118
  v_cvt_pk_bf16_f32 v104, v108, v109
  v_cvt_pk_bf16_f32 v105, v110, v111
  v_cvt_pk_bf16_f32 v106, v112, v113
  v_cvt_pk_bf16_f32 v107, v114, v115
  ds_write_b128 v116, v[104:107] offset:12288
  s_waitcnt lgkmcnt(0)
L_if_36:
  s_barrier
  s_lshl_b32 s31, s3, 8
  v_lshl_add_u32 v31, v3, 4, s31
  ds_read_b128 v[104:107], v31 offset:12288
  ds_read_b128 v[108:111], v31 offset:12352
  ds_read_b128 v[112:115], v31 offset:12416
  ds_read_b128 v[116:119], v31 offset:12480
  s_lshl_b32 s31, s3, 6
  v_lshl_add_u32 v31, v2, 2, s31
  s_waitcnt lgkmcnt(0)
  v_mfma_f32_16x16x32_bf16 v[96:99], v[104:107], v[80:83], 0
  v_mfma_f32_16x16x32_bf16 v[96:99], v[108:111], v[84:87], v[96:99]
  v_mfma_f32_16x16x32_bf16 v[96:99], v[112:115], v[88:91], v[96:99]
  v_mfma_f32_16x16x32_bf16 v[96:99], v[116:119], v[92:95], v[96:99]
  s_nop 7
  ds_write_b32 v31, v96 offset:9472
  s_waitcnt lgkmcnt(0)
  s_barrier
  v_lshlrev_b32 v31, 2, v2
  ds_read_b32 v104, v31 offset:9472
  ds_read_b32 v105, v31 offset:9536
  ds_read_b32 v106, v31 offset:9600
  ds_read_b32 v107, v31 offset:9664
  s_waitcnt lgkmcnt(0)
  v_add_f32 v104, v104, v105
  v_add_f32 v106, v106, v107
  v_add_f32 v108, v104, v106
  s_nop 1
  v_mov_b32_dpp v112, v108 quad_perm:[0,0,2,2] row_mask:0xf bank_mask:0xf
  v_mov_b32_dpp v113, v108 quad_perm:[1,1,3,3] row_mask:0xf bank_mask:0xf
  v_cvt_pk_bf16_f32 v112, v112, v113
  v_min_u32 v112, s63, v112
  v_lshrrev_b32 v113, 1, v2
  v_lshlrev_b32 v113, 2, v113
  s_lshl_b32 s31, s64, 7
  s_add_u32 s31, s31, 32768
  v_add_u32 v113, s31, v113
  s_cmp_eq_u32 s3, 0
  s_cbranch_scc0 L_if_39
  global_store_dword v113, v112, s[26:27] sc1
L_if_39:
  ds_read_b128 v[80:83], v10 offset:0
  ds_read_b128 v[84:87], v11 offset:0
  ds_read_b128 v[88:91], v12 offset:0
  ds_read_b128 v[92:95], v13 offset:0
  s_waitcnt lgkmcnt(0)
  s_lshl_b32 s31, s29, 6
  s_add_u32 s31, s31, 56
  s_lshl_b32 s31, s31, 13
  s_add_u32 s31, s31, s68
  s_add_u32 s32, s6, s31
  s_addc_u32 s33, s7, 0
  s_add_u32 s34, s32, 16384
  s_addc_u32 s35, s33, 0
  s_add_u32 s36, s8, s31
  s_addc_u32 s37, s9, 0
  s_add_u32 s38, s36, 16384
  s_addc_u32 s39, s37, 0
  s_add_u32 m0, s47, 0
  s_nop 0
  global_load_lds_dwordx4 v4, s[32:33] offset:0 nt
  global_load_lds_dwordx4 v5, s[32:33] offset:1024 nt
  global_load_lds_dwordx4 v6, s[32:33] offset:2048 nt
  global_load_lds_dwordx4 v7, s[32:33] offset:3072 nt
  s_cmp_eq_u32 s3, 0
  s_cbranch_scc0 L_if_40
  s_lshl_b32 s31, s28, 12
  s_add_u32 s31, s31, 32768
  v_add_u32 v104, s31, v25
  v_lshlrev_b32 v106, 4, v1
  s_nop 1
L_pl_41:
  global_load_dwordx4 v[116:119], v104, s[26:27] sc1
  s_waitcnt vmcnt(0)
  v_max3_u32 v105, v116, v117, v118
  v_max_u32 v105, v105, v119
  v_cmp_eq_u32 vcc, -1, v105
  s_sub_u32 s30, s30, 1
  s_cselect_b32 s30, 0, s30
  s_cbranch_scc1 L_pd_42
  s_cbranch_vccnz L_pl_41
L_pd_42:
  ds_write_b128 v106, v[116:119] offset:11264
  s_waitcnt lgkmcnt(0)
L_if_40:
  s_barrier
  ds_read_b128 v[96:99], v10 offset:4096
  ds_read_b128 v[100:103], v11 offset:4096
  ds_read_b128 v[104:107], v12 offset:4096
  ds_read_b128 v[108:111], v13 offset:4096
  ds_read_b128 v[32:35], v28 offset:11264
  ds_read_b128 v[36:39], v28 offset:11328
  ds_read_b128 v[40:43], v28 offset:11392
  ds_read_b128 v[44:47], v28 offset:11456
  s_waitcnt lgkmcnt(0)
  s_add_u32 m0, s47, 4096
  s_nop 0
  global_load_lds_dwordx4 v4, s[34:35] offset:0 nt
  global_load_lds_dwordx4 v5, s[34:35] offset:1024 nt
  global_load_lds_dwordx4 v6, s[34:35] offset:2048 nt
  global_load_lds_dwordx4 v7, s[34:35] offset:3072 nt
  s_lshl_b32 s31, s29, 6
  s_add_u32 s31, s31, 56
  s_lshl_b32 s31, s31, 13
  s_add_u32 s31, s31, s68
  s_add_u32 s32, s6, s31
  s_addc_u32 s33, s7, 0
  s_add_u32 s34, s32, 16384
  s_addc_u32 s35, s33, 0
  s_add_u32 s36, s8, s31
  s_addc_u32 s37, s9, 0
  s_add_u32 s38, s36, 16384
  s_addc_u32 s39, s37, 0
  v_mfma_f32_16x16x32_bf16 v[112:115], v[80:83], v[32:35], 0
  v_mfma_f32_16x16x32_bf16 v[112:115], v[84:87], v[36:39], v[112:115]
  v_mfma_f32_16x16x32_bf16 v[112:115], v[88:91], v[40:43], v[112:115]
  v_mfma_f32_16x16x32_bf16 v[112:115], v[92:95], v[44:47], v[112:115]
  v_mfma_f32_16x16x32_bf16 v[116:119], v[96:99], v[32:35], 0
  v_mfma_f32_16x16x32_bf16 v[116:119], v[100:103], v[36:39], v[116:119]
  v_mfma_f32_16x16x32_bf16 v[116:119], v[104:107], v[40:43], v[116:119]
  v_mfma_f32_16x16x32_bf16 v[116:119], v[108:111], v[44:47], v[116:119]
  s_waitcnt vmcnt(24)
  ds_read_b64_tr_b16 v[80:81], v14 offset:8192
  ds_read_b64_tr_b16 v[84:85], v15 offset:8192
  ds_read_b64_tr_b16 v[88:89], v16 offset:8192
  ds_read_b64_tr_b16 v[92:93], v17 offset:8192
  ds_read_b64_tr_b16 v[96:97], v18 offset:8192
  ds_read_b64_tr_b16 v[100:101], v19 offset:8192
  ds_read_b64_tr_b16 v[104:105], v20 offset:8192
  ds_read_b64_tr_b16 v[108:109], v21 offset:8192
  ds_read_b64_tr_b16 v[82:83], v14 offset:12288
  ds_read_b64_tr_b16 v[86:87], v15 offset:12288
  ds_read_b64_tr_b16 v[90:91], v16 offset:12288
  ds_read_b64_tr_b16 v[94:95], v17 offset:12288
  ds_read_b64_tr_b16 v[98:99], v18 offset:12288
  ds_read_b64_tr_b16 v[102:103], v19 offset:12288
  ds_read_b64_tr_b16 v[106:107], v20 offset:12288
  ds_read_b64_tr_b16 v[110:111], v21 offset:12288
  v_cvt_pk_bf16_f32 v120, v112, v113
  v_cvt_pk_bf16_f32 v121, v114, v115
  v_cvt_pk_bf16_f32 v122, v116, v117
  v_cvt_pk_bf16_f32 v123, v118, v119
  v_lshlrev_b32 v112, 16, v120
  v_and_b32 v113, 0xffff0000, v120
  v_lshlrev_b32 v114, 16, v121
  v_and_b32 v115, 0xffff0000, v121
  v_lshlrev_b32 v116, 16, v122
  v_and_b32 v117, 0xffff0000, v122
  v_lshlrev_b32 v118, 16, v123
  v_and_b32 v119, 0xffff0000, v123
  v_mul_f32 v112, s58, v112
  v_mul_f32 v113, s58, v113
  v_mul_f32 v114, s58, v114
  v_mul_f32 v115, s58, v115
  v_mul_f32 v116, s58, v116
  v_mul_f32 v117, s58, v117
  v_mul_f32 v118, s58, v118
  v_mul_f32 v119, s58, v119
  v_cvt_pk_bf16_f32 v120, v112, v113
  v_cvt_pk_bf16_f32 v121, v114, v115
  v_cvt_pk_bf16_f32 v122, v116, v117
  v_cvt_pk_bf16_f32 v123, v118, v119
  v_lshlrev_b32 v112, 16, v120
  v_and_b32 v113, 0xffff0000, v120
  v_lshlrev_b32 v114, 16, v121
  v_and_b32 v115, 0xffff0000, v121
  v_lshlrev_b32 v116, 16, v122
  v_and_b32 v117, 0xffff0000, v122
  v_lshlrev_b32 v118, 16, v123
  v_and_b32 v119, 0xffff0000, v123
  v_max3_f32 v124, v112, v113, v114
  v_max3_f32 v125, v115, v116, v117
  v_max3_f32 v124, v124, v118, v119
  v_max_f32 v124, v124, v125
  v_mov_b32 v125, v124
  s_nop 1
  v_permlane16_swap_b32 v124, v125
  v_max_f32 v124, v124, v125
  v_mov_b32 v125, v124
  s_nop 1
  v_permlane32_swap_b32 v124, v125
  v_max_f32 v124, v124, v125
  v_mul_f32 v124, s62, v124
  v_max_f32 v124, v124, v22
  v_sub_f32 v24, v22, v124
  v_exp_f32 v24, v24
  v_mov_b32 v22, v124
  v_fma_f32 v112, v112, s62, -v22
  v_fma_f32 v113, v113, s62, -v22
  v_fma_f32 v114, v114, s62, -v22
  v_fma_f32 v115, v115, s62, -v22
  v_fma_f32 v116, v116, s62, -v22
  v_fma_f32 v117, v117, s62, -v22
  v_fma_f32 v118, v118, s62, -v22
  v_fma_f32 v119, v119, s62, -v22
  v_exp_f32 v112, v112
  v_exp_f32 v113, v113
  v_exp_f32 v114, v114
  v_exp_f32 v115, v115
  v_exp_f32 v116, v116
  v_exp_f32 v117, v117
  v_exp_f32 v118, v118
  v_exp_f32 v119, v119
  v_mul_f32 v23, v23, v24
  v_cvt_pk_bf16_f32 v120, v112, v113
  v_cvt_pk_bf16_f32 v121, v114, v115
  v_cvt_pk_bf16_f32 v122, v116, v117
  v_cvt_pk_bf16_f32 v123, v118, v119
  v_add_f32 v124, v112, v113
  v_add_f32 v125, v114, v115
  v_add_f32 v124, v124, v116
  v_add_f32 v125, v125, v117
  v_add_f32 v124, v124, v118
  v_add_f32 v125, v125, v119
  v_add_f32 v124, v124, v125
  v_add_f32 v23, v23, v124
  v_mul_f32_dpp v48, v24, v48 quad_perm:[0,0,0,0] row_mask:0xf bank_mask:0xf
  v_mul_f32_dpp v49, v24, v49 quad_perm:[1,1,1,1] row_mask:0xf bank_mask:0xf
  v_mul_f32_dpp v50, v24, v50 quad_perm:[2,2,2,2] row_mask:0xf bank_mask:0xf
  v_mul_f32_dpp v51, v24, v51 quad_perm:[3,3,3,3] row_mask:0xf bank_mask:0xf
  v_mul_f32_dpp v52, v24, v52 quad_perm:[0,0,0,0] row_mask:0xf bank_mask:0xf
  v_mul_f32_dpp v53, v24, v53 quad_perm:[1,1,1,1] row_mask:0xf bank_mask:0xf
  v_mul_f32_dpp v54, v24, v54 quad_perm:[2,2,2,2] row_mask:0xf bank_mask:0xf
  v_mul_f32_dpp v55, v24, v55 quad_perm:[3,3,3,3] row_mask:0xf bank_mask:0xf
  v_mul_f32_dpp v56, v24, v56 quad_perm:[0,0,0,0] row_mask:0xf bank_mask:0xf
  v_mul_f32_dpp v57, v24, v57 quad_perm:[1,1,1,1] row_mask:0xf bank_mask:0xf
  v_mul_f32_dpp v58, v24, v58 quad_perm:[2,2,2,2] row_mask:0xf bank_mask:0xf
  v_mul_f32_dpp v59, v24, v59 quad_perm:[3,3,3,3] row_mask:0xf bank_mask:0xf
  v_mul_f32_dpp v60, v24, v60 quad_perm:[0,0,0,0] row_mask:0xf bank_mask:0xf
  v_mul_f32_dpp v61, v24, v61 quad_perm:[1,1,1,1] row_mask:0xf bank_mask:0xf
  v_mul_f32_dpp v62, v24, v62 quad_perm:[2,2,2,2] row_mask:0xf bank_mask:0xf
  v_mul_f32_dpp v63, v24, v63 quad_perm:[3,3,3,3] row_mask:0xf bank_mask:0xf
  v_mul_f32_dpp v64, v24, v64 quad_perm:[0,0,0,0] row_mask:0xf bank_mask:0xf
  v_mul_f32_dpp v65, v24, v65 quad_perm:[1,1,1,1] row_mask:0xf bank_mask:0xf
  v_mul_f32_dpp v66, v24, v66 quad_perm:[2,2,2,2] row_mask:0xf bank_mask:0xf
  v_mul_f32_dpp v67, v24, v67 quad_perm:[3,3,3,3] row_mask:0xf bank_mask:0xf
  v_mul_f32_dpp v68, v24, v68 quad_perm:[0,0,0,0] row_mask:0xf bank_mask:0xf
  v_mul_f32_dpp v69, v24, v69 quad_perm:[1,1,1,1] row_mask:0xf bank_mask:0xf
  v_mul_f32_dpp v70, v24, v70 quad_perm:[2,2,2,2] row_mask:0xf bank_mask:0xf
  v_mul_f32_dpp v71, v24, v71 quad_perm:[3,3,3,3] row_mask:0xf bank_mask:0xf
  v_mul_f32_dpp v72, v24, v72 quad_perm:[0,0,0,0] row_mask:0xf bank_mask:0xf
  v_mul_f32_dpp v73, v24, v73 quad_perm:[1,1,1,1] row_mask:0xf bank_mask:0xf
  v_mul_f32_dpp v74, v24, v74 quad_perm:[2,2,2,2] row_mask:0xf bank_mask:0xf
  v_mul_f32_dpp v75, v24, v75 quad_perm:[3,3,3,3] row_mask:0xf bank_mask:0xf
  v_mul_f32_dpp v76, v24, v76 quad_perm:[0,0,0,0] row_mask:0xf bank_mask:0xf
  v_mul_f32_dpp v77, v24, v77 quad_perm:[1,1,1,1] row_mask:0xf bank_mask:0xf
  v_mul_f32_dpp v78, v24, v78 quad_perm:[2,2,2,2] row_mask:0xf bank_mask:0xf
  v_mul_f32_dpp v79, v24, v79 quad_perm:[3,3,3,3] row_mask:0xf bank_mask:0xf
  s_waitcnt lgkmcnt(0)
  v_mfma_f32_16x16x32_bf16 v[48:51], v[120:123], v[80:83], v[48:51]
  v_mfma_f32_16x16x32_bf16 v[52:55], v[120:123], v[84:87], v[52:55]
  v_mfma_f32_16x16x32_bf16 v[56:59], v[120:123], v[88:91], v[56:59]
  v_mfma_f32_16x16x32_bf16 v[60:63], v[120:123], v[92:95], v[60:63]
  v_mfma_f32_16x16x32_bf16 v[64:67], v[120:123], v[96:99], v[64:67]
  v_mfma_f32_16x16x32_bf16 v[68:71], v[120:123], v[100:103], v[68:71]
  v_mfma_f32_16x16x32_bf16 v[72:75], v[120:123], v[104:107], v[72:75]
  v_mfma_f32_16x16x32_bf16 v[76:79], v[120:123], v[108:111], v[76:79]
  s_add_u32 m0, s47, 8192
  s_nop 0
  global_load_lds_dwordx4 v8, s[36:37] offset:0 nt
  global_load_lds_dwordx4 v9, s[36:37] offset:1024 nt
  global_load_lds_dwordx4 v8, s[36:37] offset:2048 nt
  global_load_lds_dwordx4 v9, s[36:37] offset:3072 nt
  s_add_u32 m0, s47, 12288
  s_nop 0
  global_load_lds_dwordx4 v8, s[38:39] offset:0 nt
  global_load_lds_dwordx4 v9, s[38:39] offset:1024 nt
  global_load_lds_dwordx4 v8, s[38:39] offset:2048 nt
  global_load_lds_dwordx4 v9, s[38:39] offset:3072 nt
  s_waitcnt vmcnt(24)
  ds_read_b128 v[80:83], v10 offset:16384
  ds_read_b128 v[84:87], v11 offset:16384
  ds_read_b128 v[88:91], v12 offset:16384
  ds_read_b128 v[92:95], v13 offset:16384
  ds_read_b128 v[96:99], v10 offset:20480
  ds_read_b128 v[100:103], v11 offset:20480
  ds_read_b128 v[104:107], v12 offset:20480
  ds_read_b128 v[108:111], v13 offset:20480
  s_waitcnt lgkmcnt(0)
  s_lshl_b32 s31, s29, 6
  s_add_u32 s31, s31, 32
  s_lshl_b32 s31, s31, 13
  s_add_u32 s31, s31, s68
  s_add_u32 s32, s6, s31
  s_addc_u32 s33, s7, 0
  s_add_u32 s34, s32, 16384
  s_addc_u32 s35, s33, 0
  s_add_u32 s36, s8, s31
  s_addc_u32 s37, s9, 0
  s_add_u32 s38, s36, 16384
  s_addc_u32 s39, s37, 0
  v_mfma_f32_16x16x32_bf16 v[112:115], v[80:83], v[32:35], 0
  v_mfma_f32_16x16x32_bf16 v[112:115], v[84:87], v[36:39], v[112:115]
  v_mfma_f32_16x16x32_bf16 v[112:115], v[88:91], v[40:43], v[112:115]
  v_mfma_f32_16x16x32_bf16 v[112:115], v[92:95], v[44:47], v[112:115]
  v_mfma_f32_16x16x32_bf16 v[116:119], v[96:99], v[32:35], 0
  v_mfma_f32_16x16x32_bf16 v[116:119], v[100:103], v[36:39], v[116:119]
  v_mfma_f32_16x16x32_bf16 v[116:119], v[104:107], v[40:43], v[116:119]
  v_mfma_f32_16x16x32_bf16 v[116:119], v[108:111], v[44:47], v[116:119]
  s_add_u32 m0, s47, 16384
  s_nop 0
  global_load_lds_dwordx4 v4, s[32:33] offset:0 nt
  global_load_lds_dwordx4 v5, s[32:33] offset:1024 nt
  global_load_lds_dwordx4 v6, s[32:33] offset:2048 nt
  global_load_lds_dwordx4 v7, s[32:33] offset:3072 nt
  s_add_u32 m0, s47, 20480
  s_nop 0
  global_load_lds_dwordx4 v4, s[34:35] offset:0 nt
  global_load_lds_dwordx4 v5, s[34:35] offset:1024 nt
  global_load_lds_dwordx4 v6, s[34:35] offset:2048 nt
  global_load_lds_dwordx4 v7, s[34:35] offset:3072 nt
  s_waitcnt vmcnt(24)
  ds_read_b64_tr_b16 v[80:81], v14 offset:24576
  ds_read_b64_tr_b16 v[84:85], v15 offset:24576
  ds_read_b64_tr_b16 v[88:89], v16 offset:24576
  ds_read_b64_tr_b16 v[92:93], v17 offset:24576
  ds_read_b64_tr_b16 v[96:97], v18 offset:24576
  ds_read_b64_tr_b16 v[100:101], v19 offset:24576
  ds_read_b64_tr_b16 v[104:105], v20 offset:24576
  ds_read_b64_tr_b16 v[108:109], v21 offset:24576
  ds_read_b64_tr_b16 v[82:83], v14 offset:28672
  ds_read_b64_tr_b16 v[86:87], v15 offset:28672
  ds_read_b64_tr_b16 v[90:91], v16 offset:28672
  ds_read_b64_tr_b16 v[94:95], v17 offset:28672
  ds_read_b64_tr_b16 v[98:99], v18 offset:28672
  ds_read_b64_tr_b16 v[102:103], v19 offset:28672
  ds_read_b64_tr_b16 v[106:107], v20 offset:28672
  ds_read_b64_tr_b16 v[110:111], v21 offset:28672
  v_cvt_pk_bf16_f32 v120, v112, v113
  v_cvt_pk_bf16_f32 v121, v114, v115
  v_cvt_pk_bf16_f32 v122, v116, v117
  v_cvt_pk_bf16_f32 v123, v118, v119
  v_lshlrev_b32 v112, 16, v120
  v_and_b32 v113, 0xffff0000, v120
  v_lshlrev_b32 v114, 16, v121
  v_and_b32 v115, 0xffff0000, v121
  v_lshlrev_b32 v116, 16, v122
  v_and_b32 v117, 0xffff0000, v122
  v_lshlrev_b32 v118, 16, v123
  v_and_b32 v119, 0xffff0000, v123
  v_mul_f32 v112, s58, v112
  v_mul_f32 v113, s58, v113
  v_mul_f32 v114, s58, v114
  v_mul_f32 v115, s58, v115
  v_mul_f32 v116, s58, v116
  v_mul_f32 v117, s58, v117
  v_mul_f32 v118, s58, v118
  v_mul_f32 v119, s58, v119
  v_cvt_pk_bf16_f32 v120, v112, v113
  v_cvt_pk_bf16_f32 v121, v114, v115
  v_cvt_pk_bf16_f32 v122, v116, v117
  v_cvt_pk_bf16_f32 v123, v118, v119
  v_lshlrev_b32 v112, 16, v120
  v_and_b32 v113, 0xffff0000, v120
  v_lshlrev_b32 v114, 16, v121
  v_and_b32 v115, 0xffff0000, v121
  v_lshlrev_b32 v116, 16, v122
  v_and_b32 v117, 0xffff0000, v122
  v_lshlrev_b32 v118, 16, v123
  v_and_b32 v119, 0xffff0000, v123
  v_max3_f32 v124, v112, v113, v114
  v_max3_f32 v125, v115, v116, v117
  v_max3_f32 v124, v124, v118, v119
  v_max_f32 v124, v124, v125
  v_mov_b32 v125, v124
  s_nop 1
  v_permlane16_swap_b32 v124, v125
  v_max_f32 v124, v124, v125
  v_mov_b32 v125, v124
  s_nop 1
  v_permlane32_swap_b32 v124, v125
  v_max_f32 v124, v124, v125
  v_mul_f32 v124, s62, v124
  v_max_f32 v124, v124, v22
  v_sub_f32 v24, v22, v124
  v_exp_f32 v24, v24
  v_mov_b32 v22, v124
  v_fma_f32 v112, v112, s62, -v22
  v_fma_f32 v113, v113, s62, -v22
  v_fma_f32 v114, v114, s62, -v22
  v_fma_f32 v115, v115, s62, -v22
  v_fma_f32 v116, v116, s62, -v22
  v_fma_f32 v117, v117, s62, -v22
  v_fma_f32 v118, v118, s62, -v22
  v_fma_f32 v119, v119, s62, -v22
  v_exp_f32 v112, v112
  v_exp_f32 v113, v113
  v_exp_f32 v114, v114
  v_exp_f32 v115, v115
  v_exp_f32 v116, v116
  v_exp_f32 v117, v117
  v_exp_f32 v118, v118
  v_exp_f32 v119, v119
  v_mul_f32 v23, v23, v24
  v_cvt_pk_bf16_f32 v120, v112, v113
  v_cvt_pk_bf16_f32 v121, v114, v115
  v_cvt_pk_bf16_f32 v122, v116, v117
  v_cvt_pk_bf16_f32 v123, v118, v119
  v_add_f32 v124, v112, v113
  v_add_f32 v125, v114, v115
  v_add_f32 v124, v124, v116
  v_add_f32 v125, v125, v117
  v_add_f32 v124, v124, v118
  v_add_f32 v125, v125, v119
  v_add_f32 v124, v124, v125
  v_add_f32 v23, v23, v124
  v_mul_f32_dpp v48, v24, v48 quad_perm:[0,0,0,0] row_mask:0xf bank_mask:0xf
  v_mul_f32_dpp v49, v24, v49 quad_perm:[1,1,1,1] row_mask:0xf bank_mask:0xf
  v_mul_f32_dpp v50, v24, v50 quad_perm:[2,2,2,2] row_mask:0xf bank_mask:0xf
  v_mul_f32_dpp v51, v24, v51 quad_perm:[3,3,3,3] row_mask:0xf bank_mask:0xf
  v_mul_f32_dpp v52, v24, v52 quad_perm:[0,0,0,0] row_mask:0xf bank_mask:0xf
  v_mul_f32_dpp v53, v24, v53 quad_perm:[1,1,1,1] row_mask:0xf bank_mask:0xf
  v_mul_f32_dpp v54, v24, v54 quad_perm:[2,2,2,2] row_mask:0xf bank_mask:0xf
  v_mul_f32_dpp v55, v24, v55 quad_perm:[3,3,3,3] row_mask:0xf bank_mask:0xf
  v_mul_f32_dpp v56, v24, v56 quad_perm:[0,0,0,0] row_mask:0xf bank_mask:0xf
  v_mul_f32_dpp v57, v24, v57 quad_perm:[1,1,1,1] row_mask:0xf bank_mask:0xf
  v_mul_f32_dpp v58, v24, v58 quad_perm:[2,2,2,2] row_mask:0xf bank_mask:0xf
  v_mul_f32_dpp v59, v24, v59 quad_perm:[3,3,3,3] row_mask:0xf bank_mask:0xf
  v_mul_f32_dpp v60, v24, v60 quad_perm:[0,0,0,0] row_mask:0xf bank_mask:0xf
  v_mul_f32_dpp v61, v24, v61 quad_perm:[1,1,1,1] row_mask:0xf bank_mask:0xf
  v_mul_f32_dpp v62, v24, v62 quad_perm:[2,2,2,2] row_mask:0xf bank_mask:0xf
  v_mul_f32_dpp v63, v24, v63 quad_perm:[3,3,3,3] row_mask:0xf bank_mask:0xf
  v_mul_f32_dpp v64, v24, v64 quad_perm:[0,0,0,0] row_mask:0xf bank_mask:0xf
  v_mul_f32_dpp v65, v24, v65 quad_perm:[1,1,1,1] row_mask:0xf bank_mask:0xf
  v_mul_f32_dpp v66, v24, v66 quad_perm:[2,2,2,2] row_mask:0xf bank_mask:0xf
  v_mul_f32_dpp v67, v24, v67 quad_perm:[3,3,3,3] row_mask:0xf bank_mask:0xf
  v_mul_f32_dpp v68, v24, v68 quad_perm:[0,0,0,0] row_mask:0xf bank_mask:0xf
  v_mul_f32_dpp v69, v24, v69 quad_perm:[1,1,1,1] row_mask:0xf bank_mask:0xf
  v_mul_f32_dpp v70, v24, v70 quad_perm:[2,2,2,2] row_mask:0xf bank_mask:0xf
  v_mul_f32_dpp v71, v24, v71 quad_perm:[3,3,3,3] row_mask:0xf bank_mask:0xf
  v_mul_f32_dpp v72, v24, v72 quad_perm:[0,0,0,0] row_mask:0xf bank_mask:0xf
  v_mul_f32_dpp v73, v24, v73 quad_perm:[1,1,1,1] row_mask:0xf bank_mask:0xf
  v_mul_f32_dpp v74, v24, v74 quad_perm:[2,2,2,2] row_mask:0xf bank_mask:0xf
  v_mul_f32_dpp v75, v24, v75 quad_perm:[3,3,3,3] row_mask:0xf bank_mask:0xf
  v_mul_f32_dpp v76, v24, v76 quad_perm:[0,0,0,0] row_mask:0xf bank_mask:0xf
  v_mul_f32_dpp v77, v24, v77 quad_perm:[1,1,1,1] row_mask:0xf bank_mask:0xf
  v_mul_f32_dpp v78, v24, v78 quad_perm:[2,2,2,2] row_mask:0xf bank_mask:0xf
  v_mul_f32_dpp v79, v24, v79 quad_perm:[3,3,3,3] row_mask:0xf bank_mask:0xf
  s_waitcnt lgkmcnt(0)
  v_mfma_f32_16x16x32_bf16 v[48:51], v[120:123], v[80:83], v[48:51]
  v_mfma_f32_16x16x32_bf16 v[52:55], v[120:123], v[84:87], v[52:55]
  v_mfma_f32_16x16x32_bf16 v[56:59], v[120:123], v[88:91], v[56:59]
  v_mfma_f32_16x16x32_bf16 v[60:63], v[120:123], v[92:95], v[60:63]
  v_mfma_f32_16x16x32_bf16 v[64:67], v[120:123], v[96:99], v[64:67]
  v_mfma_f32_16x16x32_bf16 v[68:71], v[120:123], v[100:103], v[68:71]
  v_mfma_f32_16x16x32_bf16 v[72:75], v[120:123], v[104:107], v[72:75]
  v_mfma_f32_16x16x32_bf16 v[76:79], v[120:123], v[108:111], v[76:79]
  s_add_u32 m0, s47, 24576
  s_nop 0
  global_load_lds_dwordx4 v8, s[36:37] offset:0 nt
  global_load_lds_dwordx4 v9, s[36:37] offset:1024 nt
  global_load_lds_dwordx4 v8, s[36:37] offset:2048 nt
  global_load_lds_dwordx4 v9, s[36:37] offset:3072 nt
  s_add_u32 m0, s47, 28672
  s_nop 0
  global_load_lds_dwordx4 v8, s[38:39] offset:0 nt
  global_load_lds_dwordx4 v9, s[38:39] offset:1024 nt
  global_load_lds_dwordx4 v8, s[38:39] offset:2048 nt
  global_load_lds_dwordx4 v9, s[38:39] offset:3072 nt
  v_mfma_f32_16x16x32_bf16 v[112:115], v[128:131], v[32:35], 0
  v_mfma_f32_16x16x32_bf16 v[112:115], v[132:135], v[36:39], v[112:115]
  v_mfma_f32_16x16x32_bf16 v[112:115], v[136:139], v[40:43], v[112:115]
  v_mfma_f32_16x16x32_bf16 v[112:115], v[140:143], v[44:47], v[112:115]
  v_mfma_f32_16x16x32_bf16 v[116:119], v[144:147], v[32:35], 0
  v_mfma_f32_16x16x32_bf16 v[116:119], v[148:151], v[36:39], v[116:119]
  v_mfma_f32_16x16x32_bf16 v[116:119], v[152:155], v[40:43], v[116:119]
  v_mfma_f32_16x16x32_bf16 v[116:119], v[156:159], v[44:47], v[116:119]
  s_nop 3
  v_cvt_pk_bf16_f32 v120, v112, v113
  v_cvt_pk_bf16_f32 v121, v114, v115
  s_nop 1
  v_cvt_pk_bf16_f32 v122, v116, v117
  v_cvt_pk_bf16_f32 v123, v118, v119
  v_lshlrev_b32 v112, 16, v120
  v_and_b32 v113, 0xffff0000, v120
  v_lshlrev_b32 v114, 16, v121
  v_and_b32 v115, 0xffff0000, v121
  v_lshlrev_b32 v116, 16, v122
  v_and_b32 v117, 0xffff0000, v122
  v_lshlrev_b32 v118, 16, v123
  v_and_b32 v119, 0xffff0000, v123
  v_mul_f32 v112, s58, v112
  v_mul_f32 v113, s58, v113
  v_mul_f32 v114, s58, v114
  v_mul_f32 v115, s58, v115
  v_mul_f32 v116, s58, v116
  v_mul_f32 v117, s58, v117
  v_mul_f32 v118, s58, v118
  v_mul_f32 v119, s58, v119
  v_cvt_pk_bf16_f32 v120, v112, v113
  v_cvt_pk_bf16_f32 v121, v114, v115
  v_cvt_pk_bf16_f32 v122, v116, v117
  v_cvt_pk_bf16_f32 v123, v118, v119
  v_lshlrev_b32 v112, 16, v120
  v_and_b32 v113, 0xffff0000, v120
  v_lshlrev_b32 v114, 16, v121
  v_and_b32 v115, 0xffff0000, v121
  v_lshlrev_b32 v116, 16, v122
  v_and_b32 v117, 0xffff0000, v122
  v_lshlrev_b32 v118, 16, v123
  v_and_b32 v119, 0xffff0000, v123
  v_max3_f32 v124, v112, v113, v114
  v_max3_f32 v125, v115, v116, v117
  v_max3_f32 v124, v124, v118, v119
  v_max_f32 v124, v124, v125
  v_mov_b32 v125, v124
  s_nop 1
  v_permlane16_swap_b32 v124, v125
  v_max_f32 v124, v124, v125
  v_mov_b32 v125, v124
  s_nop 1
  v_permlane32_swap_b32 v124, v125
  v_max_f32 v124, v124, v125
  v_mul_f32 v124, s62, v124
  v_max_f32 v124, v124, v22
  v_sub_f32 v24, v22, v124
  v_exp_f32 v24, v24
  v_mov_b32 v22, v124
  v_fma_f32 v112, v112, s62, -v22
  v_fma_f32 v113, v113, s62, -v22
  v_fma_f32 v114, v114, s62, -v22
  v_fma_f32 v115, v115, s62, -v22
  v_fma_f32 v116, v116, s62, -v22
  v_fma_f32 v117, v117, s62, -v22
  v_fma_f32 v118, v118, s62, -v22
  v_fma_f32 v119, v119, s62, -v22
  v_exp_f32 v112, v112
  v_exp_f32 v113, v113
  v_exp_f32 v114, v114
  v_exp_f32 v115, v115
  v_exp_f32 v116, v116
  v_exp_f32 v117, v117
  v_exp_f32 v118, v118
  v_exp_f32 v119, v119
  v_mul_f32 v23, v23, v24
  v_cvt_pk_bf16_f32 v120, v112, v113
  v_cvt_pk_bf16_f32 v121, v114, v115
  v_cvt_pk_bf16_f32 v122, v116, v117
  v_cvt_pk_bf16_f32 v123, v118, v119
  v_add_f32 v124, v112, v113
  v_add_f32 v125, v114, v115
  v_add_f32 v124, v124, v116
  v_add_f32 v125, v125, v117
  v_add_f32 v124, v124, v118
  v_add_f32 v125, v125, v119
  v_add_f32 v124, v124, v125
  v_add_f32 v23, v23, v124
  v_mul_f32_dpp v48, v24, v48 quad_perm:[0,0,0,0] row_mask:0xf bank_mask:0xf
  v_mul_f32_dpp v49, v24, v49 quad_perm:[1,1,1,1] row_mask:0xf bank_mask:0xf
  v_mul_f32_dpp v50, v24, v50 quad_perm:[2,2,2,2] row_mask:0xf bank_mask:0xf
  v_mul_f32_dpp v51, v24, v51 quad_perm:[3,3,3,3] row_mask:0xf bank_mask:0xf
  v_mul_f32_dpp v52, v24, v52 quad_perm:[0,0,0,0] row_mask:0xf bank_mask:0xf
  v_mul_f32_dpp v53, v24, v53 quad_perm:[1,1,1,1] row_mask:0xf bank_mask:0xf
  v_mul_f32_dpp v54, v24, v54 quad_perm:[2,2,2,2] row_mask:0xf bank_mask:0xf
  v_mul_f32_dpp v55, v24, v55 quad_perm:[3,3,3,3] row_mask:0xf bank_mask:0xf
  v_mul_f32_dpp v56, v24, v56 quad_perm:[0,0,0,0] row_mask:0xf bank_mask:0xf
  v_mul_f32_dpp v57, v24, v57 quad_perm:[1,1,1,1] row_mask:0xf bank_mask:0xf
  v_mul_f32_dpp v58, v24, v58 quad_perm:[2,2,2,2] row_mask:0xf bank_mask:0xf
  v_mul_f32_dpp v59, v24, v59 quad_perm:[3,3,3,3] row_mask:0xf bank_mask:0xf
  v_mul_f32_dpp v60, v24, v60 quad_perm:[0,0,0,0] row_mask:0xf bank_mask:0xf
  v_mul_f32_dpp v61, v24, v61 quad_perm:[1,1,1,1] row_mask:0xf bank_mask:0xf
  v_mul_f32_dpp v62, v24, v62 quad_perm:[2,2,2,2] row_mask:0xf bank_mask:0xf
  v_mul_f32_dpp v63, v24, v63 quad_perm:[3,3,3,3] row_mask:0xf bank_mask:0xf
  v_mul_f32_dpp v64, v24, v64 quad_perm:[0,0,0,0] row_mask:0xf bank_mask:0xf
  v_mul_f32_dpp v65, v24, v65 quad_perm:[1,1,1,1] row_mask:0xf bank_mask:0xf
  v_mul_f32_dpp v66, v24, v66 quad_perm:[2,2,2,2] row_mask:0xf bank_mask:0xf
  v_mul_f32_dpp v67, v24, v67 quad_perm:[3,3,3,3] row_mask:0xf bank_mask:0xf
  v_mul_f32_dpp v68, v24, v68 quad_perm:[0,0,0,0] row_mask:0xf bank_mask:0xf
  v_mul_f32_dpp v69, v24, v69 quad_perm:[1,1,1,1] row_mask:0xf bank_mask:0xf
  v_mul_f32_dpp v70, v24, v70 quad_perm:[2,2,2,2] row_mask:0xf bank_mask:0xf
  v_mul_f32_dpp v71, v24, v71 quad_perm:[3,3,3,3] row_mask:0xf bank_mask:0xf
  v_mul_f32_dpp v72, v24, v72 quad_perm:[0,0,0,0] row_mask:0xf bank_mask:0xf
  v_mul_f32_dpp v73, v24, v73 quad_perm:[1,1,1,1] row_mask:0xf bank_mask:0xf
  v_mul_f32_dpp v74, v24, v74 quad_perm:[2,2,2,2] row_mask:0xf bank_mask:0xf
  v_mul_f32_dpp v75, v24, v75 quad_perm:[3,3,3,3] row_mask:0xf bank_mask:0xf
  v_mul_f32_dpp v76, v24, v76 quad_perm:[0,0,0,0] row_mask:0xf bank_mask:0xf
  v_mul_f32_dpp v77, v24, v77 quad_perm:[1,1,1,1] row_mask:0xf bank_mask:0xf
  v_mul_f32_dpp v78, v24, v78 quad_perm:[2,2,2,2] row_mask:0xf bank_mask:0xf
  v_mul_f32_dpp v79, v24, v79 quad_perm:[3,3,3,3] row_mask:0xf bank_mask:0xf
  v_mfma_f32_16x16x32_bf16 v[48:51], v[120:123], v[160:163], v[48:51]
  v_mfma_f32_16x16x32_bf16 v[52:55], v[120:123], v[164:167], v[52:55]
  v_mfma_f32_16x16x32_bf16 v[56:59], v[120:123], v[168:171], v[56:59]
  v_mfma_f32_16x16x32_bf16 v[60:63], v[120:123], v[172:175], v[60:63]
  v_mfma_f32_16x16x32_bf16 v[64:67], v[120:123], v[176:179], v[64:67]
  v_mfma_f32_16x16x32_bf16 v[68:71], v[120:123], v[180:183], v[68:71]
  v_mfma_f32_16x16x32_bf16 v[72:75], v[120:123], v[184:187], v[72:75]
  v_mfma_f32_16x16x32_bf16 v[76:79], v[120:123], v[188:191], v[76:79]
  s_waitcnt vmcnt(24)
  ds_read_b128 v[80:83], v10 offset:0
  ds_read_b128 v[84:87], v11 offset:0
  ds_read_b128 v[88:91], v12 offset:0
  ds_read_b128 v[92:95], v13 offset:0
  ds_read_b128 v[96:99], v10 offset:4096
  ds_read_b128 v[100:103], v11 offset:4096
  ds_read_b128 v[104:107], v12 offset:4096
  ds_read_b128 v[108:111], v13 offset:4096
  s_waitcnt lgkmcnt(0)
  s_lshl_b32 s31, s29, 6
  s_add_u32 s31, s31, 36
  s_lshl_b32 s31, s31, 13
  s_add_u32 s31, s31, s68
  s_add_u32 s32, s6, s31
  s_addc_u32 s33, s7, 0
  s_add_u32 s34, s32, 16384
  s_addc_u32 s35, s33, 0
  s_add_u32 s36, s8, s31
  s_addc_u32 s37, s9, 0
  s_add_u32 s38, s36, 16384
  s_addc_u32 s39, s37, 0
  v_mfma_f32_16x16x32_bf16 v[112:115], v[80:83], v[32:35], 0
  v_mfma_f32_16x16x32_bf16 v[112:115], v[84:87], v[36:39], v[112:115]
  v_mfma_f32_16x16x32_bf16 v[112:115], v[88:91], v[40:43], v[112:115]
  v_mfma_f32_16x16x32_bf16 v[112:115], v[92:95], v[44:47], v[112:115]
  v_mfma_f32_16x16x32_bf16 v[116:119], v[96:99], v[32:35], 0
  v_mfma_f32_16x16x32_bf16 v[116:119], v[100:103], v[36:39], v[116:119]
  v_mfma_f32_16x16x32_bf16 v[116:119], v[104:107], v[40:43], v[116:119]
  v_mfma_f32_16x16x32_bf16 v[116:119], v[108:111], v[44:47], v[116:119]
  s_add_u32 m0, s47, 0
  s_nop 0
  global_load_lds_dwordx4 v4, s[32:33] offset:0 nt
  global_load_lds_dwordx4 v5, s[32:33] offset:1024 nt
  global_load_lds_dwordx4 v6, s[32:33] offset:2048 nt
  global_load_lds_dwordx4 v7, s[32:33] offset:3072 nt
  s_add_u32 m0, s47, 4096
  s_nop 0
  global_load_lds_dwordx4 v4, s[34:35] offset:0 nt
  global_load_lds_dwordx4 v5, s[34:35] offset:1024 nt
  global_load_lds_dwordx4 v6, s[34:35] offset:2048 nt
  global_load_lds_dwordx4 v7, s[34:35] offset:3072 nt
  s_waitcnt vmcnt(24)
  ds_read_b64_tr_b16 v[80:81], v14 offset:8192
  ds_read_b64_tr_b16 v[84:85], v15 offset:8192
  ds_read_b64_tr_b16 v[88:89], v16 offset:8192
  ds_read_b64_tr_b16 v[92:93], v17 offset:8192
  ds_read_b64_tr_b16 v[96:97], v18 offset:8192
  ds_read_b64_tr_b16 v[100:101], v19 offset:8192
  ds_read_b64_tr_b16 v[104:105], v20 offset:8192
  ds_read_b64_tr_b16 v[108:109], v21 offset:8192
  ds_read_b64_tr_b16 v[82:83], v14 offset:12288
  ds_read_b64_tr_b16 v[86:87], v15 offset:12288
  ds_read_b64_tr_b16 v[90:91], v16 offset:12288
  ds_read_b64_tr_b16 v[94:95], v17 offset:12288
  ds_read_b64_tr_b16 v[98:99], v18 offset:12288
  ds_read_b64_tr_b16 v[102:103], v19 offset:12288
  ds_read_b64_tr_b16 v[106:107], v20 offset:12288
  ds_read_b64_tr_b16 v[110:111], v21 offset:12288
  v_cvt_pk_bf16_f32 v120, v112, v113
  v_cvt_pk_bf16_f32 v121, v114, v115
  v_cvt_pk_bf16_f32 v122, v116, v117
  v_cvt_pk_bf16_f32 v123, v118, v119
  v_lshlrev_b32 v112, 16, v120
  v_and_b32 v113, 0xffff0000, v120
  v_lshlrev_b32 v114, 16, v121
  v_and_b32 v115, 0xffff0000, v121
  v_lshlrev_b32 v116, 16, v122
  v_and_b32 v117, 0xffff0000, v122
  v_lshlrev_b32 v118, 16, v123
  v_and_b32 v119, 0xffff0000, v123
  v_mul_f32 v112, s58, v112
  v_mul_f32 v113, s58, v113
  v_mul_f32 v114, s58, v114
  v_mul_f32 v115, s58, v115
  v_mul_f32 v116, s58, v116
  v_mul_f32 v117, s58, v117
  v_mul_f32 v118, s58, v118
  v_mul_f32 v119, s58, v119
  v_cvt_pk_bf16_f32 v120, v112, v113
  v_cvt_pk_bf16_f32 v121, v114, v115
  v_cvt_pk_bf16_f32 v122, v116, v117
  v_cvt_pk_bf16_f32 v123, v118, v119
  v_lshlrev_b32 v112, 16, v120
  v_and_b32 v113, 0xffff0000, v120
  v_lshlrev_b32 v114, 16, v121
  v_and_b32 v115, 0xffff0000, v121
  v_lshlrev_b32 v116, 16, v122
  v_and_b32 v117, 0xffff0000, v122
  v_lshlrev_b32 v118, 16, v123
  v_and_b32 v119, 0xffff0000, v123
  v_max3_f32 v124, v112, v113, v114
  v_max3_f32 v125, v115, v116, v117
  v_max3_f32 v124, v124, v118, v119
  v_max_f32 v124, v124, v125
  v_mov_b32 v125, v124
  s_nop 1
  v_permlane16_swap_b32 v124, v125
  v_max_f32 v124, v124, v125
  v_mov_b32 v125, v124
  s_nop 1
  v_permlane32_swap_b32 v124, v125
  v_max_f32 v124, v124, v125
  v_mul_f32 v124, s62, v124
  v_max_f32 v124, v124, v22
  v_sub_f32 v24, v22, v124
  v_exp_f32 v24, v24
  v_mov_b32 v22, v124
  v_fma_f32 v112, v112, s62, -v22
  v_fma_f32 v113, v113, s62, -v22
  v_fma_f32 v114, v114, s62, -v22
  v_fma_f32 v115, v115, s62, -v22
  v_fma_f32 v116, v116, s62, -v22
  v_fma_f32 v117, v117, s62, -v22
  v_fma_f32 v118, v118, s62, -v22
  v_fma_f32 v119, v119, s62, -v22
  v_exp_f32 v112, v112
  v_exp_f32 v113, v113
  v_exp_f32 v114, v114
  v_exp_f32 v115, v115
  v_exp_f32 v116, v116
  v_exp_f32 v117, v117
  v_exp_f32 v118, v118
  v_exp_f32 v119, v119
  v_mul_f32 v23, v23, v24
  v_cvt_pk_bf16_f32 v120, v112, v113
  v_cvt_pk_bf16_f32 v121, v114, v115
  v_cvt_pk_bf16_f32 v122, v116, v117
  v_cvt_pk_bf16_f32 v123, v118, v119
  v_add_f32 v124, v112, v113
  v_add_f32 v125, v114, v115
  v_add_f32 v124, v124, v116
  v_add_f32 v125, v125, v117
  v_add_f32 v124, v124, v118
  v_add_f32 v125, v125, v119
  v_add_f32 v124, v124, v125
  v_add_f32 v23, v23, v124
  v_mul_f32_dpp v48, v24, v48 quad_perm:[0,0,0,0] row_mask:0xf bank_mask:0xf
  v_mul_f32_dpp v49, v24, v49 quad_perm:[1,1,1,1] row_mask:0xf bank_mask:0xf
  v_mul_f32_dpp v50, v24, v50 quad_perm:[2,2,2,2] row_mask:0xf bank_mask:0xf
  v_mul_f32_dpp v51, v24, v51 quad_perm:[3,3,3,3] row_mask:0xf bank_mask:0xf
  v_mul_f32_dpp v52, v24, v52 quad_perm:[0,0,0,0] row_mask:0xf bank_mask:0xf
  v_mul_f32_dpp v53, v24, v53 quad_perm:[1,1,1,1] row_mask:0xf bank_mask:0xf
  v_mul_f32_dpp v54, v24, v54 quad_perm:[2,2,2,2] row_mask:0xf bank_mask:0xf
  v_mul_f32_dpp v55, v24, v55 quad_perm:[3,3,3,3] row_mask:0xf bank_mask:0xf
  v_mul_f32_dpp v56, v24, v56 quad_perm:[0,0,0,0] row_mask:0xf bank_mask:0xf
  v_mul_f32_dpp v57, v24, v57 quad_perm:[1,1,1,1] row_mask:0xf bank_mask:0xf
  v_mul_f32_dpp v58, v24, v58 quad_perm:[2,2,2,2] row_mask:0xf bank_mask:0xf
  v_mul_f32_dpp v59, v24, v59 quad_perm:[3,3,3,3] row_mask:0xf bank_mask:0xf
  v_mul_f32_dpp v60, v24, v60 quad_perm:[0,0,0,0] row_mask:0xf bank_mask:0xf
  v_mul_f32_dpp v61, v24, v61 quad_perm:[1,1,1,1] row_mask:0xf bank_mask:0xf
  v_mul_f32_dpp v62, v24, v62 quad_perm:[2,2,2,2] row_mask:0xf bank_mask:0xf
  v_mul_f32_dpp v63, v24, v63 quad_perm:[3,3,3,3] row_mask:0xf bank_mask:0xf
  v_mul_f32_dpp v64, v24, v64 quad_perm:[0,0,0,0] row_mask:0xf bank_mask:0xf
  v_mul_f32_dpp v65, v24, v65 quad_perm:[1,1,1,1] row_mask:0xf bank_mask:0xf
  v_mul_f32_dpp v66, v24, v66 quad_perm:[2,2,2,2] row_mask:0xf bank_mask:0xf
  v_mul_f32_dpp v67, v24, v67 quad_perm:[3,3,3,3] row_mask:0xf bank_mask:0xf
  v_mul_f32_dpp v68, v24, v68 quad_perm:[0,0,0,0] row_mask:0xf bank_mask:0xf
  v_mul_f32_dpp v69, v24, v69 quad_perm:[1,1,1,1] row_mask:0xf bank_mask:0xf
  v_mul_f32_dpp v70, v24, v70 quad_perm:[2,2,2,2] row_mask:0xf bank_mask:0xf
  v_mul_f32_dpp v71, v24, v71 quad_perm:[3,3,3,3] row_mask:0xf bank_mask:0xf
  v_mul_f32_dpp v72, v24, v72 quad_perm:[0,0,0,0] row_mask:0xf bank_mask:0xf
  v_mul_f32_dpp v73, v24, v73 quad_perm:[1,1,1,1] row_mask:0xf bank_mask:0xf
  v_mul_f32_dpp v74, v24, v74 quad_perm:[2,2,2,2] row_mask:0xf bank_mask:0xf
  v_mul_f32_dpp v75, v24, v75 quad_perm:[3,3,3,3] row_mask:0xf bank_mask:0xf
  v_mul_f32_dpp v76, v24, v76 quad_perm:[0,0,0,0] row_mask:0xf bank_mask:0xf
  v_mul_f32_dpp v77, v24, v77 quad_perm:[1,1,1,1] row_mask:0xf bank_mask:0xf
  v_mul_f32_dpp v78, v24, v78 quad_perm:[2,2,2,2] row_mask:0xf bank_mask:0xf
  v_mul_f32_dpp v79, v24, v79 quad_perm:[3,3,3,3] row_mask:0xf bank_mask:0xf
  s_waitcnt lgkmcnt(0)
  v_mfma_f32_16x16x32_bf16 v[48:51], v[120:123], v[80:83], v[48:51]
  v_mfma_f32_16x16x32_bf16 v[52:55], v[120:123], v[84:87], v[52:55]
  v_mfma_f32_16x16x32_bf16 v[56:59], v[120:123], v[88:91], v[56:59]
  v_mfma_f32_16x16x32_bf16 v[60:63], v[120:123], v[92:95], v[60:63]
  v_mfma_f32_16x16x32_bf16 v[64:67], v[120:123], v[96:99], v[64:67]
  v_mfma_f32_16x16x32_bf16 v[68:71], v[120:123], v[100:103], v[68:71]
  v_mfma_f32_16x16x32_bf16 v[72:75], v[120:123], v[104:107], v[72:75]
  v_mfma_f32_16x16x32_bf16 v[76:79], v[120:123], v[108:111], v[76:79]
  s_add_u32 m0, s47, 8192
  s_nop 0
  global_load_lds_dwordx4 v8, s[36:37] offset:0 nt
  global_load_lds_dwordx4 v9, s[36:37] offset:1024 nt
  global_load_lds_dwordx4 v8, s[36:37] offset:2048 nt
  global_load_lds_dwordx4 v9, s[36:37] offset:3072 nt
  s_add_u32 m0, s47, 12288
  s_nop 0
  global_load_lds_dwordx4 v8, s[38:39] offset:0 nt
  global_load_lds_dwordx4 v9, s[38:39] offset:1024 nt
  global_load_lds_dwordx4 v8, s[38:39] offset:2048 nt
  global_load_lds_dwordx4 v9, s[38:39] offset:3072 nt
  v_mfma_f32_16x16x32_bf16 v[112:115], v[192:195], v[32:35], 0
  v_mfma_f32_16x16x32_bf16 v[112:115], v[196:199], v[36:39], v[112:115]
  v_mfma_f32_16x16x32_bf16 v[112:115], v[200:203], v[40:43], v[112:115]
  v_mfma_f32_16x16x32_bf16 v[112:115], v[204:207], v[44:47], v[112:115]
  v_mfma_f32_16x16x32_bf16 v[116:119], v[208:211], v[32:35], 0
  v_mfma_f32_16x16x32_bf16 v[116:119], v[212:215], v[36:39], v[116:119]
  v_mfma_f32_16x16x32_bf16 v[116:119], v[216:219], v[40:43], v[116:119]
  v_mfma_f32_16x16x32_bf16 v[116:119], v[220:223], v[44:47], v[116:119]
  s_nop 3
  v_cvt_pk_bf16_f32 v120, v112, v113
  v_cvt_pk_bf16_f32 v121, v114, v115
  s_nop 1
  v_cvt_pk_bf16_f32 v122, v116, v117
  v_cvt_pk_bf16_f32 v123, v118, v119
  v_lshlrev_b32 v112, 16, v120
  v_and_b32 v113, 0xffff0000, v120
  v_lshlrev_b32 v114, 16, v121
  v_and_b32 v115, 0xffff0000, v121
  v_lshlrev_b32 v116, 16, v122
  v_and_b32 v117, 0xffff0000, v122
  v_lshlrev_b32 v118, 16, v123
  v_and_b32 v119, 0xffff0000, v123
  v_mul_f32 v112, s58, v112
  v_mul_f32 v113, s58, v113
  v_mul_f32 v114, s58, v114
  v_mul_f32 v115, s58, v115
  v_mul_f32 v116, s58, v116
  v_mul_f32 v117, s58, v117
  v_mul_f32 v118, s58, v118
  v_mul_f32 v119, s58, v119
  v_cvt_pk_bf16_f32 v120, v112, v113
  v_cvt_pk_bf16_f32 v121, v114, v115
  v_cvt_pk_bf16_f32 v122, v116, v117
  v_cvt_pk_bf16_f32 v123, v118, v119
  v_lshlrev_b32 v112, 16, v120
  v_and_b32 v113, 0xffff0000, v120
  v_lshlrev_b32 v114, 16, v121
  v_and_b32 v115, 0xffff0000, v121
  v_lshlrev_b32 v116, 16, v122
  v_and_b32 v117, 0xffff0000, v122
  v_lshlrev_b32 v118, 16, v123
  v_and_b32 v119, 0xffff0000, v123
  v_max3_f32 v124, v112, v113, v114
  v_max3_f32 v125, v115, v116, v117
  v_max3_f32 v124, v124, v118, v119
  v_max_f32 v124, v124, v125
  v_mov_b32 v125, v124
  s_nop 1
  v_permlane16_swap_b32 v124, v125
  v_max_f32 v124, v124, v125
  v_mov_b32 v125, v124
  s_nop 1
  v_permlane32_swap_b32 v124, v125
  v_max_f32 v124, v124, v125
  v_mul_f32 v124, s62, v124
  v_max_f32 v124, v124, v22
  v_sub_f32 v24, v22, v124
  v_exp_f32 v24, v24
  v_mov_b32 v22, v124
  v_fma_f32 v112, v112, s62, -v22
  v_fma_f32 v113, v113, s62, -v22
  v_fma_f32 v114, v114, s62, -v22
  v_fma_f32 v115, v115, s62, -v22
  v_fma_f32 v116, v116, s62, -v22
  v_fma_f32 v117, v117, s62, -v22
  v_fma_f32 v118, v118, s62, -v22
  v_fma_f32 v119, v119, s62, -v22
  v_exp_f32 v112, v112
  v_exp_f32 v113, v113
  v_exp_f32 v114, v114
  v_exp_f32 v115, v115
  v_exp_f32 v116, v116
  v_exp_f32 v117, v117
  v_exp_f32 v118, v118
  v_exp_f32 v119, v119
  v_mul_f32 v23, v23, v24
  v_cvt_pk_bf16_f32 v120, v112, v113
  v_cvt_pk_bf16_f32 v121, v114, v115
  v_cvt_pk_bf16_f32 v122, v116, v117
  v_cvt_pk_bf16_f32 v123, v118, v119
  v_add_f32 v124, v112, v113
  v_add_f32 v125, v114, v115
  v_add_f32 v124, v124, v116
  v_add_f32 v125, v125, v117
  v_add_f32 v124, v124, v118
  v_add_f32 v125, v125, v119
  v_add_f32 v124, v124, v125
  v_add_f32 v23, v23, v124
  v_mul_f32_dpp v48, v24, v48 quad_perm:[0,0,0,0] row_mask:0xf bank_mask:0xf
  v_mul_f32_dpp v49, v24, v49 quad_perm:[1,1,1,1] row_mask:0xf bank_mask:0xf
  v_mul_f32_dpp v50, v24, v50 quad_perm:[2,2,2,2] row_mask:0xf bank_mask:0xf
  v_mul_f32_dpp v51, v24, v51 quad_perm:[3,3,3,3] row_mask:0xf bank_mask:0xf
  v_mul_f32_dpp v52, v24, v52 quad_perm:[0,0,0,0] row_mask:0xf bank_mask:0xf
  v_mul_f32_dpp v53, v24, v53 quad_perm:[1,1,1,1] row_mask:0xf bank_mask:0xf
  v_mul_f32_dpp v54, v24, v54 quad_perm:[2,2,2,2] row_mask:0xf bank_mask:0xf
  v_mul_f32_dpp v55, v24, v55 quad_perm:[3,3,3,3] row_mask:0xf bank_mask:0xf
  v_mul_f32_dpp v56, v24, v56 quad_perm:[0,0,0,0] row_mask:0xf bank_mask:0xf
  v_mul_f32_dpp v57, v24, v57 quad_perm:[1,1,1,1] row_mask:0xf bank_mask:0xf
  v_mul_f32_dpp v58, v24, v58 quad_perm:[2,2,2,2] row_mask:0xf bank_mask:0xf
  v_mul_f32_dpp v59, v24, v59 quad_perm:[3,3,3,3] row_mask:0xf bank_mask:0xf
  v_mul_f32_dpp v60, v24, v60 quad_perm:[0,0,0,0] row_mask:0xf bank_mask:0xf
  v_mul_f32_dpp v61, v24, v61 quad_perm:[1,1,1,1] row_mask:0xf bank_mask:0xf
  v_mul_f32_dpp v62, v24, v62 quad_perm:[2,2,2,2] row_mask:0xf bank_mask:0xf
  v_mul_f32_dpp v63, v24, v63 quad_perm:[3,3,3,3] row_mask:0xf bank_mask:0xf
  v_mul_f32_dpp v64, v24, v64 quad_perm:[0,0,0,0] row_mask:0xf bank_mask:0xf
  v_mul_f32_dpp v65, v24, v65 quad_perm:[1,1,1,1] row_mask:0xf bank_mask:0xf
  v_mul_f32_dpp v66, v24, v66 quad_perm:[2,2,2,2] row_mask:0xf bank_mask:0xf
  v_mul_f32_dpp v67, v24, v67 quad_perm:[3,3,3,3] row_mask:0xf bank_mask:0xf
  v_mul_f32_dpp v68, v24, v68 quad_perm:[0,0,0,0] row_mask:0xf bank_mask:0xf
  v_mul_f32_dpp v69, v24, v69 quad_perm:[1,1,1,1] row_mask:0xf bank_mask:0xf
  v_mul_f32_dpp v70, v24, v70 quad_perm:[2,2,2,2] row_mask:0xf bank_mask:0xf
  v_mul_f32_dpp v71, v24, v71 quad_perm:[3,3,3,3] row_mask:0xf bank_mask:0xf
  v_mul_f32_dpp v72, v24, v72 quad_perm:[0,0,0,0] row_mask:0xf bank_mask:0xf
  v_mul_f32_dpp v73, v24, v73 quad_perm:[1,1,1,1] row_mask:0xf bank_mask:0xf
  v_mul_f32_dpp v74, v24, v74 quad_perm:[2,2,2,2] row_mask:0xf bank_mask:0xf
  v_mul_f32_dpp v75, v24, v75 quad_perm:[3,3,3,3] row_mask:0xf bank_mask:0xf
  v_mul_f32_dpp v76, v24, v76 quad_perm:[0,0,0,0] row_mask:0xf bank_mask:0xf
  v_mul_f32_dpp v77, v24, v77 quad_perm:[1,1,1,1] row_mask:0xf bank_mask:0xf
  v_mul_f32_dpp v78, v24, v78 quad_perm:[2,2,2,2] row_mask:0xf bank_mask:0xf
  v_mul_f32_dpp v79, v24, v79 quad_perm:[3,3,3,3] row_mask:0xf bank_mask:0xf
  v_mfma_f32_16x16x32_bf16 v[48:51], v[120:123], v[224:227], v[48:51]
  v_mfma_f32_16x16x32_bf16 v[52:55], v[120:123], v[228:231], v[52:55]
  v_mfma_f32_16x16x32_bf16 v[56:59], v[120:123], v[232:235], v[56:59]
  v_mfma_f32_16x16x32_bf16 v[60:63], v[120:123], v[236:239], v[60:63]
  v_mfma_f32_16x16x32_bf16 v[64:67], v[120:123], v[240:243], v[64:67]
  v_mfma_f32_16x16x32_bf16 v[68:71], v[120:123], v[244:247], v[68:71]
  v_mfma_f32_16x16x32_bf16 v[72:75], v[120:123], v[248:251], v[72:75]
  v_mfma_f32_16x16x32_bf16 v[76:79], v[120:123], v[252:255], v[76:79]
  s_waitcnt vmcnt(24)
  ds_read_b128 v[80:83], v10 offset:16384
  ds_read_b128 v[84:87], v11 offset:16384
  ds_read_b128 v[88:91], v12 offset:16384
  ds_read_b128 v[92:95], v13 offset:16384
  ds_read_b128 v[96:99], v10 offset:20480
  ds_read_b128 v[100:103], v11 offset:20480
  ds_read_b128 v[104:107], v12 offset:20480
  ds_read_b128 v[108:111], v13 offset:20480
  s_waitcnt lgkmcnt(0)
  s_lshl_b32 s31, s29, 6
  s_add_u32 s31, s31, 40
  s_lshl_b32 s31, s31, 13
  s_add_u32 s31, s31, s68
  s_add_u32 s32, s6, s31
  s_addc_u32 s33, s7, 0
  s_add_u32 s34, s32, 16384
  s_addc_u32 s35, s33, 0
  s_add_u32 s36, s8, s31
  s_addc_u32 s37, s9, 0
  s_add_u32 s38, s36, 16384
  s_addc_u32 s39, s37, 0
  v_mfma_f32_16x16x32_bf16 v[112:115], v[80:83], v[32:35], 0
  v_mfma_f32_16x16x32_bf16 v[112:115], v[84:87], v[36:39], v[112:115]
  v_mfma_f32_16x16x32_bf16 v[112:115], v[88:91], v[40:43], v[112:115]
  v_mfma_f32_16x16x32_bf16 v[112:115], v[92:95], v[44:47], v[112:115]
  v_mfma_f32_16x16x32_bf16 v[116:119], v[96:99], v[32:35], 0
  v_mfma_f32_16x16x32_bf16 v[116:119], v[100:103], v[36:39], v[116:119]
  v_mfma_f32_16x16x32_bf16 v[116:119], v[104:107], v[40:43], v[116:119]
  v_mfma_f32_16x16x32_bf16 v[116:119], v[108:111], v[44:47], v[116:119]
  s_add_u32 m0, s47, 16384
  s_nop 0
  global_load_lds_dwordx4 v4, s[32:33] offset:0 nt
  global_load_lds_dwordx4 v5, s[32:33] offset:1024 nt
  global_load_lds_dwordx4 v6, s[32:33] offset:2048 nt
  global_load_lds_dwordx4 v7, s[32:33] offset:3072 nt
  s_add_u32 m0, s47, 20480
  s_nop 0
  global_load_lds_dwordx4 v4, s[34:35] offset:0 nt
  global_load_lds_dwordx4 v5, s[34:35] offset:1024 nt
  global_load_lds_dwordx4 v6, s[34:35] offset:2048 nt
  global_load_lds_dwordx4 v7, s[34:35] offset:3072 nt
  s_waitcnt vmcnt(24)
  ds_read_b64_tr_b16 v[80:81], v14 offset:24576
  ds_read_b64_tr_b16 v[84:85], v15 offset:24576
  ds_read_b64_tr_b16 v[88:89], v16 offset:24576
  ds_read_b64_tr_b16 v[92:93], v17 offset:24576
  ds_read_b64_tr_b16 v[96:97], v18 offset:24576
  ds_read_b64_tr_b16 v[100:101], v19 offset:24576
  ds_read_b64_tr_b16 v[104:105], v20 offset:24576
  ds_read_b64_tr_b16 v[108:109], v21 offset:24576
  ds_read_b64_tr_b16 v[82:83], v14 offset:28672
  ds_read_b64_tr_b16 v[86:87], v15 offset:28672
  ds_read_b64_tr_b16 v[90:91], v16 offset:28672
  ds_read_b64_tr_b16 v[94:95], v17 offset:28672
  ds_read_b64_tr_b16 v[98:99], v18 offset:28672
  ds_read_b64_tr_b16 v[102:103], v19 offset:28672
  ds_read_b64_tr_b16 v[106:107], v20 offset:28672
  ds_read_b64_tr_b16 v[110:111], v21 offset:28672
  v_cvt_pk_bf16_f32 v120, v112, v113
  v_cvt_pk_bf16_f32 v121, v114, v115
  v_cvt_pk_bf16_f32 v122, v116, v117
  v_cvt_pk_bf16_f32 v123, v118, v119
  v_lshlrev_b32 v112, 16, v120
  v_and_b32 v113, 0xffff0000, v120
  v_lshlrev_b32 v114, 16, v121
  v_and_b32 v115, 0xffff0000, v121
  v_lshlrev_b32 v116, 16, v122
  v_and_b32 v117, 0xffff0000, v122
  v_lshlrev_b32 v118, 16, v123
  v_and_b32 v119, 0xffff0000, v123
  v_mul_f32 v112, s58, v112
  v_mul_f32 v113, s58, v113
  v_mul_f32 v114, s58, v114
  v_mul_f32 v115, s58, v115
  v_mul_f32 v116, s58, v116
  v_mul_f32 v117, s58, v117
  v_mul_f32 v118, s58, v118
  v_mul_f32 v119, s58, v119
  v_cvt_pk_bf16_f32 v120, v112, v113
  v_cvt_pk_bf16_f32 v121, v114, v115
  v_cvt_pk_bf16_f32 v122, v116, v117
  v_cvt_pk_bf16_f32 v123, v118, v119
  v_lshlrev_b32 v112, 16, v120
  v_and_b32 v113, 0xffff0000, v120
  v_lshlrev_b32 v114, 16, v121
  v_and_b32 v115, 0xffff0000, v121
  v_lshlrev_b32 v116, 16, v122
  v_and_b32 v117, 0xffff0000, v122
  v_lshlrev_b32 v118, 16, v123
  v_and_b32 v119, 0xffff0000, v123
  v_max3_f32 v124, v112, v113, v114
  v_max3_f32 v125, v115, v116, v117
  v_max3_f32 v124, v124, v118, v119
  v_max_f32 v124, v124, v125
  v_mov_b32 v125, v124
  s_nop 1
  v_permlane16_swap_b32 v124, v125
  v_max_f32 v124, v124, v125
  v_mov_b32 v125, v124
  s_nop 1
  v_permlane32_swap_b32 v124, v125
  v_max_f32 v124, v124, v125
  v_mul_f32 v124, s62, v124
  v_max_f32 v124, v124, v22
  v_sub_f32 v24, v22, v124
  v_exp_f32 v24, v24
  v_mov_b32 v22, v124
  v_fma_f32 v112, v112, s62, -v22
  v_fma_f32 v113, v113, s62, -v22
  v_fma_f32 v114, v114, s62, -v22
  v_fma_f32 v115, v115, s62, -v22
  v_fma_f32 v116, v116, s62, -v22
  v_fma_f32 v117, v117, s62, -v22
  v_fma_f32 v118, v118, s62, -v22
  v_fma_f32 v119, v119, s62, -v22
  v_exp_f32 v112, v112
  v_exp_f32 v113, v113
  v_exp_f32 v114, v114
  v_exp_f32 v115, v115
  v_exp_f32 v116, v116
  v_exp_f32 v117, v117
  v_exp_f32 v118, v118
  v_exp_f32 v119, v119
  v_mul_f32 v23, v23, v24
  v_cvt_pk_bf16_f32 v120, v112, v113
  v_cvt_pk_bf16_f32 v121, v114, v115
  v_cvt_pk_bf16_f32 v122, v116, v117
  v_cvt_pk_bf16_f32 v123, v118, v119
  v_add_f32 v124, v112, v113
  v_add_f32 v125, v114, v115
  v_add_f32 v124, v124, v116
  v_add_f32 v125, v125, v117
  v_add_f32 v124, v124, v118
  v_add_f32 v125, v125, v119
  v_add_f32 v124, v124, v125
  v_add_f32 v23, v23, v124
  v_mul_f32_dpp v48, v24, v48 quad_perm:[0,0,0,0] row_mask:0xf bank_mask:0xf
  v_mul_f32_dpp v49, v24, v49 quad_perm:[1,1,1,1] row_mask:0xf bank_mask:0xf
  v_mul_f32_dpp v50, v24, v50 quad_perm:[2,2,2,2] row_mask:0xf bank_mask:0xf
  v_mul_f32_dpp v51, v24, v51 quad_perm:[3,3,3,3] row_mask:0xf bank_mask:0xf
  v_mul_f32_dpp v52, v24, v52 quad_perm:[0,0,0,0] row_mask:0xf bank_mask:0xf
  v_mul_f32_dpp v53, v24, v53 quad_perm:[1,1,1,1] row_mask:0xf bank_mask:0xf
  v_mul_f32_dpp v54, v24, v54 quad_perm:[2,2,2,2] row_mask:0xf bank_mask:0xf
  v_mul_f32_dpp v55, v24, v55 quad_perm:[3,3,3,3] row_mask:0xf bank_mask:0xf
  v_mul_f32_dpp v56, v24, v56 quad_perm:[0,0,0,0] row_mask:0xf bank_mask:0xf
  v_mul_f32_dpp v57, v24, v57 quad_perm:[1,1,1,1] row_mask:0xf bank_mask:0xf
  v_mul_f32_dpp v58, v24, v58 quad_perm:[2,2,2,2] row_mask:0xf bank_mask:0xf
  v_mul_f32_dpp v59, v24, v59 quad_perm:[3,3,3,3] row_mask:0xf bank_mask:0xf
  v_mul_f32_dpp v60, v24, v60 quad_perm:[0,0,0,0] row_mask:0xf bank_mask:0xf
  v_mul_f32_dpp v61, v24, v61 quad_perm:[1,1,1,1] row_mask:0xf bank_mask:0xf
  v_mul_f32_dpp v62, v24, v62 quad_perm:[2,2,2,2] row_mask:0xf bank_mask:0xf
  v_mul_f32_dpp v63, v24, v63 quad_perm:[3,3,3,3] row_mask:0xf bank_mask:0xf
  v_mul_f32_dpp v64, v24, v64 quad_perm:[0,0,0,0] row_mask:0xf bank_mask:0xf
  v_mul_f32_dpp v65, v24, v65 quad_perm:[1,1,1,1] row_mask:0xf bank_mask:0xf
  v_mul_f32_dpp v66, v24, v66 quad_perm:[2,2,2,2] row_mask:0xf bank_mask:0xf
  v_mul_f32_dpp v67, v24, v67 quad_perm:[3,3,3,3] row_mask:0xf bank_mask:0xf
  v_mul_f32_dpp v68, v24, v68 quad_perm:[0,0,0,0] row_mask:0xf bank_mask:0xf
  v_mul_f32_dpp v69, v24, v69 quad_perm:[1,1,1,1] row_mask:0xf bank_mask:0xf
  v_mul_f32_dpp v70, v24, v70 quad_perm:[2,2,2,2] row_mask:0xf bank_mask:0xf
  v_mul_f32_dpp v71, v24, v71 quad_perm:[3,3,3,3] row_mask:0xf bank_mask:0xf
  v_mul_f32_dpp v72, v24, v72 quad_perm:[0,0,0,0] row_mask:0xf bank_mask:0xf
  v_mul_f32_dpp v73, v24, v73 quad_perm:[1,1,1,1] row_mask:0xf bank_mask:0xf
  v_mul_f32_dpp v74, v24, v74 quad_perm:[2,2,2,2] row_mask:0xf bank_mask:0xf
  v_mul_f32_dpp v75, v24, v75 quad_perm:[3,3,3,3] row_mask:0xf bank_mask:0xf
  v_mul_f32_dpp v76, v24, v76 quad_perm:[0,0,0,0] row_mask:0xf bank_mask:0xf
  v_mul_f32_dpp v77, v24, v77 quad_perm:[1,1,1,1] row_mask:0xf bank_mask:0xf
  v_mul_f32_dpp v78, v24, v78 quad_perm:[2,2,2,2] row_mask:0xf bank_mask:0xf
  v_mul_f32_dpp v79, v24, v79 quad_perm:[3,3,3,3] row_mask:0xf bank_mask:0xf
  s_waitcnt lgkmcnt(0)
  v_mfma_f32_16x16x32_bf16 v[48:51], v[120:123], v[80:83], v[48:51]
  v_mfma_f32_16x16x32_bf16 v[52:55], v[120:123], v[84:87], v[52:55]
  v_mfma_f32_16x16x32_bf16 v[56:59], v[120:123], v[88:91], v[56:59]
  v_mfma_f32_16x16x32_bf16 v[60:63], v[120:123], v[92:95], v[60:63]
  v_mfma_f32_16x16x32_bf16 v[64:67], v[120:123], v[96:99], v[64:67]
  v_mfma_f32_16x16x32_bf16 v[68:71], v[120:123], v[100:103], v[68:71]
  v_mfma_f32_16x16x32_bf16 v[72:75], v[120:123], v[104:107], v[72:75]
  v_mfma_f32_16x16x32_bf16 v[76:79], v[120:123], v[108:111], v[76:79]
  s_add_u32 m0, s47, 24576
  s_nop 0
  global_load_lds_dwordx4 v8, s[36:37] offset:0 nt
  global_load_lds_dwordx4 v9, s[36:37] offset:1024 nt
  global_load_lds_dwordx4 v8, s[36:37] offset:2048 nt
  global_load_lds_dwordx4 v9, s[36:37] offset:3072 nt
  s_add_u32 m0, s47, 28672
  s_nop 0
  global_load_lds_dwordx4 v8, s[38:39] offset:0 nt
  global_load_lds_dwordx4 v9, s[38:39] offset:1024 nt
  global_load_lds_dwordx4 v8, s[38:39] offset:2048 nt
  global_load_lds_dwordx4 v9, s[38:39] offset:3072 nt
  v_mfma_f32_16x16x32_bf16 v[112:115], a[0:3], v[32:35], 0
  v_mfma_f32_16x16x32_bf16 v[112:115], a[4:7], v[36:39], v[112:115]
  v_mfma_f32_16x16x32_bf16 v[112:115], a[8:11], v[40:43], v[112:115]
  v_mfma_f32_16x16x32_bf16 v[112:115], a[12:15], v[44:47], v[112:115]
  v_mfma_f32_16x16x32_bf16 v[116:119], a[16:19], v[32:35], 0
  v_mfma_f32_16x16x32_bf16 v[116:119], a[20:23], v[36:39], v[116:119]
  v_mfma_f32_16x16x32_bf16 v[116:119], a[24:27], v[40:43], v[116:119]
  v_mfma_f32_16x16x32_bf16 v[116:119], a[28:31], v[44:47], v[116:119]
  s_nop 3
  v_cvt_pk_bf16_f32 v120, v112, v113
  v_cvt_pk_bf16_f32 v121, v114, v115
  s_nop 1
  v_cvt_pk_bf16_f32 v122, v116, v117
  v_cvt_pk_bf16_f32 v123, v118, v119
  v_lshlrev_b32 v112, 16, v120
  v_and_b32 v113, 0xffff0000, v120
  v_lshlrev_b32 v114, 16, v121
  v_and_b32 v115, 0xffff0000, v121
  v_lshlrev_b32 v116, 16, v122
  v_and_b32 v117, 0xffff0000, v122
  v_lshlrev_b32 v118, 16, v123
  v_and_b32 v119, 0xffff0000, v123
  v_mul_f32 v112, s58, v112
  v_mul_f32 v113, s58, v113
  v_mul_f32 v114, s58, v114
  v_mul_f32 v115, s58, v115
  v_mul_f32 v116, s58, v116
  v_mul_f32 v117, s58, v117
  v_mul_f32 v118, s58, v118
  v_mul_f32 v119, s58, v119
  v_cvt_pk_bf16_f32 v120, v112, v113
  v_cvt_pk_bf16_f32 v121, v114, v115
  v_cvt_pk_bf16_f32 v122, v116, v117
  v_cvt_pk_bf16_f32 v123, v118, v119
  v_lshlrev_b32 v112, 16, v120
  v_and_b32 v113, 0xffff0000, v120
  v_lshlrev_b32 v114, 16, v121
  v_and_b32 v115, 0xffff0000, v121
  v_lshlrev_b32 v116, 16, v122
  v_and_b32 v117, 0xffff0000, v122
  v_lshlrev_b32 v118, 16, v123
  v_and_b32 v119, 0xffff0000, v123
  v_max3_f32 v124, v112, v113, v114
  v_max3_f32 v125, v115, v116, v117
  v_max3_f32 v124, v124, v118, v119
  v_max_f32 v124, v124, v125
  v_mov_b32 v125, v124
  s_nop 1
  v_permlane16_swap_b32 v124, v125
  v_max_f32 v124, v124, v125
  v_mov_b32 v125, v124
  s_nop 1
  v_permlane32_swap_b32 v124, v125
  v_max_f32 v124, v124, v125
  v_mul_f32 v124, s62, v124
  v_max_f32 v124, v124, v22
  v_sub_f32 v24, v22, v124
  v_exp_f32 v24, v24
  v_mov_b32 v22, v124
  v_fma_f32 v112, v112, s62, -v22
  v_fma_f32 v113, v113, s62, -v22
  v_fma_f32 v114, v114, s62, -v22
  v_fma_f32 v115, v115, s62, -v22
  v_fma_f32 v116, v116, s62, -v22
  v_fma_f32 v117, v117, s62, -v22
  v_fma_f32 v118, v118, s62, -v22
  v_fma_f32 v119, v119, s62, -v22
  v_exp_f32 v112, v112
  v_exp_f32 v113, v113
  v_exp_f32 v114, v114
  v_exp_f32 v115, v115
  v_exp_f32 v116, v116
  v_exp_f32 v117, v117
  v_exp_f32 v118, v118
  v_exp_f32 v119, v119
  v_mul_f32 v23, v23, v24
  v_cvt_pk_bf16_f32 v120, v112, v113
  v_cvt_pk_bf16_f32 v121, v114, v115
  v_cvt_pk_bf16_f32 v122, v116, v117
  v_cvt_pk_bf16_f32 v123, v118, v119
  v_add_f32 v124, v112, v113
  v_add_f32 v125, v114, v115
  v_add_f32 v124, v124, v116
  v_add_f32 v125, v125, v117
  v_add_f32 v124, v124, v118
  v_add_f32 v125, v125, v119
  v_add_f32 v124, v124, v125
  v_add_f32 v23, v23, v124
  v_mul_f32_dpp v48, v24, v48 quad_perm:[0,0,0,0] row_mask:0xf bank_mask:0xf
  v_mul_f32_dpp v49, v24, v49 quad_perm:[1,1,1,1] row_mask:0xf bank_mask:0xf
  v_mul_f32_dpp v50, v24, v50 quad_perm:[2,2,2,2] row_mask:0xf bank_mask:0xf
  v_mul_f32_dpp v51, v24, v51 quad_perm:[3,3,3,3] row_mask:0xf bank_mask:0xf
  v_mul_f32_dpp v52, v24, v52 quad_perm:[0,0,0,0] row_mask:0xf bank_mask:0xf
  v_mul_f32_dpp v53, v24, v53 quad_perm:[1,1,1,1] row_mask:0xf bank_mask:0xf
  v_mul_f32_dpp v54, v24, v54 quad_perm:[2,2,2,2] row_mask:0xf bank_mask:0xf
  v_mul_f32_dpp v55, v24, v55 quad_perm:[3,3,3,3] row_mask:0xf bank_mask:0xf
  v_mul_f32_dpp v56, v24, v56 quad_perm:[0,0,0,0] row_mask:0xf bank_mask:0xf
  v_mul_f32_dpp v57, v24, v57 quad_perm:[1,1,1,1] row_mask:0xf bank_mask:0xf
  v_mul_f32_dpp v58, v24, v58 quad_perm:[2,2,2,2] row_mask:0xf bank_mask:0xf
  v_mul_f32_dpp v59, v24, v59 quad_perm:[3,3,3,3] row_mask:0xf bank_mask:0xf
  v_mul_f32_dpp v60, v24, v60 quad_perm:[0,0,0,0] row_mask:0xf bank_mask:0xf
  v_mul_f32_dpp v61, v24, v61 quad_perm:[1,1,1,1] row_mask:0xf bank_mask:0xf
  v_mul_f32_dpp v62, v24, v62 quad_perm:[2,2,2,2] row_mask:0xf bank_mask:0xf
  v_mul_f32_dpp v63, v24, v63 quad_perm:[3,3,3,3] row_mask:0xf bank_mask:0xf
  v_mul_f32_dpp v64, v24, v64 quad_perm:[0,0,0,0] row_mask:0xf bank_mask:0xf
  v_mul_f32_dpp v65, v24, v65 quad_perm:[1,1,1,1] row_mask:0xf bank_mask:0xf
  v_mul_f32_dpp v66, v24, v66 quad_perm:[2,2,2,2] row_mask:0xf bank_mask:0xf
  v_mul_f32_dpp v67, v24, v67 quad_perm:[3,3,3,3] row_mask:0xf bank_mask:0xf
  v_mul_f32_dpp v68, v24, v68 quad_perm:[0,0,0,0] row_mask:0xf bank_mask:0xf
  v_mul_f32_dpp v69, v24, v69 quad_perm:[1,1,1,1] row_mask:0xf bank_mask:0xf
  v_mul_f32_dpp v70, v24, v70 quad_perm:[2,2,2,2] row_mask:0xf bank_mask:0xf
  v_mul_f32_dpp v71, v24, v71 quad_perm:[3,3,3,3] row_mask:0xf bank_mask:0xf
  v_mul_f32_dpp v72, v24, v72 quad_perm:[0,0,0,0] row_mask:0xf bank_mask:0xf
  v_mul_f32_dpp v73, v24, v73 quad_perm:[1,1,1,1] row_mask:0xf bank_mask:0xf
  v_mul_f32_dpp v74, v24, v74 quad_perm:[2,2,2,2] row_mask:0xf bank_mask:0xf
  v_mul_f32_dpp v75, v24, v75 quad_perm:[3,3,3,3] row_mask:0xf bank_mask:0xf
  v_mul_f32_dpp v76, v24, v76 quad_perm:[0,0,0,0] row_mask:0xf bank_mask:0xf
  v_mul_f32_dpp v77, v24, v77 quad_perm:[1,1,1,1] row_mask:0xf bank_mask:0xf
  v_mul_f32_dpp v78, v24, v78 quad_perm:[2,2,2,2] row_mask:0xf bank_mask:0xf
  v_mul_f32_dpp v79, v24, v79 quad_perm:[3,3,3,3] row_mask:0xf bank_mask:0xf
  v_mfma_f32_16x16x32_bf16 v[48:51], v[120:123], a[32:35], v[48:51]
  v_mfma_f32_16x16x32_bf16 v[52:55], v[120:123], a[36:39], v[52:55]
  v_mfma_f32_16x16x32_bf16 v[56:59], v[120:123], a[40:43], v[56:59]
  v_mfma_f32_16x16x32_bf16 v[60:63], v[120:123], a[44:47], v[60:63]
  v_mfma_f32_16x16x32_bf16 v[64:67], v[120:123], a[48:51], v[64:67]
  v_mfma_f32_16x16x32_bf16 v[68:71], v[120:123], a[52:55], v[68:71]
  v_mfma_f32_16x16x32_bf16 v[72:75], v[120:123], a[56:59], v[72:75]
  v_mfma_f32_16x16x32_bf16 v[76:79], v[120:123], a[60:63], v[76:79]
  s_waitcnt vmcnt(24)
  ds_read_b128 v[80:83], v10 offset:0
  ds_read_b128 v[84:87], v11 offset:0
  ds_read_b128 v[88:91], v12 offset:0
  ds_read_b128 v[92:95], v13 offset:0
  ds_read_b128 v[96:99], v10 offset:4096
  ds_read_b128 v[100:103], v11 offset:4096
  ds_read_b128 v[104:107], v12 offset:4096
  ds_read_b128 v[108:111], v13 offset:4096
  s_waitcnt lgkmcnt(0)
  s_lshl_b32 s31, s29, 6
  s_add_u32 s31, s31, 44
  s_lshl_b32 s31, s31, 13
  s_add_u32 s31, s31, s68
  s_add_u32 s32, s6, s31
  s_addc_u32 s33, s7, 0
  s_add_u32 s34, s32, 16384
  s_addc_u32 s35, s33, 0
  s_add_u32 s36, s8, s31
  s_addc_u32 s37, s9, 0
  s_add_u32 s38, s36, 16384
  s_addc_u32 s39, s37, 0
  v_mfma_f32_16x16x32_bf16 v[112:115], v[80:83], v[32:35], 0
  v_mfma_f32_16x16x32_bf16 v[112:115], v[84:87], v[36:39], v[112:115]
  v_mfma_f32_16x16x32_bf16 v[112:115], v[88:91], v[40:43], v[112:115]
  v_mfma_f32_16x16x32_bf16 v[112:115], v[92:95], v[44:47], v[112:115]
  v_mfma_f32_16x16x32_bf16 v[116:119], v[96:99], v[32:35], 0
  v_mfma_f32_16x16x32_bf16 v[116:119], v[100:103], v[36:39], v[116:119]
  v_mfma_f32_16x16x32_bf16 v[116:119], v[104:107], v[40:43], v[116:119]
  v_mfma_f32_16x16x32_bf16 v[116:119], v[108:111], v[44:47], v[116:119]
  s_add_u32 m0, s47, 0
  s_nop 0
  global_load_lds_dwordx4 v4, s[32:33] offset:0 nt
  global_load_lds_dwordx4 v5, s[32:33] offset:1024 nt
  global_load_lds_dwordx4 v6, s[32:33] offset:2048 nt
  global_load_lds_dwordx4 v7, s[32:33] offset:3072 nt
  s_add_u32 m0, s47, 4096
  s_nop 0
  global_load_lds_dwordx4 v4, s[34:35] offset:0 nt
  global_load_lds_dwordx4 v5, s[34:35] offset:1024 nt
  global_load_lds_dwordx4 v6, s[34:35] offset:2048 nt
  global_load_lds_dwordx4 v7, s[34:35] offset:3072 nt
  s_waitcnt vmcnt(24)
  ds_read_b64_tr_b16 v[80:81], v14 offset:8192
  ds_read_b64_tr_b16 v[84:85], v15 offset:8192
  ds_read_b64_tr_b16 v[88:89], v16 offset:8192
  ds_read_b64_tr_b16 v[92:93], v17 offset:8192
  ds_read_b64_tr_b16 v[96:97], v18 offset:8192
  ds_read_b64_tr_b16 v[100:101], v19 offset:8192
  ds_read_b64_tr_b16 v[104:105], v20 offset:8192
  ds_read_b64_tr_b16 v[108:109], v21 offset:8192
  ds_read_b64_tr_b16 v[82:83], v14 offset:12288
  ds_read_b64_tr_b16 v[86:87], v15 offset:12288
  ds_read_b64_tr_b16 v[90:91], v16 offset:12288
  ds_read_b64_tr_b16 v[94:95], v17 offset:12288
  ds_read_b64_tr_b16 v[98:99], v18 offset:12288
  ds_read_b64_tr_b16 v[102:103], v19 offset:12288
  ds_read_b64_tr_b16 v[106:107], v20 offset:12288
  ds_read_b64_tr_b16 v[110:111], v21 offset:12288
  v_cvt_pk_bf16_f32 v120, v112, v113
  v_cvt_pk_bf16_f32 v121, v114, v115
  v_cvt_pk_bf16_f32 v122, v116, v117
  v_cvt_pk_bf16_f32 v123, v118, v119
  v_lshlrev_b32 v112, 16, v120
  v_and_b32 v113, 0xffff0000, v120
  v_lshlrev_b32 v114, 16, v121
  v_and_b32 v115, 0xffff0000, v121
  v_lshlrev_b32 v116, 16, v122
  v_and_b32 v117, 0xffff0000, v122
  v_lshlrev_b32 v118, 16, v123
  v_and_b32 v119, 0xffff0000, v123
  v_mul_f32 v112, s58, v112
  v_mul_f32 v113, s58, v113
  v_mul_f32 v114, s58, v114
  v_mul_f32 v115, s58, v115
  v_mul_f32 v116, s58, v116
  v_mul_f32 v117, s58, v117
  v_mul_f32 v118, s58, v118
  v_mul_f32 v119, s58, v119
  v_cvt_pk_bf16_f32 v120, v112, v113
  v_cvt_pk_bf16_f32 v121, v114, v115
  v_cvt_pk_bf16_f32 v122, v116, v117
  v_cvt_pk_bf16_f32 v123, v118, v119
  v_lshlrev_b32 v112, 16, v120
  v_and_b32 v113, 0xffff0000, v120
  v_lshlrev_b32 v114, 16, v121
  v_and_b32 v115, 0xffff0000, v121
  v_lshlrev_b32 v116, 16, v122
  v_and_b32 v117, 0xffff0000, v122
  v_lshlrev_b32 v118, 16, v123
  v_and_b32 v119, 0xffff0000, v123
  v_max3_f32 v124, v112, v113, v114
  v_max3_f32 v125, v115, v116, v117
  v_max3_f32 v124, v124, v118, v119
  v_max_f32 v124, v124, v125
  v_mov_b32 v125, v124
  s_nop 1
  v_permlane16_swap_b32 v124, v125
  v_max_f32 v124, v124, v125
  v_mov_b32 v125, v124
  s_nop 1
  v_permlane32_swap_b32 v124, v125
  v_max_f32 v124, v124, v125
  v_mul_f32 v124, s62, v124
  v_max_f32 v124, v124, v22
  v_sub_f32 v24, v22, v124
  v_exp_f32 v24, v24
  v_mov_b32 v22, v124
  v_fma_f32 v112, v112, s62, -v22
  v_fma_f32 v113, v113, s62, -v22
  v_fma_f32 v114, v114, s62, -v22
  v_fma_f32 v115, v115, s62, -v22
  v_fma_f32 v116, v116, s62, -v22
  v_fma_f32 v117, v117, s62, -v22
  v_fma_f32 v118, v118, s62, -v22
  v_fma_f32 v119, v119, s62, -v22
  v_exp_f32 v112, v112
  v_exp_f32 v113, v113
  v_exp_f32 v114, v114
  v_exp_f32 v115, v115
  v_exp_f32 v116, v116
  v_exp_f32 v117, v117
  v_exp_f32 v118, v118
  v_exp_f32 v119, v119
  v_mul_f32 v23, v23, v24
  v_cvt_pk_bf16_f32 v120, v112, v113
  v_cvt_pk_bf16_f32 v121, v114, v115
  v_cvt_pk_bf16_f32 v122, v116, v117
  v_cvt_pk_bf16_f32 v123, v118, v119
  v_add_f32 v124, v112, v113
  v_add_f32 v125, v114, v115
  v_add_f32 v124, v124, v116
  v_add_f32 v125, v125, v117
  v_add_f32 v124, v124, v118
  v_add_f32 v125, v125, v119
  v_add_f32 v124, v124, v125
  v_add_f32 v23, v23, v124
  v_mul_f32_dpp v48, v24, v48 quad_perm:[0,0,0,0] row_mask:0xf bank_mask:0xf
  v_mul_f32_dpp v49, v24, v49 quad_perm:[1,1,1,1] row_mask:0xf bank_mask:0xf
  v_mul_f32_dpp v50, v24, v50 quad_perm:[2,2,2,2] row_mask:0xf bank_mask:0xf
  v_mul_f32_dpp v51, v24, v51 quad_perm:[3,3,3,3] row_mask:0xf bank_mask:0xf
  v_mul_f32_dpp v52, v24, v52 quad_perm:[0,0,0,0] row_mask:0xf bank_mask:0xf
  v_mul_f32_dpp v53, v24, v53 quad_perm:[1,1,1,1] row_mask:0xf bank_mask:0xf
  v_mul_f32_dpp v54, v24, v54 quad_perm:[2,2,2,2] row_mask:0xf bank_mask:0xf
  v_mul_f32_dpp v55, v24, v55 quad_perm:[3,3,3,3] row_mask:0xf bank_mask:0xf
  v_mul_f32_dpp v56, v24, v56 quad_perm:[0,0,0,0] row_mask:0xf bank_mask:0xf
  v_mul_f32_dpp v57, v24, v57 quad_perm:[1,1,1,1] row_mask:0xf bank_mask:0xf
  v_mul_f32_dpp v58, v24, v58 quad_perm:[2,2,2,2] row_mask:0xf bank_mask:0xf
  v_mul_f32_dpp v59, v24, v59 quad_perm:[3,3,3,3] row_mask:0xf bank_mask:0xf
  v_mul_f32_dpp v60, v24, v60 quad_perm:[0,0,0,0] row_mask:0xf bank_mask:0xf
  v_mul_f32_dpp v61, v24, v61 quad_perm:[1,1,1,1] row_mask:0xf bank_mask:0xf
  v_mul_f32_dpp v62, v24, v62 quad_perm:[2,2,2,2] row_mask:0xf bank_mask:0xf
  v_mul_f32_dpp v63, v24, v63 quad_perm:[3,3,3,3] row_mask:0xf bank_mask:0xf
  v_mul_f32_dpp v64, v24, v64 quad_perm:[0,0,0,0] row_mask:0xf bank_mask:0xf
  v_mul_f32_dpp v65, v24, v65 quad_perm:[1,1,1,1] row_mask:0xf bank_mask:0xf
  v_mul_f32_dpp v66, v24, v66 quad_perm:[2,2,2,2] row_mask:0xf bank_mask:0xf
  v_mul_f32_dpp v67, v24, v67 quad_perm:[3,3,3,3] row_mask:0xf bank_mask:0xf
  v_mul_f32_dpp v68, v24, v68 quad_perm:[0,0,0,0] row_mask:0xf bank_mask:0xf
  v_mul_f32_dpp v69, v24, v69 quad_perm:[1,1,1,1] row_mask:0xf bank_mask:0xf
  v_mul_f32_dpp v70, v24, v70 quad_perm:[2,2,2,2] row_mask:0xf bank_mask:0xf
  v_mul_f32_dpp v71, v24, v71 quad_perm:[3,3,3,3] row_mask:0xf bank_mask:0xf
  v_mul_f32_dpp v72, v24, v72 quad_perm:[0,0,0,0] row_mask:0xf bank_mask:0xf
  v_mul_f32_dpp v73, v24, v73 quad_perm:[1,1,1,1] row_mask:0xf bank_mask:0xf
  v_mul_f32_dpp v74, v24, v74 quad_perm:[2,2,2,2] row_mask:0xf bank_mask:0xf
  v_mul_f32_dpp v75, v24, v75 quad_perm:[3,3,3,3] row_mask:0xf bank_mask:0xf
  v_mul_f32_dpp v76, v24, v76 quad_perm:[0,0,0,0] row_mask:0xf bank_mask:0xf
  v_mul_f32_dpp v77, v24, v77 quad_perm:[1,1,1,1] row_mask:0xf bank_mask:0xf
  v_mul_f32_dpp v78, v24, v78 quad_perm:[2,2,2,2] row_mask:0xf bank_mask:0xf
  v_mul_f32_dpp v79, v24, v79 quad_perm:[3,3,3,3] row_mask:0xf bank_mask:0xf
  s_waitcnt lgkmcnt(0)
  v_mfma_f32_16x16x32_bf16 v[48:51], v[120:123], v[80:83], v[48:51]
  v_mfma_f32_16x16x32_bf16 v[52:55], v[120:123], v[84:87], v[52:55]
  v_mfma_f32_16x16x32_bf16 v[56:59], v[120:123], v[88:91], v[56:59]
  v_mfma_f32_16x16x32_bf16 v[60:63], v[120:123], v[92:95], v[60:63]
  v_mfma_f32_16x16x32_bf16 v[64:67], v[120:123], v[96:99], v[64:67]
  v_mfma_f32_16x16x32_bf16 v[68:71], v[120:123], v[100:103], v[68:71]
  v_mfma_f32_16x16x32_bf16 v[72:75], v[120:123], v[104:107], v[72:75]
  v_mfma_f32_16x16x32_bf16 v[76:79], v[120:123], v[108:111], v[76:79]
  s_add_u32 m0, s47, 8192
  s_nop 0
  global_load_lds_dwordx4 v8, s[36:37] offset:0 nt
  global_load_lds_dwordx4 v9, s[36:37] offset:1024 nt
  global_load_lds_dwordx4 v8, s[36:37] offset:2048 nt
  global_load_lds_dwordx4 v9, s[36:37] offset:3072 nt
  s_add_u32 m0, s47, 12288
  s_nop 0
  global_load_lds_dwordx4 v8, s[38:39] offset:0 nt
  global_load_lds_dwordx4 v9, s[38:39] offset:1024 nt
  global_load_lds_dwordx4 v8, s[38:39] offset:2048 nt
  global_load_lds_dwordx4 v9, s[38:39] offset:3072 nt
  v_mfma_f32_16x16x32_bf16 v[112:115], a[64:67], v[32:35], 0
  v_mfma_f32_16x16x32_bf16 v[112:115], a[68:71], v[36:39], v[112:115]
  v_mfma_f32_16x16x32_bf16 v[112:115], a[72:75], v[40:43], v[112:115]
  v_mfma_f32_16x16x32_bf16 v[112:115], a[76:79], v[44:47], v[112:115]
  v_mfma_f32_16x16x32_bf16 v[116:119], a[80:83], v[32:35], 0
  v_mfma_f32_16x16x32_bf16 v[116:119], a[84:87], v[36:39], v[116:119]
  v_mfma_f32_16x16x32_bf16 v[116:119], a[88:91], v[40:43], v[116:119]
  v_mfma_f32_16x16x32_bf16 v[116:119], a[92:95], v[44:47], v[116:119]
  s_nop 3
  v_cvt_pk_bf16_f32 v120, v112, v113
  v_cvt_pk_bf16_f32 v121, v114, v115
  s_nop 1
  v_cvt_pk_bf16_f32 v122, v116, v117
  v_cvt_pk_bf16_f32 v123, v118, v119
  v_lshlrev_b32 v112, 16, v120
  v_and_b32 v113, 0xffff0000, v120
  v_lshlrev_b32 v114, 16, v121
  v_and_b32 v115, 0xffff0000, v121
  v_lshlrev_b32 v116, 16, v122
  v_and_b32 v117, 0xffff0000, v122
  v_lshlrev_b32 v118, 16, v123
  v_and_b32 v119, 0xffff0000, v123
  v_mul_f32 v112, s58, v112
  v_mul_f32 v113, s58, v113
  v_mul_f32 v114, s58, v114
  v_mul_f32 v115, s58, v115
  v_mul_f32 v116, s58, v116
  v_mul_f32 v117, s58, v117
  v_mul_f32 v118, s58, v118
  v_mul_f32 v119, s58, v119
  v_cvt_pk_bf16_f32 v120, v112, v113
  v_cvt_pk_bf16_f32 v121, v114, v115
  v_cvt_pk_bf16_f32 v122, v116, v117
  v_cvt_pk_bf16_f32 v123, v118, v119
  v_lshlrev_b32 v112, 16, v120
  v_and_b32 v113, 0xffff0000, v120
  v_lshlrev_b32 v114, 16, v121
  v_and_b32 v115, 0xffff0000, v121
  v_lshlrev_b32 v116, 16, v122
  v_and_b32 v117, 0xffff0000, v122
  v_lshlrev_b32 v118, 16, v123
  v_and_b32 v119, 0xffff0000, v123
  v_max3_f32 v124, v112, v113, v114
  v_max3_f32 v125, v115, v116, v117
  v_max3_f32 v124, v124, v118, v119
  v_max_f32 v124, v124, v125
  v_mov_b32 v125, v124
  s_nop 1
  v_permlane16_swap_b32 v124, v125
  v_max_f32 v124, v124, v125
  v_mov_b32 v125, v124
  s_nop 1
  v_permlane32_swap_b32 v124, v125
  v_max_f32 v124, v124, v125
  v_mul_f32 v124, s62, v124
  v_max_f32 v124, v124, v22
  v_sub_f32 v24, v22, v124
  v_exp_f32 v24, v24
  v_mov_b32 v22, v124
  v_fma_f32 v112, v112, s62, -v22
  v_fma_f32 v113, v113, s62, -v22
  v_fma_f32 v114, v114, s62, -v22
  v_fma_f32 v115, v115, s62, -v22
  v_fma_f32 v116, v116, s62, -v22
  v_fma_f32 v117, v117, s62, -v22
  v_fma_f32 v118, v118, s62, -v22
  v_fma_f32 v119, v119, s62, -v22
  v_exp_f32 v112, v112
  v_exp_f32 v113, v113
  v_exp_f32 v114, v114
  v_exp_f32 v115, v115
  v_exp_f32 v116, v116
  v_exp_f32 v117, v117
  v_exp_f32 v118, v118
  v_exp_f32 v119, v119
  v_mul_f32 v23, v23, v24
  v_cvt_pk_bf16_f32 v120, v112, v113
  v_cvt_pk_bf16_f32 v121, v114, v115
  v_cvt_pk_bf16_f32 v122, v116, v117
  v_cvt_pk_bf16_f32 v123, v118, v119
  v_add_f32 v124, v112, v113
  v_add_f32 v125, v114, v115
  v_add_f32 v124, v124, v116
  v_add_f32 v125, v125, v117
  v_add_f32 v124, v124, v118
  v_add_f32 v125, v125, v119
  v_add_f32 v124, v124, v125
  v_add_f32 v23, v23, v124
  v_mul_f32_dpp v48, v24, v48 quad_perm:[0,0,0,0] row_mask:0xf bank_mask:0xf
  v_mul_f32_dpp v49, v24, v49 quad_perm:[1,1,1,1] row_mask:0xf bank_mask:0xf
  v_mul_f32_dpp v50, v24, v50 quad_perm:[2,2,2,2] row_mask:0xf bank_mask:0xf
  v_mul_f32_dpp v51, v24, v51 quad_perm:[3,3,3,3] row_mask:0xf bank_mask:0xf
  v_mul_f32_dpp v52, v24, v52 quad_perm:[0,0,0,0] row_mask:0xf bank_mask:0xf
  v_mul_f32_dpp v53, v24, v53 quad_perm:[1,1,1,1] row_mask:0xf bank_mask:0xf
  v_mul_f32_dpp v54, v24, v54 quad_perm:[2,2,2,2] row_mask:0xf bank_mask:0xf
  v_mul_f32_dpp v55, v24, v55 quad_perm:[3,3,3,3] row_mask:0xf bank_mask:0xf
  v_mul_f32_dpp v56, v24, v56 quad_perm:[0,0,0,0] row_mask:0xf bank_mask:0xf
  v_mul_f32_dpp v57, v24, v57 quad_perm:[1,1,1,1] row_mask:0xf bank_mask:0xf
  v_mul_f32_dpp v58, v24, v58 quad_perm:[2,2,2,2] row_mask:0xf bank_mask:0xf
  v_mul_f32_dpp v59, v24, v59 quad_perm:[3,3,3,3] row_mask:0xf bank_mask:0xf
  v_mul_f32_dpp v60, v24, v60 quad_perm:[0,0,0,0] row_mask:0xf bank_mask:0xf
  v_mul_f32_dpp v61, v24, v61 quad_perm:[1,1,1,1] row_mask:0xf bank_mask:0xf
  v_mul_f32_dpp v62, v24, v62 quad_perm:[2,2,2,2] row_mask:0xf bank_mask:0xf
  v_mul_f32_dpp v63, v24, v63 quad_perm:[3,3,3,3] row_mask:0xf bank_mask:0xf
  v_mul_f32_dpp v64, v24, v64 quad_perm:[0,0,0,0] row_mask:0xf bank_mask:0xf
  v_mul_f32_dpp v65, v24, v65 quad_perm:[1,1,1,1] row_mask:0xf bank_mask:0xf
  v_mul_f32_dpp v66, v24, v66 quad_perm:[2,2,2,2] row_mask:0xf bank_mask:0xf
  v_mul_f32_dpp v67, v24, v67 quad_perm:[3,3,3,3] row_mask:0xf bank_mask:0xf
  v_mul_f32_dpp v68, v24, v68 quad_perm:[0,0,0,0] row_mask:0xf bank_mask:0xf
  v_mul_f32_dpp v69, v24, v69 quad_perm:[1,1,1,1] row_mask:0xf bank_mask:0xf
  v_mul_f32_dpp v70, v24, v70 quad_perm:[2,2,2,2] row_mask:0xf bank_mask:0xf
  v_mul_f32_dpp v71, v24, v71 quad_perm:[3,3,3,3] row_mask:0xf bank_mask:0xf
  v_mul_f32_dpp v72, v24, v72 quad_perm:[0,0,0,0] row_mask:0xf bank_mask:0xf
  v_mul_f32_dpp v73, v24, v73 quad_perm:[1,1,1,1] row_mask:0xf bank_mask:0xf
  v_mul_f32_dpp v74, v24, v74 quad_perm:[2,2,2,2] row_mask:0xf bank_mask:0xf
  v_mul_f32_dpp v75, v24, v75 quad_perm:[3,3,3,3] row_mask:0xf bank_mask:0xf
  v_mul_f32_dpp v76, v24, v76 quad_perm:[0,0,0,0] row_mask:0xf bank_mask:0xf
  v_mul_f32_dpp v77, v24, v77 quad_perm:[1,1,1,1] row_mask:0xf bank_mask:0xf
  v_mul_f32_dpp v78, v24, v78 quad_perm:[2,2,2,2] row_mask:0xf bank_mask:0xf
  v_mul_f32_dpp v79, v24, v79 quad_perm:[3,3,3,3] row_mask:0xf bank_mask:0xf
  v_mfma_f32_16x16x32_bf16 v[48:51], v[120:123], a[96:99], v[48:51]
  v_mfma_f32_16x16x32_bf16 v[52:55], v[120:123], a[100:103], v[52:55]
  v_mfma_f32_16x16x32_bf16 v[56:59], v[120:123], a[104:107], v[56:59]
  v_mfma_f32_16x16x32_bf16 v[60:63], v[120:123], a[108:111], v[60:63]
  v_mfma_f32_16x16x32_bf16 v[64:67], v[120:123], a[112:115], v[64:67]
  v_mfma_f32_16x16x32_bf16 v[68:71], v[120:123], a[116:119], v[68:71]
  v_mfma_f32_16x16x32_bf16 v[72:75], v[120:123], a[120:123], v[72:75]
  v_mfma_f32_16x16x32_bf16 v[76:79], v[120:123], a[124:127], v[76:79]
  s_waitcnt vmcnt(24)
  ds_read_b128 v[80:83], v10 offset:16384
  ds_read_b128 v[84:87], v11 offset:16384
  ds_read_b128 v[88:91], v12 offset:16384
  ds_read_b128 v[92:95], v13 offset:16384
  ds_read_b128 v[96:99], v10 offset:20480
  ds_read_b128 v[100:103], v11 offset:20480
  ds_read_b128 v[104:107], v12 offset:20480
  ds_read_b128 v[108:111], v13 offset:20480
  s_waitcnt lgkmcnt(0)
  s_lshl_b32 s31, s29, 6
  s_add_u32 s31, s31, 48
  s_lshl_b32 s31, s31, 13
  s_add_u32 s31, s31, s68
  s_add_u32 s32, s6, s31
  s_addc_u32 s33, s7, 0
  s_add_u32 s34, s32, 16384
  s_addc_u32 s35, s33, 0
  s_add_u32 s36, s8, s31
  s_addc_u32 s37, s9, 0
  s_add_u32 s38, s36, 16384
  s_addc_u32 s39, s37, 0
  v_mfma_f32_16x16x32_bf16 v[112:115], v[80:83], v[32:35], 0
  v_mfma_f32_16x16x32_bf16 v[112:115], v[84:87], v[36:39], v[112:115]
  v_mfma_f32_16x16x32_bf16 v[112:115], v[88:91], v[40:43], v[112:115]
  v_mfma_f32_16x16x32_bf16 v[112:115], v[92:95], v[44:47], v[112:115]
  v_mfma_f32_16x16x32_bf16 v[116:119], v[96:99], v[32:35], 0
  v_mfma_f32_16x16x32_bf16 v[116:119], v[100:103], v[36:39], v[116:119]
  v_mfma_f32_16x16x32_bf16 v[116:119], v[104:107], v[40:43], v[116:119]
  v_mfma_f32_16x16x32_bf16 v[116:119], v[108:111], v[44:47], v[116:119]
  s_add_u32 m0, s47, 16384
  s_nop 0
  global_load_lds_dwordx4 v4, s[32:33] offset:0 nt
  global_load_lds_dwordx4 v5, s[32:33] offset:1024 nt
  global_load_lds_dwordx4 v6, s[32:33] offset:2048 nt
  global_load_lds_dwordx4 v7, s[32:33] offset:3072 nt
  s_add_u32 m0, s47, 20480
  s_nop 0
  global_load_lds_dwordx4 v4, s[34:35] offset:0 nt
  global_load_lds_dwordx4 v5, s[34:35] offset:1024 nt
  global_load_lds_dwordx4 v6, s[34:35] offset:2048 nt
  global_load_lds_dwordx4 v7, s[34:35] offset:3072 nt
  s_waitcnt vmcnt(24)
  ds_read_b64_tr_b16 v[80:81], v14 offset:24576
  ds_read_b64_tr_b16 v[84:85], v15 offset:24576
  ds_read_b64_tr_b16 v[88:89], v16 offset:24576
  ds_read_b64_tr_b16 v[92:93], v17 offset:24576
  ds_read_b64_tr_b16 v[96:97], v18 offset:24576
  ds_read_b64_tr_b16 v[100:101], v19 offset:24576
  ds_read_b64_tr_b16 v[104:105], v20 offset:24576
  ds_read_b64_tr_b16 v[108:109], v21 offset:24576
  ds_read_b64_tr_b16 v[82:83], v14 offset:28672
  ds_read_b64_tr_b16 v[86:87], v15 offset:28672
  ds_read_b64_tr_b16 v[90:91], v16 offset:28672
  ds_read_b64_tr_b16 v[94:95], v17 offset:28672
  ds_read_b64_tr_b16 v[98:99], v18 offset:28672
  ds_read_b64_tr_b16 v[102:103], v19 offset:28672
  ds_read_b64_tr_b16 v[106:107], v20 offset:28672
  ds_read_b64_tr_b16 v[110:111], v21 offset:28672
  v_cvt_pk_bf16_f32 v120, v112, v113
  v_cvt_pk_bf16_f32 v121, v114, v115
  v_cvt_pk_bf16_f32 v122, v116, v117
  v_cvt_pk_bf16_f32 v123, v118, v119
  v_lshlrev_b32 v112, 16, v120
  v_and_b32 v113, 0xffff0000, v120
  v_lshlrev_b32 v114, 16, v121
  v_and_b32 v115, 0xffff0000, v121
  v_lshlrev_b32 v116, 16, v122
  v_and_b32 v117, 0xffff0000, v122
  v_lshlrev_b32 v118, 16, v123
  v_and_b32 v119, 0xffff0000, v123
  v_mul_f32 v112, s58, v112
  v_mul_f32 v113, s58, v113
  v_mul_f32 v114, s58, v114
  v_mul_f32 v115, s58, v115
  v_mul_f32 v116, s58, v116
  v_mul_f32 v117, s58, v117
  v_mul_f32 v118, s58, v118
  v_mul_f32 v119, s58, v119
  v_cvt_pk_bf16_f32 v120, v112, v113
  v_cvt_pk_bf16_f32 v121, v114, v115
  v_cvt_pk_bf16_f32 v122, v116, v117
  v_cvt_pk_bf16_f32 v123, v118, v119
  v_lshlrev_b32 v112, 16, v120
  v_and_b32 v113, 0xffff0000, v120
  v_lshlrev_b32 v114, 16, v121
  v_and_b32 v115, 0xffff0000, v121
  v_lshlrev_b32 v116, 16, v122
  v_and_b32 v117, 0xffff0000, v122
  v_lshlrev_b32 v118, 16, v123
  v_and_b32 v119, 0xffff0000, v123
  v_max3_f32 v124, v112, v113, v114
  v_max3_f32 v125, v115, v116, v117
  v_max3_f32 v124, v124, v118, v119
  v_max_f32 v124, v124, v125
  v_mov_b32 v125, v124
  s_nop 1
  v_permlane16_swap_b32 v124, v125
  v_max_f32 v124, v124, v125
  v_mov_b32 v125, v124
  s_nop 1
  v_permlane32_swap_b32 v124, v125
  v_max_f32 v124, v124, v125
  v_mul_f32 v124, s62, v124
  v_max_f32 v124, v124, v22
  v_sub_f32 v24, v22, v124
  v_exp_f32 v24, v24
  v_mov_b32 v22, v124
  v_fma_f32 v112, v112, s62, -v22
  v_fma_f32 v113, v113, s62, -v22
  v_fma_f32 v114, v114, s62, -v22
  v_fma_f32 v115, v115, s62, -v22
  v_fma_f32 v116, v116, s62, -v22
  v_fma_f32 v117, v117, s62, -v22
  v_fma_f32 v118, v118, s62, -v22
  v_fma_f32 v119, v119, s62, -v22
  v_exp_f32 v112, v112
  v_exp_f32 v113, v113
  v_exp_f32 v114, v114
  v_exp_f32 v115, v115
  v_exp_f32 v116, v116
  v_exp_f32 v117, v117
  v_exp_f32 v118, v118
  v_exp_f32 v119, v119
  v_mul_f32 v23, v23, v24
  v_cvt_pk_bf16_f32 v120, v112, v113
  v_cvt_pk_bf16_f32 v121, v114, v115
  v_cvt_pk_bf16_f32 v122, v116, v117
  v_cvt_pk_bf16_f32 v123, v118, v119
  v_add_f32 v124, v112, v113
  v_add_f32 v125, v114, v115
  v_add_f32 v124, v124, v116
  v_add_f32 v125, v125, v117
  v_add_f32 v124, v124, v118
  v_add_f32 v125, v125, v119
  v_add_f32 v124, v124, v125
  v_add_f32 v23, v23, v124
  v_mul_f32_dpp v48, v24, v48 quad_perm:[0,0,0,0] row_mask:0xf bank_mask:0xf
  v_mul_f32_dpp v49, v24, v49 quad_perm:[1,1,1,1] row_mask:0xf bank_mask:0xf
  v_mul_f32_dpp v50, v24, v50 quad_perm:[2,2,2,2] row_mask:0xf bank_mask:0xf
  v_mul_f32_dpp v51, v24, v51 quad_perm:[3,3,3,3] row_mask:0xf bank_mask:0xf
  v_mul_f32_dpp v52, v24, v52 quad_perm:[0,0,0,0] row_mask:0xf bank_mask:0xf
  v_mul_f32_dpp v53, v24, v53 quad_perm:[1,1,1,1] row_mask:0xf bank_mask:0xf
  v_mul_f32_dpp v54, v24, v54 quad_perm:[2,2,2,2] row_mask:0xf bank_mask:0xf
  v_mul_f32_dpp v55, v24, v55 quad_perm:[3,3,3,3] row_mask:0xf bank_mask:0xf
  v_mul_f32_dpp v56, v24, v56 quad_perm:[0,0,0,0] row_mask:0xf bank_mask:0xf
  v_mul_f32_dpp v57, v24, v57 quad_perm:[1,1,1,1] row_mask:0xf bank_mask:0xf
  v_mul_f32_dpp v58, v24, v58 quad_perm:[2,2,2,2] row_mask:0xf bank_mask:0xf
  v_mul_f32_dpp v59, v24, v59 quad_perm:[3,3,3,3] row_mask:0xf bank_mask:0xf
  v_mul_f32_dpp v60, v24, v60 quad_perm:[0,0,0,0] row_mask:0xf bank_mask:0xf
  v_mul_f32_dpp v61, v24, v61 quad_perm:[1,1,1,1] row_mask:0xf bank_mask:0xf
  v_mul_f32_dpp v62, v24, v62 quad_perm:[2,2,2,2] row_mask:0xf bank_mask:0xf
  v_mul_f32_dpp v63, v24, v63 quad_perm:[3,3,3,3] row_mask:0xf bank_mask:0xf
  v_mul_f32_dpp v64, v24, v64 quad_perm:[0,0,0,0] row_mask:0xf bank_mask:0xf
  v_mul_f32_dpp v65, v24, v65 quad_perm:[1,1,1,1] row_mask:0xf bank_mask:0xf
  v_mul_f32_dpp v66, v24, v66 quad_perm:[2,2,2,2] row_mask:0xf bank_mask:0xf
  v_mul_f32_dpp v67, v24, v67 quad_perm:[3,3,3,3] row_mask:0xf bank_mask:0xf
  v_mul_f32_dpp v68, v24, v68 quad_perm:[0,0,0,0] row_mask:0xf bank_mask:0xf
  v_mul_f32_dpp v69, v24, v69 quad_perm:[1,1,1,1] row_mask:0xf bank_mask:0xf
  v_mul_f32_dpp v70, v24, v70 quad_perm:[2,2,2,2] row_mask:0xf bank_mask:0xf
  v_mul_f32_dpp v71, v24, v71 quad_perm:[3,3,3,3] row_mask:0xf bank_mask:0xf
  v_mul_f32_dpp v72, v24, v72 quad_perm:[0,0,0,0] row_mask:0xf bank_mask:0xf
  v_mul_f32_dpp v73, v24, v73 quad_perm:[1,1,1,1] row_mask:0xf bank_mask:0xf
  v_mul_f32_dpp v74, v24, v74 quad_perm:[2,2,2,2] row_mask:0xf bank_mask:0xf
  v_mul_f32_dpp v75, v24, v75 quad_perm:[3,3,3,3] row_mask:0xf bank_mask:0xf
  v_mul_f32_dpp v76, v24, v76 quad_perm:[0,0,0,0] row_mask:0xf bank_mask:0xf
  v_mul_f32_dpp v77, v24, v77 quad_perm:[1,1,1,1] row_mask:0xf bank_mask:0xf
  v_mul_f32_dpp v78, v24, v78 quad_perm:[2,2,2,2] row_mask:0xf bank_mask:0xf
  v_mul_f32_dpp v79, v24, v79 quad_perm:[3,3,3,3] row_mask:0xf bank_mask:0xf
  s_waitcnt lgkmcnt(0)
  v_mfma_f32_16x16x32_bf16 v[48:51], v[120:123], v[80:83], v[48:51]
  v_mfma_f32_16x16x32_bf16 v[52:55], v[120:123], v[84:87], v[52:55]
  v_mfma_f32_16x16x32_bf16 v[56:59], v[120:123], v[88:91], v[56:59]
  v_mfma_f32_16x16x32_bf16 v[60:63], v[120:123], v[92:95], v[60:63]
  v_mfma_f32_16x16x32_bf16 v[64:67], v[120:123], v[96:99], v[64:67]
  v_mfma_f32_16x16x32_bf16 v[68:71], v[120:123], v[100:103], v[68:71]
  v_mfma_f32_16x16x32_bf16 v[72:75], v[120:123], v[104:107], v[72:75]
  v_mfma_f32_16x16x32_bf16 v[76:79], v[120:123], v[108:111], v[76:79]
  s_add_u32 m0, s47, 24576
  s_nop 0
  global_load_lds_dwordx4 v8, s[36:37] offset:0 nt
  global_load_lds_dwordx4 v9, s[36:37] offset:1024 nt
  global_load_lds_dwordx4 v8, s[36:37] offset:2048 nt
  global_load_lds_dwordx4 v9, s[36:37] offset:3072 nt
  s_add_u32 m0, s47, 28672
  s_nop 0
  global_load_lds_dwordx4 v8, s[38:39] offset:0 nt
  global_load_lds_dwordx4 v9, s[38:39] offset:1024 nt
  global_load_lds_dwordx4 v8, s[38:39] offset:2048 nt
  global_load_lds_dwordx4 v9, s[38:39] offset:3072 nt
  v_mfma_f32_16x16x32_bf16 v[112:115], a[128:131], v[32:35], 0
  v_mfma_f32_16x16x32_bf16 v[112:115], a[132:135], v[36:39], v[112:115]
  v_mfma_f32_16x16x32_bf16 v[112:115], a[136:139], v[40:43], v[112:115]
  v_mfma_f32_16x16x32_bf16 v[112:115], a[140:143], v[44:47], v[112:115]
  v_mfma_f32_16x16x32_bf16 v[116:119], a[144:147], v[32:35], 0
  v_mfma_f32_16x16x32_bf16 v[116:119], a[148:151], v[36:39], v[116:119]
  v_mfma_f32_16x16x32_bf16 v[116:119], a[152:155], v[40:43], v[116:119]
  v_mfma_f32_16x16x32_bf16 v[116:119], a[156:159], v[44:47], v[116:119]
  s_nop 3
  v_cvt_pk_bf16_f32 v120, v112, v113
  v_cvt_pk_bf16_f32 v121, v114, v115
  s_nop 1
  v_cvt_pk_bf16_f32 v122, v116, v117
  v_cvt_pk_bf16_f32 v123, v118, v119
  v_lshlrev_b32 v112, 16, v120
  v_and_b32 v113, 0xffff0000, v120
  v_lshlrev_b32 v114, 16, v121
  v_and_b32 v115, 0xffff0000, v121
  v_lshlrev_b32 v116, 16, v122
  v_and_b32 v117, 0xffff0000, v122
  v_lshlrev_b32 v118, 16, v123
  v_and_b32 v119, 0xffff0000, v123
  v_mul_f32 v112, s58, v112
  v_mul_f32 v113, s58, v113
  v_mul_f32 v114, s58, v114
  v_mul_f32 v115, s58, v115
  v_mul_f32 v116, s58, v116
  v_mul_f32 v117, s58, v117
  v_mul_f32 v118, s58, v118
  v_mul_f32 v119, s58, v119
  v_cvt_pk_bf16_f32 v120, v112, v113
  v_cvt_pk_bf16_f32 v121, v114, v115
  v_cvt_pk_bf16_f32 v122, v116, v117
  v_cvt_pk_bf16_f32 v123, v118, v119
  v_lshlrev_b32 v112, 16, v120
  v_and_b32 v113, 0xffff0000, v120
  v_lshlrev_b32 v114, 16, v121
  v_and_b32 v115, 0xffff0000, v121
  v_lshlrev_b32 v116, 16, v122
  v_and_b32 v117, 0xffff0000, v122
  v_lshlrev_b32 v118, 16, v123
  v_and_b32 v119, 0xffff0000, v123
  v_max3_f32 v124, v112, v113, v114
  v_max3_f32 v125, v115, v116, v117
  v_max3_f32 v124, v124, v118, v119
  v_max_f32 v124, v124, v125
  v_mov_b32 v125, v124
  s_nop 1
  v_permlane16_swap_b32 v124, v125
  v_max_f32 v124, v124, v125
  v_mov_b32 v125, v124
  s_nop 1
  v_permlane32_swap_b32 v124, v125
  v_max_f32 v124, v124, v125
  v_mul_f32 v124, s62, v124
  v_max_f32 v124, v124, v22
  v_sub_f32 v24, v22, v124
  v_exp_f32 v24, v24
  v_mov_b32 v22, v124
  v_fma_f32 v112, v112, s62, -v22
  v_fma_f32 v113, v113, s62, -v22
  v_fma_f32 v114, v114, s62, -v22
  v_fma_f32 v115, v115, s62, -v22
  v_fma_f32 v116, v116, s62, -v22
  v_fma_f32 v117, v117, s62, -v22
  v_fma_f32 v118, v118, s62, -v22
  v_fma_f32 v119, v119, s62, -v22
  v_exp_f32 v112, v112
  v_exp_f32 v113, v113
  v_exp_f32 v114, v114
  v_exp_f32 v115, v115
  v_exp_f32 v116, v116
  v_exp_f32 v117, v117
  v_exp_f32 v118, v118
  v_exp_f32 v119, v119
  v_mul_f32 v23, v23, v24
  v_cvt_pk_bf16_f32 v120, v112, v113
  v_cvt_pk_bf16_f32 v121, v114, v115
  v_cvt_pk_bf16_f32 v122, v116, v117
  v_cvt_pk_bf16_f32 v123, v118, v119
  v_add_f32 v124, v112, v113
  v_add_f32 v125, v114, v115
  v_add_f32 v124, v124, v116
  v_add_f32 v125, v125, v117
  v_add_f32 v124, v124, v118
  v_add_f32 v125, v125, v119
  v_add_f32 v124, v124, v125
  v_add_f32 v23, v23, v124
  v_mul_f32_dpp v48, v24, v48 quad_perm:[0,0,0,0] row_mask:0xf bank_mask:0xf
  v_mul_f32_dpp v49, v24, v49 quad_perm:[1,1,1,1] row_mask:0xf bank_mask:0xf
  v_mul_f32_dpp v50, v24, v50 quad_perm:[2,2,2,2] row_mask:0xf bank_mask:0xf
  v_mul_f32_dpp v51, v24, v51 quad_perm:[3,3,3,3] row_mask:0xf bank_mask:0xf
  v_mul_f32_dpp v52, v24, v52 quad_perm:[0,0,0,0] row_mask:0xf bank_mask:0xf
  v_mul_f32_dpp v53, v24, v53 quad_perm:[1,1,1,1] row_mask:0xf bank_mask:0xf
  v_mul_f32_dpp v54, v24, v54 quad_perm:[2,2,2,2] row_mask:0xf bank_mask:0xf
  v_mul_f32_dpp v55, v24, v55 quad_perm:[3,3,3,3] row_mask:0xf bank_mask:0xf
  v_mul_f32_dpp v56, v24, v56 quad_perm:[0,0,0,0] row_mask:0xf bank_mask:0xf
  v_mul_f32_dpp v57, v24, v57 quad_perm:[1,1,1,1] row_mask:0xf bank_mask:0xf
  v_mul_f32_dpp v58, v24, v58 quad_perm:[2,2,2,2] row_mask:0xf bank_mask:0xf
  v_mul_f32_dpp v59, v24, v59 quad_perm:[3,3,3,3] row_mask:0xf bank_mask:0xf
  v_mul_f32_dpp v60, v24, v60 quad_perm:[0,0,0,0] row_mask:0xf bank_mask:0xf
  v_mul_f32_dpp v61, v24, v61 quad_perm:[1,1,1,1] row_mask:0xf bank_mask:0xf
  v_mul_f32_dpp v62, v24, v62 quad_perm:[2,2,2,2] row_mask:0xf bank_mask:0xf
  v_mul_f32_dpp v63, v24, v63 quad_perm:[3,3,3,3] row_mask:0xf bank_mask:0xf
  v_mul_f32_dpp v64, v24, v64 quad_perm:[0,0,0,0] row_mask:0xf bank_mask:0xf
  v_mul_f32_dpp v65, v24, v65 quad_perm:[1,1,1,1] row_mask:0xf bank_mask:0xf
  v_mul_f32_dpp v66, v24, v66 quad_perm:[2,2,2,2] row_mask:0xf bank_mask:0xf
  v_mul_f32_dpp v67, v24, v67 quad_perm:[3,3,3,3] row_mask:0xf bank_mask:0xf
  v_mul_f32_dpp v68, v24, v68 quad_perm:[0,0,0,0] row_mask:0xf bank_mask:0xf
  v_mul_f32_dpp v69, v24, v69 quad_perm:[1,1,1,1] row_mask:0xf bank_mask:0xf
  v_mul_f32_dpp v70, v24, v70 quad_perm:[2,2,2,2] row_mask:0xf bank_mask:0xf
  v_mul_f32_dpp v71, v24, v71 quad_perm:[3,3,3,3] row_mask:0xf bank_mask:0xf
  v_mul_f32_dpp v72, v24, v72 quad_perm:[0,0,0,0] row_mask:0xf bank_mask:0xf
  v_mul_f32_dpp v73, v24, v73 quad_perm:[1,1,1,1] row_mask:0xf bank_mask:0xf
  v_mul_f32_dpp v74, v24, v74 quad_perm:[2,2,2,2] row_mask:0xf bank_mask:0xf
  v_mul_f32_dpp v75, v24, v75 quad_perm:[3,3,3,3] row_mask:0xf bank_mask:0xf
  v_mul_f32_dpp v76, v24, v76 quad_perm:[0,0,0,0] row_mask:0xf bank_mask:0xf
  v_mul_f32_dpp v77, v24, v77 quad_perm:[1,1,1,1] row_mask:0xf bank_mask:0xf
  v_mul_f32_dpp v78, v24, v78 quad_perm:[2,2,2,2] row_mask:0xf bank_mask:0xf
  v_mul_f32_dpp v79, v24, v79 quad_perm:[3,3,3,3] row_mask:0xf bank_mask:0xf
  v_mfma_f32_16x16x32_bf16 v[48:51], v[120:123], a[160:163], v[48:51]
  v_mfma_f32_16x16x32_bf16 v[52:55], v[120:123], a[164:167], v[52:55]
  v_mfma_f32_16x16x32_bf16 v[56:59], v[120:123], a[168:171], v[56:59]
  v_mfma_f32_16x16x32_bf16 v[60:63], v[120:123], a[172:175], v[60:63]
  v_mfma_f32_16x16x32_bf16 v[64:67], v[120:123], a[176:179], v[64:67]
  v_mfma_f32_16x16x32_bf16 v[68:71], v[120:123], a[180:183], v[68:71]
  v_mfma_f32_16x16x32_bf16 v[72:75], v[120:123], a[184:187], v[72:75]
  v_mfma_f32_16x16x32_bf16 v[76:79], v[120:123], a[188:191], v[76:79]
  s_waitcnt vmcnt(24)
  ds_read_b128 v[80:83], v10 offset:0
  ds_read_b128 v[84:87], v11 offset:0
  ds_read_b128 v[88:91], v12 offset:0
  ds_read_b128 v[92:95], v13 offset:0
  ds_read_b128 v[96:99], v10 offset:4096
  ds_read_b128 v[100:103], v11 offset:4096
  ds_read_b128 v[104:107], v12 offset:4096
  ds_read_b128 v[108:111], v13 offset:4096
  s_waitcnt lgkmcnt(0)
  s_lshl_b32 s31, s29, 6
  s_add_u32 s31, s31, 52
  s_lshl_b32 s31, s31, 13
  s_add_u32 s31, s31, s68
  s_add_u32 s32, s6, s31
  s_addc_u32 s33, s7, 0
  s_add_u32 s34, s32, 16384
  s_addc_u32 s35, s33, 0
  s_add_u32 s36, s8, s31
  s_addc_u32 s37, s9, 0
  s_add_u32 s38, s36, 16384
  s_addc_u32 s39, s37, 0
  v_mfma_f32_16x16x32_bf16 v[112:115], v[80:83], v[32:35], 0
  v_mfma_f32_16x16x32_bf16 v[112:115], v[84:87], v[36:39], v[112:115]
  v_mfma_f32_16x16x32_bf16 v[112:115], v[88:91], v[40:43], v[112:115]
  v_mfma_f32_16x16x32_bf16 v[112:115], v[92:95], v[44:47], v[112:115]
  v_mfma_f32_16x16x32_bf16 v[116:119], v[96:99], v[32:35], 0
  v_mfma_f32_16x16x32_bf16 v[116:119], v[100:103], v[36:39], v[116:119]
  v_mfma_f32_16x16x32_bf16 v[116:119], v[104:107], v[40:43], v[116:119]
  v_mfma_f32_16x16x32_bf16 v[116:119], v[108:111], v[44:47], v[116:119]
  s_add_u32 m0, s47, 0
  s_nop 0
  global_load_lds_dwordx4 v4, s[32:33] offset:0 nt
  global_load_lds_dwordx4 v5, s[32:33] offset:1024 nt
  global_load_lds_dwordx4 v6, s[32:33] offset:2048 nt
  global_load_lds_dwordx4 v7, s[32:33] offset:3072 nt
  s_add_u32 m0, s47, 4096
  s_nop 0
  global_load_lds_dwordx4 v4, s[34:35] offset:0 nt
  global_load_lds_dwordx4 v5, s[34:35] offset:1024 nt
  global_load_lds_dwordx4 v6, s[34:35] offset:2048 nt
  global_load_lds_dwordx4 v7, s[34:35] offset:3072 nt
  s_waitcnt vmcnt(24)
  ds_read_b64_tr_b16 v[80:81], v14 offset:8192
  ds_read_b64_tr_b16 v[84:85], v15 offset:8192
  ds_read_b64_tr_b16 v[88:89], v16 offset:8192
  ds_read_b64_tr_b16 v[92:93], v17 offset:8192
  ds_read_b64_tr_b16 v[96:97], v18 offset:8192
  ds_read_b64_tr_b16 v[100:101], v19 offset:8192
  ds_read_b64_tr_b16 v[104:105], v20 offset:8192
  ds_read_b64_tr_b16 v[108:109], v21 offset:8192
  ds_read_b64_tr_b16 v[82:83], v14 offset:12288
  ds_read_b64_tr_b16 v[86:87], v15 offset:12288
  ds_read_b64_tr_b16 v[90:91], v16 offset:12288
  ds_read_b64_tr_b16 v[94:95], v17 offset:12288
  ds_read_b64_tr_b16 v[98:99], v18 offset:12288
  ds_read_b64_tr_b16 v[102:103], v19 offset:12288
  ds_read_b64_tr_b16 v[106:107], v20 offset:12288
  ds_read_b64_tr_b16 v[110:111], v21 offset:12288
  v_cvt_pk_bf16_f32 v120, v112, v113
  v_cvt_pk_bf16_f32 v121, v114, v115
  v_cvt_pk_bf16_f32 v122, v116, v117
  v_cvt_pk_bf16_f32 v123, v118, v119
  v_lshlrev_b32 v112, 16, v120
  v_and_b32 v113, 0xffff0000, v120
  v_lshlrev_b32 v114, 16, v121
  v_and_b32 v115, 0xffff0000, v121
  v_lshlrev_b32 v116, 16, v122
  v_and_b32 v117, 0xffff0000, v122
  v_lshlrev_b32 v118, 16, v123
  v_and_b32 v119, 0xffff0000, v123
  v_mul_f32 v112, s58, v112
  v_mul_f32 v113, s58, v113
  v_mul_f32 v114, s58, v114
  v_mul_f32 v115, s58, v115
  v_mul_f32 v116, s58, v116
  v_mul_f32 v117, s58, v117
  v_mul_f32 v118, s58, v118
  v_mul_f32 v119, s58, v119
  v_cvt_pk_bf16_f32 v120, v112, v113
  v_cvt_pk_bf16_f32 v121, v114, v115
  v_cvt_pk_bf16_f32 v122, v116, v117
  v_cvt_pk_bf16_f32 v123, v118, v119
  v_lshlrev_b32 v112, 16, v120
  v_and_b32 v113, 0xffff0000, v120
  v_lshlrev_b32 v114, 16, v121
  v_and_b32 v115, 0xffff0000, v121
  v_lshlrev_b32 v116, 16, v122
  v_and_b32 v117, 0xffff0000, v122
  v_lshlrev_b32 v118, 16, v123
  v_and_b32 v119, 0xffff0000, v123
  v_max3_f32 v124, v112, v113, v114
  v_max3_f32 v125, v115, v116, v117
  v_max3_f32 v124, v124, v118, v119
  v_max_f32 v124, v124, v125
  v_mov_b32 v125, v124
  s_nop 1
  v_permlane16_swap_b32 v124, v125
  v_max_f32 v124, v124, v125
  v_mov_b32 v125, v124
  s_nop 1
  v_permlane32_swap_b32 v124, v125
  v_max_f32 v124, v124, v125
  v_mul_f32 v124, s62, v124
  v_max_f32 v124, v124, v22
  v_sub_f32 v24, v22, v124
  v_exp_f32 v24, v24
  v_mov_b32 v22, v124
  v_fma_f32 v112, v112, s62, -v22
  v_fma_f32 v113, v113, s62, -v22
  v_fma_f32 v114, v114, s62, -v22
  v_fma_f32 v115, v115, s62, -v22
  v_fma_f32 v116, v116, s62, -v22
  v_fma_f32 v117, v117, s62, -v22
  v_fma_f32 v118, v118, s62, -v22
  v_fma_f32 v119, v119, s62, -v22
  v_exp_f32 v112, v112
  v_exp_f32 v113, v113
  v_exp_f32 v114, v114
  v_exp_f32 v115, v115
  v_exp_f32 v116, v116
  v_exp_f32 v117, v117
  v_exp_f32 v118, v118
  v_exp_f32 v119, v119
  v_mul_f32 v23, v23, v24
  v_cvt_pk_bf16_f32 v120, v112, v113
  v_cvt_pk_bf16_f32 v121, v114, v115
  v_cvt_pk_bf16_f32 v122, v116, v117
  v_cvt_pk_bf16_f32 v123, v118, v119
  v_add_f32 v124, v112, v113
  v_add_f32 v125, v114, v115
  v_add_f32 v124, v124, v116
  v_add_f32 v125, v125, v117
  v_add_f32 v124, v124, v118
  v_add_f32 v125, v125, v119
  v_add_f32 v124, v124, v125
  v_add_f32 v23, v23, v124
  v_mul_f32_dpp v48, v24, v48 quad_perm:[0,0,0,0] row_mask:0xf bank_mask:0xf
  v_mul_f32_dpp v49, v24, v49 quad_perm:[1,1,1,1] row_mask:0xf bank_mask:0xf
  v_mul_f32_dpp v50, v24, v50 quad_perm:[2,2,2,2] row_mask:0xf bank_mask:0xf
  v_mul_f32_dpp v51, v24, v51 quad_perm:[3,3,3,3] row_mask:0xf bank_mask:0xf
  v_mul_f32_dpp v52, v24, v52 quad_perm:[0,0,0,0] row_mask:0xf bank_mask:0xf
  v_mul_f32_dpp v53, v24, v53 quad_perm:[1,1,1,1] row_mask:0xf bank_mask:0xf
  v_mul_f32_dpp v54, v24, v54 quad_perm:[2,2,2,2] row_mask:0xf bank_mask:0xf
  v_mul_f32_dpp v55, v24, v55 quad_perm:[3,3,3,3] row_mask:0xf bank_mask:0xf
  v_mul_f32_dpp v56, v24, v56 quad_perm:[0,0,0,0] row_mask:0xf bank_mask:0xf
  v_mul_f32_dpp v57, v24, v57 quad_perm:[1,1,1,1] row_mask:0xf bank_mask:0xf
  v_mul_f32_dpp v58, v24, v58 quad_perm:[2,2,2,2] row_mask:0xf bank_mask:0xf
  v_mul_f32_dpp v59, v24, v59 quad_perm:[3,3,3,3] row_mask:0xf bank_mask:0xf
  v_mul_f32_dpp v60, v24, v60 quad_perm:[0,0,0,0] row_mask:0xf bank_mask:0xf
  v_mul_f32_dpp v61, v24, v61 quad_perm:[1,1,1,1] row_mask:0xf bank_mask:0xf
  v_mul_f32_dpp v62, v24, v62 quad_perm:[2,2,2,2] row_mask:0xf bank_mask:0xf
  v_mul_f32_dpp v63, v24, v63 quad_perm:[3,3,3,3] row_mask:0xf bank_mask:0xf
  v_mul_f32_dpp v64, v24, v64 quad_perm:[0,0,0,0] row_mask:0xf bank_mask:0xf
  v_mul_f32_dpp v65, v24, v65 quad_perm:[1,1,1,1] row_mask:0xf bank_mask:0xf
  v_mul_f32_dpp v66, v24, v66 quad_perm:[2,2,2,2] row_mask:0xf bank_mask:0xf
  v_mul_f32_dpp v67, v24, v67 quad_perm:[3,3,3,3] row_mask:0xf bank_mask:0xf
  v_mul_f32_dpp v68, v24, v68 quad_perm:[0,0,0,0] row_mask:0xf bank_mask:0xf
  v_mul_f32_dpp v69, v24, v69 quad_perm:[1,1,1,1] row_mask:0xf bank_mask:0xf
  v_mul_f32_dpp v70, v24, v70 quad_perm:[2,2,2,2] row_mask:0xf bank_mask:0xf
  v_mul_f32_dpp v71, v24, v71 quad_perm:[3,3,3,3] row_mask:0xf bank_mask:0xf
  v_mul_f32_dpp v72, v24, v72 quad_perm:[0,0,0,0] row_mask:0xf bank_mask:0xf
  v_mul_f32_dpp v73, v24, v73 quad_perm:[1,1,1,1] row_mask:0xf bank_mask:0xf
  v_mul_f32_dpp v74, v24, v74 quad_perm:[2,2,2,2] row_mask:0xf bank_mask:0xf
  v_mul_f32_dpp v75, v24, v75 quad_perm:[3,3,3,3] row_mask:0xf bank_mask:0xf
  v_mul_f32_dpp v76, v24, v76 quad_perm:[0,0,0,0] row_mask:0xf bank_mask:0xf
  v_mul_f32_dpp v77, v24, v77 quad_perm:[1,1,1,1] row_mask:0xf bank_mask:0xf
  v_mul_f32_dpp v78, v24, v78 quad_perm:[2,2,2,2] row_mask:0xf bank_mask:0xf
  v_mul_f32_dpp v79, v24, v79 quad_perm:[3,3,3,3] row_mask:0xf bank_mask:0xf
  s_waitcnt lgkmcnt(0)
  s_mov_b32 s46, 1
  s_atomic_add s46, s[92:93], 0 glc
  v_mfma_f32_16x16x32_bf16 v[48:51], v[120:123], v[80:83], v[48:51]
  v_mfma_f32_16x16x32_bf16 v[52:55], v[120:123], v[84:87], v[52:55]
  v_mfma_f32_16x16x32_bf16 v[56:59], v[120:123], v[88:91], v[56:59]
  v_mfma_f32_16x16x32_bf16 v[60:63], v[120:123], v[92:95], v[60:63]
  v_mfma_f32_16x16x32_bf16 v[64:67], v[120:123], v[96:99], v[64:67]
  v_mfma_f32_16x16x32_bf16 v[68:71], v[120:123], v[100:103], v[68:71]
  v_mfma_f32_16x16x32_bf16 v[72:75], v[120:123], v[104:107], v[72:75]
  v_mfma_f32_16x16x32_bf16 v[76:79], v[120:123], v[108:111], v[76:79]
  s_add_u32 m0, s47, 8192
  s_nop 0
  global_load_lds_dwordx4 v8, s[36:37] offset:0 nt
  global_load_lds_dwordx4 v9, s[36:37] offset:1024 nt
  global_load_lds_dwordx4 v8, s[36:37] offset:2048 nt
  global_load_lds_dwordx4 v9, s[36:37] offset:3072 nt
  s_add_u32 m0, s47, 12288
  s_nop 0
  global_load_lds_dwordx4 v8, s[38:39] offset:0 nt
  global_load_lds_dwordx4 v9, s[38:39] offset:1024 nt
  global_load_lds_dwordx4 v8, s[38:39] offset:2048 nt
  global_load_lds_dwordx4 v9, s[38:39] offset:3072 nt
  v_mfma_f32_16x16x32_bf16 v[112:115], a[192:195], v[32:35], 0
  v_mfma_f32_16x16x32_bf16 v[112:115], a[196:199], v[36:39], v[112:115]
  v_mfma_f32_16x16x32_bf16 v[112:115], a[200:203], v[40:43], v[112:115]
  v_mfma_f32_16x16x32_bf16 v[112:115], a[204:207], v[44:47], v[112:115]
  v_mfma_f32_16x16x32_bf16 v[116:119], a[208:211], v[32:35], 0
  v_mfma_f32_16x16x32_bf16 v[116:119], a[212:215], v[36:39], v[116:119]
  v_mfma_f32_16x16x32_bf16 v[116:119], a[216:219], v[40:43], v[116:119]
  v_mfma_f32_16x16x32_bf16 v[116:119], a[220:223], v[44:47], v[116:119]
  s_nop 3
  v_cvt_pk_bf16_f32 v120, v112, v113
  v_cvt_pk_bf16_f32 v121, v114, v115
  s_nop 1
  v_cvt_pk_bf16_f32 v122, v116, v117
  v_cvt_pk_bf16_f32 v123, v118, v119
  v_lshlrev_b32 v112, 16, v120
  v_and_b32 v113, 0xffff0000, v120
  v_lshlrev_b32 v114, 16, v121
  v_and_b32 v115, 0xffff0000, v121
  v_lshlrev_b32 v116, 16, v122
  v_and_b32 v117, 0xffff0000, v122
  v_lshlrev_b32 v118, 16, v123
  v_and_b32 v119, 0xffff0000, v123
  v_mul_f32 v112, s58, v112
  v_mul_f32 v113, s58, v113
  v_mul_f32 v114, s58, v114
  v_mul_f32 v115, s58, v115
  v_mul_f32 v116, s58, v116
  v_mul_f32 v117, s58, v117
  v_mul_f32 v118, s58, v118
  v_mul_f32 v119, s58, v119
  v_cvt_pk_bf16_f32 v120, v112, v113
  v_cvt_pk_bf16_f32 v121, v114, v115
  v_cvt_pk_bf16_f32 v122, v116, v117
  v_cvt_pk_bf16_f32 v123, v118, v119
  v_lshlrev_b32 v112, 16, v120
  v_and_b32 v113, 0xffff0000, v120
  v_lshlrev_b32 v114, 16, v121
  v_and_b32 v115, 0xffff0000, v121
  v_lshlrev_b32 v116, 16, v122
  v_and_b32 v117, 0xffff0000, v122
  v_lshlrev_b32 v118, 16, v123
  v_and_b32 v119, 0xffff0000, v123
  v_max3_f32 v124, v112, v113, v114
  v_max3_f32 v125, v115, v116, v117
  v_max3_f32 v124, v124, v118, v119
  v_max_f32 v124, v124, v125
  v_mov_b32 v125, v124
  s_nop 1
  v_permlane16_swap_b32 v124, v125
  v_max_f32 v124, v124, v125
  v_mov_b32 v125, v124
  s_nop 1
  v_permlane32_swap_b32 v124, v125
  v_max_f32 v124, v124, v125
  v_mul_f32 v124, s62, v124
  v_max_f32 v124, v124, v22
  v_sub_f32 v24, v22, v124
  v_exp_f32 v24, v24
  v_mov_b32 v22, v124
  v_fma_f32 v112, v112, s62, -v22
  v_fma_f32 v113, v113, s62, -v22
  v_fma_f32 v114, v114, s62, -v22
  v_fma_f32 v115, v115, s62, -v22
  v_fma_f32 v116, v116, s62, -v22
  v_fma_f32 v117, v117, s62, -v22
  v_fma_f32 v118, v118, s62, -v22
  v_fma_f32 v119, v119, s62, -v22
  v_exp_f32 v112, v112
  v_exp_f32 v113, v113
  v_exp_f32 v114, v114
  v_exp_f32 v115, v115
  v_exp_f32 v116, v116
  v_exp_f32 v117, v117
  v_exp_f32 v118, v118
  v_exp_f32 v119, v119
  v_mul_f32 v23, v23, v24
  v_cvt_pk_bf16_f32 v120, v112, v113
  v_cvt_pk_bf16_f32 v121, v114, v115
  v_cvt_pk_bf16_f32 v122, v116, v117
  v_cvt_pk_bf16_f32 v123, v118, v119
  v_add_f32 v124, v112, v113
  v_add_f32 v125, v114, v115
  v_add_f32 v124, v124, v116
  v_add_f32 v125, v125, v117
  v_add_f32 v124, v124, v118
  v_add_f32 v125, v125, v119
  v_add_f32 v124, v124, v125
  v_add_f32 v23, v23, v124
  v_mul_f32_dpp v48, v24, v48 quad_perm:[0,0,0,0] row_mask:0xf bank_mask:0xf
  v_mul_f32_dpp v49, v24, v49 quad_perm:[1,1,1,1] row_mask:0xf bank_mask:0xf
  v_mul_f32_dpp v50, v24, v50 quad_perm:[2,2,2,2] row_mask:0xf bank_mask:0xf
  v_mul_f32_dpp v51, v24, v51 quad_perm:[3,3,3,3] row_mask:0xf bank_mask:0xf
  v_mul_f32_dpp v52, v24, v52 quad_perm:[0,0,0,0] row_mask:0xf bank_mask:0xf
  v_mul_f32_dpp v53, v24, v53 quad_perm:[1,1,1,1] row_mask:0xf bank_mask:0xf
  v_mul_f32_dpp v54, v24, v54 quad_perm:[2,2,2,2] row_mask:0xf bank_mask:0xf
  v_mul_f32_dpp v55, v24, v55 quad_perm:[3,3,3,3] row_mask:0xf bank_mask:0xf
  v_mul_f32_dpp v56, v24, v56 quad_perm:[0,0,0,0] row_mask:0xf bank_mask:0xf
  v_mul_f32_dpp v57, v24, v57 quad_perm:[1,1,1,1] row_mask:0xf bank_mask:0xf
  v_mul_f32_dpp v58, v24, v58 quad_perm:[2,2,2,2] row_mask:0xf bank_mask:0xf
  v_mul_f32_dpp v59, v24, v59 quad_perm:[3,3,3,3] row_mask:0xf bank_mask:0xf
  v_mul_f32_dpp v60, v24, v60 quad_perm:[0,0,0,0] row_mask:0xf bank_mask:0xf
  v_mul_f32_dpp v61, v24, v61 quad_perm:[1,1,1,1] row_mask:0xf bank_mask:0xf
  v_mul_f32_dpp v62, v24, v62 quad_perm:[2,2,2,2] row_mask:0xf bank_mask:0xf
  v_mul_f32_dpp v63, v24, v63 quad_perm:[3,3,3,3] row_mask:0xf bank_mask:0xf
  v_mul_f32_dpp v64, v24, v64 quad_perm:[0,0,0,0] row_mask:0xf bank_mask:0xf
  v_mul_f32_dpp v65, v24, v65 quad_perm:[1,1,1,1] row_mask:0xf bank_mask:0xf
  v_mul_f32_dpp v66, v24, v66 quad_perm:[2,2,2,2] row_mask:0xf bank_mask:0xf
  v_mul_f32_dpp v67, v24, v67 quad_perm:[3,3,3,3] row_mask:0xf bank_mask:0xf
  v_mul_f32_dpp v68, v24, v68 quad_perm:[0,0,0,0] row_mask:0xf bank_mask:0xf
  v_mul_f32_dpp v69, v24, v69 quad_perm:[1,1,1,1] row_mask:0xf bank_mask:0xf
  v_mul_f32_dpp v70, v24, v70 quad_perm:[2,2,2,2] row_mask:0xf bank_mask:0xf
  v_mul_f32_dpp v71, v24, v71 quad_perm:[3,3,3,3] row_mask:0xf bank_mask:0xf
  v_mul_f32_dpp v72, v24, v72 quad_perm:[0,0,0,0] row_mask:0xf bank_mask:0xf
  v_mul_f32_dpp v73, v24, v73 quad_perm:[1,1,1,1] row_mask:0xf bank_mask:0xf
  v_mul_f32_dpp v74, v24, v74 quad_perm:[2,2,2,2] row_mask:0xf bank_mask:0xf
  v_mul_f32_dpp v75, v24, v75 quad_perm:[3,3,3,3] row_mask:0xf bank_mask:0xf
  v_mul_f32_dpp v76, v24, v76 quad_perm:[0,0,0,0] row_mask:0xf bank_mask:0xf
  v_mul_f32_dpp v77, v24, v77 quad_perm:[1,1,1,1] row_mask:0xf bank_mask:0xf
  v_mul_f32_dpp v78, v24, v78 quad_perm:[2,2,2,2] row_mask:0xf bank_mask:0xf
  v_mul_f32_dpp v79, v24, v79 quad_perm:[3,3,3,3] row_mask:0xf bank_mask:0xf
  v_mfma_f32_16x16x32_bf16 v[48:51], v[120:123], a[224:227], v[48:51]
  v_mfma_f32_16x16x32_bf16 v[52:55], v[120:123], a[228:231], v[52:55]
  v_mfma_f32_16x16x32_bf16 v[56:59], v[120:123], a[232:235], v[56:59]
  v_mfma_f32_16x16x32_bf16 v[60:63], v[120:123], a[236:239], v[60:63]
  v_mfma_f32_16x16x32_bf16 v[64:67], v[120:123], a[240:243], v[64:67]
  v_mfma_f32_16x16x32_bf16 v[68:71], v[120:123], a[244:247], v[68:71]
  v_mfma_f32_16x16x32_bf16 v[72:75], v[120:123], a[248:251], v[72:75]
  v_mfma_f32_16x16x32_bf16 v[76:79], v[120:123], a[252:255], v[76:79]
  s_nop 7
L_dtop_43:
  s_waitcnt vmcnt(24)
  ds_read_b128 v[80:83], v10 offset:16384
  ds_read_b128 v[84:87], v11 offset:16384
  ds_read_b128 v[88:91], v12 offset:16384
  ds_read_b128 v[92:95], v13 offset:16384
  ds_read_b128 v[96:99], v10 offset:20480
  ds_read_b128 v[100:103], v11 offset:20480
  ds_read_b128 v[104:107], v12 offset:20480
  ds_read_b128 v[108:111], v13 offset:20480
  s_waitcnt lgkmcnt(0)
  s_cmp_ge_u32 s46, 8
  s_cbranch_scc1 L_dt0_44
  v_mov_b32 v124, s46
  s_nop 0
  v_readfirstlane_b32 s46, v124
  s_and_b32 s31, s29, 24
  s_and_b32 s66, s46, 7
  s_add_u32 s31, s31, s66
  s_lshl_b32 s31, s31, 6
  s_lshr_b32 s66, s46, 3
  s_lshl_b32 s66, s66, 2
  s_sub_u32 s31, s31, s66
  s_add_u32 s31, s31, 60
  s_lshl_b32 s31, s31, 13
  s_add_u32 s31, s31, s68
  s_add_u32 s32, s6, s31
  s_addc_u32 s33, s7, 0
  s_add_u32 s34, s32, 16384
  s_addc_u32 s35, s33, 0
  s_add_u32 s36, s8, s31
  s_addc_u32 s37, s9, 0
  s_add_u32 s38, s36, 16384
  s_addc_u32 s39, s37, 0
  v_mfma_f32_16x16x32_bf16 v[112:115], v[80:83], v[32:35], 0
  v_mfma_f32_16x16x32_bf16 v[112:115], v[84:87], v[36:39], v[112:115]
  v_mfma_f32_16x16x32_bf16 v[112:115], v[88:91], v[40:43], v[112:115]
  v_mfma_f32_16x16x32_bf16 v[112:115], v[92:95], v[44:47], v[112:115]
  v_mfma_f32_16x16x32_bf16 v[116:119], v[96:99], v[32:35], 0
  v_mfma_f32_16x16x32_bf16 v[116:119], v[100:103], v[36:39], v[116:119]
  v_mfma_f32_16x16x32_bf16 v[116:119], v[104:107], v[40:43], v[116:119]
  v_mfma_f32_16x16x32_bf16 v[116:119], v[108:111], v[44:47], v[116:119]
  s_add_u32 m0, s47, 16384
  s_nop 0
  global_load_lds_dwordx4 v4, s[32:33] offset:0 nt
  global_load_lds_dwordx4 v5, s[32:33] offset:1024 nt
  global_load_lds_dwordx4 v6, s[32:33] offset:2048 nt
  global_load_lds_dwordx4 v7, s[32:33] offset:3072 nt
  s_add_u32 m0, s47, 20480
  s_nop 0
  global_load_lds_dwordx4 v4, s[34:35] offset:0 nt
  global_load_lds_dwordx4 v5, s[34:35] offset:1024 nt
  global_load_lds_dwordx4 v6, s[34:35] offset:2048 nt
  global_load_lds_dwordx4 v7, s[34:35] offset:3072 nt
  s_waitcnt vmcnt(24)
  ds_read_b64_tr_b16 v[80:81], v14 offset:24576
  ds_read_b64_tr_b16 v[84:85], v15 offset:24576
  ds_read_b64_tr_b16 v[88:89], v16 offset:24576
  ds_read_b64_tr_b16 v[92:93], v17 offset:24576
  ds_read_b64_tr_b16 v[96:97], v18 offset:24576
  ds_read_b64_tr_b16 v[100:101], v19 offset:24576
  ds_read_b64_tr_b16 v[104:105], v20 offset:24576
  ds_read_b64_tr_b16 v[108:109], v21 offset:24576
  ds_read_b64_tr_b16 v[82:83], v14 offset:28672
  ds_read_b64_tr_b16 v[86:87], v15 offset:28672
  ds_read_b64_tr_b16 v[90:91], v16 offset:28672
  ds_read_b64_tr_b16 v[94:95], v17 offset:28672
  ds_read_b64_tr_b16 v[98:99], v18 offset:28672
  ds_read_b64_tr_b16 v[102:103], v19 offset:28672
  ds_read_b64_tr_b16 v[106:107], v20 offset:28672
  ds_read_b64_tr_b16 v[110:111], v21 offset:28672
  v_cvt_pk_bf16_f32 v120, v112, v113
  v_cvt_pk_bf16_f32 v121, v114, v115
  v_cvt_pk_bf16_f32 v122, v116, v117
  v_cvt_pk_bf16_f32 v123, v118, v119
  v_lshlrev_b32 v112, 16, v120
  v_and_b32 v113, 0xffff0000, v120
  v_lshlrev_b32 v114, 16, v121
  v_and_b32 v115, 0xffff0000, v121
  v_lshlrev_b32 v116, 16, v122
  v_and_b32 v117, 0xffff0000, v122
  v_lshlrev_b32 v118, 16, v123
  v_and_b32 v119, 0xffff0000, v123
  v_mul_f32 v112, s58, v112
  v_mul_f32 v113, s58, v113
  v_mul_f32 v114, s58, v114
  v_mul_f32 v115, s58, v115
  v_mul_f32 v116, s58, v116
  v_mul_f32 v117, s58, v117
  v_mul_f32 v118, s58, v118
  v_mul_f32 v119, s58, v119
  v_cvt_pk_bf16_f32 v120, v112, v113
  v_cvt_pk_bf16_f32 v121, v114, v115
  v_cvt_pk_bf16_f32 v122, v116, v117
  v_cvt_pk_bf16_f32 v123, v118, v119
  v_lshlrev_b32 v112, 16, v120
  v_and_b32 v113, 0xffff0000, v120
  v_lshlrev_b32 v114, 16, v121
  v_and_b32 v115, 0xffff0000, v121
  v_lshlrev_b32 v116, 16, v122
  v_and_b32 v117, 0xffff0000, v122
  v_lshlrev_b32 v118, 16, v123
  v_and_b32 v119, 0xffff0000, v123
  v_max3_f32 v124, v112, v113, v114
  v_max3_f32 v125, v115, v116, v117
  v_max3_f32 v124, v124, v118, v119
  v_max_f32 v124, v124, v125
  v_mov_b32 v125, v124
  s_nop 1
  v_permlane16_swap_b32 v124, v125
  v_max_f32 v124, v124, v125
  v_mov_b32 v125, v124
  s_nop 1
  v_permlane32_swap_b32 v124, v125
  v_max_f32 v124, v124, v125
  v_mul_f32 v124, s62, v124
  v_max_f32 v124, v124, v22
  v_sub_f32 v24, v22, v124
  v_exp_f32 v24, v24
  v_mov_b32 v22, v124
  v_fma_f32 v112, v112, s62, -v22
  v_fma_f32 v113, v113, s62, -v22
  v_fma_f32 v114, v114, s62, -v22
  v_fma_f32 v115, v115, s62, -v22
  v_fma_f32 v116, v116, s62, -v22
  v_fma_f32 v117, v117, s62, -v22
  v_fma_f32 v118, v118, s62, -v22
  v_fma_f32 v119, v119, s62, -v22
  v_exp_f32 v112, v112
  v_exp_f32 v113, v113
  v_exp_f32 v114, v114
  v_exp_f32 v115, v115
  v_exp_f32 v116, v116
  v_exp_f32 v117, v117
  v_exp_f32 v118, v118
  v_exp_f32 v119, v119
  v_mul_f32 v23, v23, v24
  v_cvt_pk_bf16_f32 v120, v112, v113
  v_cvt_pk_bf16_f32 v121, v114, v115
  v_cvt_pk_bf16_f32 v122, v116, v117
  v_cvt_pk_bf16_f32 v123, v118, v119
  v_add_f32 v124, v112, v113
  v_add_f32 v125, v114, v115
  v_add_f32 v124, v124, v116
  v_add_f32 v125, v125, v117
  v_add_f32 v124, v124, v118
  v_add_f32 v125, v125, v119
  v_add_f32 v124, v124, v125
  v_add_f32 v23, v23, v124
  v_mul_f32_dpp v48, v24, v48 quad_perm:[0,0,0,0] row_mask:0xf bank_mask:0xf
  v_mul_f32_dpp v49, v24, v49 quad_perm:[1,1,1,1] row_mask:0xf bank_mask:0xf
  v_mul_f32_dpp v50, v24, v50 quad_perm:[2,2,2,2] row_mask:0xf bank_mask:0xf
  v_mul_f32_dpp v51, v24, v51 quad_perm:[3,3,3,3] row_mask:0xf bank_mask:0xf
  v_mul_f32_dpp v52, v24, v52 quad_perm:[0,0,0,0] row_mask:0xf bank_mask:0xf
  v_mul_f32_dpp v53, v24, v53 quad_perm:[1,1,1,1] row_mask:0xf bank_mask:0xf
  v_mul_f32_dpp v54, v24, v54 quad_perm:[2,2,2,2] row_mask:0xf bank_mask:0xf
  v_mul_f32_dpp v55, v24, v55 quad_perm:[3,3,3,3] row_mask:0xf bank_mask:0xf
  v_mul_f32_dpp v56, v24, v56 quad_perm:[0,0,0,0] row_mask:0xf bank_mask:0xf
  v_mul_f32_dpp v57, v24, v57 quad_perm:[1,1,1,1] row_mask:0xf bank_mask:0xf
  v_mul_f32_dpp v58, v24, v58 quad_perm:[2,2,2,2] row_mask:0xf bank_mask:0xf
  v_mul_f32_dpp v59, v24, v59 quad_perm:[3,3,3,3] row_mask:0xf bank_mask:0xf
  v_mul_f32_dpp v60, v24, v60 quad_perm:[0,0,0,0] row_mask:0xf bank_mask:0xf
  v_mul_f32_dpp v61, v24, v61 quad_perm:[1,1,1,1] row_mask:0xf bank_mask:0xf
  v_mul_f32_dpp v62, v24, v62 quad_perm:[2,2,2,2] row_mask:0xf bank_mask:0xf
  v_mul_f32_dpp v63, v24, v63 quad_perm:[3,3,3,3] row_mask:0xf bank_mask:0xf
  v_mul_f32_dpp v64, v24, v64 quad_perm:[0,0,0,0] row_mask:0xf bank_mask:0xf
  v_mul_f32_dpp v65, v24, v65 quad_perm:[1,1,1,1] row_mask:0xf bank_mask:0xf
  v_mul_f32_dpp v66, v24, v66 quad_perm:[2,2,2,2] row_mask:0xf bank_mask:0xf
  v_mul_f32_dpp v67, v24, v67 quad_perm:[3,3,3,3] row_mask:0xf bank_mask:0xf
  v_mul_f32_dpp v68, v24, v68 quad_perm:[0,0,0,0] row_mask:0xf bank_mask:0xf
  v_mul_f32_dpp v69, v24, v69 quad_perm:[1,1,1,1] row_mask:0xf bank_mask:0xf
  v_mul_f32_dpp v70, v24, v70 quad_perm:[2,2,2,2] row_mask:0xf bank_mask:0xf
  v_mul_f32_dpp v71, v24, v71 quad_perm:[3,3,3,3] row_mask:0xf bank_mask:0xf
  v_mul_f32_dpp v72, v24, v72 quad_perm:[0,0,0,0] row_mask:0xf bank_mask:0xf
  v_mul_f32_dpp v73, v24, v73 quad_perm:[1,1,1,1] row_mask:0xf bank_mask:0xf
  v_mul_f32_dpp v74, v24, v74 quad_perm:[2,2,2,2] row_mask:0xf bank_mask:0xf
  v_mul_f32_dpp v75, v24, v75 quad_perm:[3,3,3,3] row_mask:0xf bank_mask:0xf
  v_mul_f32_dpp v76, v24, v76 quad_perm:[0,0,0,0] row_mask:0xf bank_mask:0xf
  v_mul_f32_dpp v77, v24, v77 quad_perm:[1,1,1,1] row_mask:0xf bank_mask:0xf
  v_mul_f32_dpp v78, v24, v78 quad_perm:[2,2,2,2] row_mask:0xf bank_mask:0xf
  v_mul_f32_dpp v79, v24, v79 quad_perm:[3,3,3,3] row_mask:0xf bank_mask:0xf
  s_waitcnt lgkmcnt(0)
  s_mov_b32 s46, 1
  s_atomic_add s46, s[92:93], 0 glc
  v_mfma_f32_16x16x32_bf16 v[48:51], v[120:123], v[80:83], v[48:51]
  v_mfma_f32_16x16x32_bf16 v[52:55], v[120:123], v[84:87], v[52:55]
  v_mfma_f32_16x16x32_bf16 v[56:59], v[120:123], v[88:91], v[56:59]
  v_mfma_f32_16x16x32_bf16 v[60:63], v[120:123], v[92:95], v[60:63]
  v_mfma_f32_16x16x32_bf16 v[64:67], v[120:123], v[96:99], v[64:67]
  v_mfma_f32_16x16x32_bf16 v[68:71], v[120:123], v[100:103], v[68:71]
  v_mfma_f32_16x16x32_bf16 v[72:75], v[120:123], v[104:107], v[72:75]
  v_mfma_f32_16x16x32_bf16 v[76:79], v[120:123], v[108:111], v[76:79]
  s_add_u32 m0, s47, 24576
  s_nop 0
  global_load_lds_dwordx4 v8, s[36:37] offset:0 nt
  global_load_lds_dwordx4 v9, s[36:37] offset:1024 nt
  global_load_lds_dwordx4 v8, s[36:37] offset:2048 nt
  global_load_lds_dwordx4 v9, s[36:37] offset:3072 nt
  s_add_u32 m0, s47, 28672
  s_nop 0
  global_load_lds_dwordx4 v8, s[38:39] offset:0 nt
  global_load_lds_dwordx4 v9, s[38:39] offset:1024 nt
  global_load_lds_dwordx4 v8, s[38:39] offset:2048 nt
  global_load_lds_dwordx4 v9, s[38:39] offset:3072 nt
  s_waitcnt vmcnt(24)
  ds_read_b128 v[80:83], v10 offset:0
  ds_read_b128 v[84:87], v11 offset:0
  ds_read_b128 v[88:91], v12 offset:0
  ds_read_b128 v[92:95], v13 offset:0
  ds_read_b128 v[96:99], v10 offset:4096
  ds_read_b128 v[100:103], v11 offset:4096
  ds_read_b128 v[104:107], v12 offset:4096
  ds_read_b128 v[108:111], v13 offset:4096
  s_waitcnt lgkmcnt(0)
  s_cmp_ge_u32 s46, 8
  s_cbranch_scc1 L_dt1_45
  v_mov_b32 v124, s46
  s_nop 0
  v_readfirstlane_b32 s46, v124
  s_and_b32 s31, s29, 24
  s_and_b32 s66, s46, 7
  s_add_u32 s31, s31, s66
  s_lshl_b32 s31, s31, 6
  s_lshr_b32 s66, s46, 3
  s_lshl_b32 s66, s66, 2
  s_sub_u32 s31, s31, s66
  s_add_u32 s31, s31, 60
  s_lshl_b32 s31, s31, 13
  s_add_u32 s31, s31, s68
  s_add_u32 s32, s6, s31
  s_addc_u32 s33, s7, 0
  s_add_u32 s34, s32, 16384
  s_addc_u32 s35, s33, 0
  s_add_u32 s36, s8, s31
  s_addc_u32 s37, s9, 0
  s_add_u32 s38, s36, 16384
  s_addc_u32 s39, s37, 0
  v_mfma_f32_16x16x32_bf16 v[112:115], v[80:83], v[32:35], 0
  v_mfma_f32_16x16x32_bf16 v[112:115], v[84:87], v[36:39], v[112:115]
  v_mfma_f32_16x16x32_bf16 v[112:115], v[88:91], v[40:43], v[112:115]
  v_mfma_f32_16x16x32_bf16 v[112:115], v[92:95], v[44:47], v[112:115]
  v_mfma_f32_16x16x32_bf16 v[116:119], v[96:99], v[32:35], 0
  v_mfma_f32_16x16x32_bf16 v[116:119], v[100:103], v[36:39], v[116:119]
  v_mfma_f32_16x16x32_bf16 v[116:119], v[104:107], v[40:43], v[116:119]
  v_mfma_f32_16x16x32_bf16 v[116:119], v[108:111], v[44:47], v[116:119]
  s_add_u32 m0, s47, 0
  s_nop 0
  global_load_lds_dwordx4 v4, s[32:33] offset:0 nt
  global_load_lds_dwordx4 v5, s[32:33] offset:1024 nt
  global_load_lds_dwordx4 v6, s[32:33] offset:2048 nt
  global_load_lds_dwordx4 v7, s[32:33] offset:3072 nt
  s_add_u32 m0, s47, 4096
  s_nop 0
  global_load_lds_dwordx4 v4, s[34:35] offset:0 nt
  global_load_lds_dwordx4 v5, s[34:35] offset:1024 nt
  global_load_lds_dwordx4 v6, s[34:35] offset:2048 nt
  global_load_lds_dwordx4 v7, s[34:35] offset:3072 nt
  s_waitcnt vmcnt(24)
  ds_read_b64_tr_b16 v[80:81], v14 offset:8192
  ds_read_b64_tr_b16 v[84:85], v15 offset:8192
  ds_read_b64_tr_b16 v[88:89], v16 offset:8192
  ds_read_b64_tr_b16 v[92:93], v17 offset:8192
  ds_read_b64_tr_b16 v[96:97], v18 offset:8192
  ds_read_b64_tr_b16 v[100:101], v19 offset:8192
  ds_read_b64_tr_b16 v[104:105], v20 offset:8192
  ds_read_b64_tr_b16 v[108:109], v21 offset:8192
  ds_read_b64_tr_b16 v[82:83], v14 offset:12288
  ds_read_b64_tr_b16 v[86:87], v15 offset:12288
  ds_read_b64_tr_b16 v[90:91], v16 offset:12288
  ds_read_b64_tr_b16 v[94:95], v17 offset:12288
  ds_read_b64_tr_b16 v[98:99], v18 offset:12288
  ds_read_b64_tr_b16 v[102:103], v19 offset:12288
  ds_read_b64_tr_b16 v[106:107], v20 offset:12288
  ds_read_b64_tr_b16 v[110:111], v21 offset:12288
  v_cvt_pk_bf16_f32 v120, v112, v113
  v_cvt_pk_bf16_f32 v121, v114, v115
  v_cvt_pk_bf16_f32 v122, v116, v117
  v_cvt_pk_bf16_f32 v123, v118, v119
  v_lshlrev_b32 v112, 16, v120
  v_and_b32 v113, 0xffff0000, v120
  v_lshlrev_b32 v114, 16, v121
  v_and_b32 v115, 0xffff0000, v121
  v_lshlrev_b32 v116, 16, v122
  v_and_b32 v117, 0xffff0000, v122
  v_lshlrev_b32 v118, 16, v123
  v_and_b32 v119, 0xffff0000, v123
  v_mul_f32 v112, s58, v112
  v_mul_f32 v113, s58, v113
  v_mul_f32 v114, s58, v114
  v_mul_f32 v115, s58, v115
  v_mul_f32 v116, s58, v116
  v_mul_f32 v117, s58, v117
  v_mul_f32 v118, s58, v118
  v_mul_f32 v119, s58, v119
  v_cvt_pk_bf16_f32 v120, v112, v113
  v_cvt_pk_bf16_f32 v121, v114, v115
  v_cvt_pk_bf16_f32 v122, v116, v117
  v_cvt_pk_bf16_f32 v123, v118, v119
  v_lshlrev_b32 v112, 16, v120
  v_and_b32 v113, 0xffff0000, v120
  v_lshlrev_b32 v114, 16, v121
  v_and_b32 v115, 0xffff0000, v121
  v_lshlrev_b32 v116, 16, v122
  v_and_b32 v117, 0xffff0000, v122
  v_lshlrev_b32 v118, 16, v123
  v_and_b32 v119, 0xffff0000, v123
  v_max3_f32 v124, v112, v113, v114
  v_max3_f32 v125, v115, v116, v117
  v_max3_f32 v124, v124, v118, v119
  v_max_f32 v124, v124, v125
  v_mov_b32 v125, v124
  s_nop 1
  v_permlane16_swap_b32 v124, v125
  v_max_f32 v124, v124, v125
  v_mov_b32 v125, v124
  s_nop 1
  v_permlane32_swap_b32 v124, v125
  v_max_f32 v124, v124, v125
  v_mul_f32 v124, s62, v124
  v_max_f32 v124, v124, v22
  v_sub_f32 v24, v22, v124
  v_exp_f32 v24, v24
  v_mov_b32 v22, v124
  v_fma_f32 v112, v112, s62, -v22
  v_fma_f32 v113, v113, s62, -v22
  v_fma_f32 v114, v114, s62, -v22
  v_fma_f32 v115, v115, s62, -v22
  v_fma_f32 v116, v116, s62, -v22
  v_fma_f32 v117, v117, s62, -v22
  v_fma_f32 v118, v118, s62, -v22
  v_fma_f32 v119, v119, s62, -v22
  v_exp_f32 v112, v112
  v_exp_f32 v113, v113
  v_exp_f32 v114, v114
  v_exp_f32 v115, v115
  v_exp_f32 v116, v116
  v_exp_f32 v117, v117
  v_exp_f32 v118, v118
  v_exp_f32 v119, v119
  v_mul_f32 v23, v23, v24
  v_cvt_pk_bf16_f32 v120, v112, v113
  v_cvt_pk_bf16_f32 v121, v114, v115
  v_cvt_pk_bf16_f32 v122, v116, v117
  v_cvt_pk_bf16_f32 v123, v118, v119
  v_add_f32 v124, v112, v113
  v_add_f32 v125, v114, v115
  v_add_f32 v124, v124, v116
  v_add_f32 v125, v125, v117
  v_add_f32 v124, v124, v118
  v_add_f32 v125, v125, v119
  v_add_f32 v124, v124, v125
  v_add_f32 v23, v23, v124
  v_mul_f32_dpp v48, v24, v48 quad_perm:[0,0,0,0] row_mask:0xf bank_mask:0xf
  v_mul_f32_dpp v49, v24, v49 quad_perm:[1,1,1,1] row_mask:0xf bank_mask:0xf
  v_mul_f32_dpp v50, v24, v50 quad_perm:[2,2,2,2] row_mask:0xf bank_mask:0xf
  v_mul_f32_dpp v51, v24, v51 quad_perm:[3,3,3,3] row_mask:0xf bank_mask:0xf
  v_mul_f32_dpp v52, v24, v52 quad_perm:[0,0,0,0] row_mask:0xf bank_mask:0xf
  v_mul_f32_dpp v53, v24, v53 quad_perm:[1,1,1,1] row_mask:0xf bank_mask:0xf
  v_mul_f32_dpp v54, v24, v54 quad_perm:[2,2,2,2] row_mask:0xf bank_mask:0xf
  v_mul_f32_dpp v55, v24, v55 quad_perm:[3,3,3,3] row_mask:0xf bank_mask:0xf
  v_mul_f32_dpp v56, v24, v56 quad_perm:[0,0,0,0] row_mask:0xf bank_mask:0xf
  v_mul_f32_dpp v57, v24, v57 quad_perm:[1,1,1,1] row_mask:0xf bank_mask:0xf
  v_mul_f32_dpp v58, v24, v58 quad_perm:[2,2,2,2] row_mask:0xf bank_mask:0xf
  v_mul_f32_dpp v59, v24, v59 quad_perm:[3,3,3,3] row_mask:0xf bank_mask:0xf
  v_mul_f32_dpp v60, v24, v60 quad_perm:[0,0,0,0] row_mask:0xf bank_mask:0xf
  v_mul_f32_dpp v61, v24, v61 quad_perm:[1,1,1,1] row_mask:0xf bank_mask:0xf
  v_mul_f32_dpp v62, v24, v62 quad_perm:[2,2,2,2] row_mask:0xf bank_mask:0xf
  v_mul_f32_dpp v63, v24, v63 quad_perm:[3,3,3,3] row_mask:0xf bank_mask:0xf
  v_mul_f32_dpp v64, v24, v64 quad_perm:[0,0,0,0] row_mask:0xf bank_mask:0xf
  v_mul_f32_dpp v65, v24, v65 quad_perm:[1,1,1,1] row_mask:0xf bank_mask:0xf
  v_mul_f32_dpp v66, v24, v66 quad_perm:[2,2,2,2] row_mask:0xf bank_mask:0xf
  v_mul_f32_dpp v67, v24, v67 quad_perm:[3,3,3,3] row_mask:0xf bank_mask:0xf
  v_mul_f32_dpp v68, v24, v68 quad_perm:[0,0,0,0] row_mask:0xf bank_mask:0xf
  v_mul_f32_dpp v69, v24, v69 quad_perm:[1,1,1,1] row_mask:0xf bank_mask:0xf
  v_mul_f32_dpp v70, v24, v70 quad_perm:[2,2,2,2] row_mask:0xf bank_mask:0xf
  v_mul_f32_dpp v71, v24, v71 quad_perm:[3,3,3,3] row_mask:0xf bank_mask:0xf
  v_mul_f32_dpp v72, v24, v72 quad_perm:[0,0,0,0] row_mask:0xf bank_mask:0xf
  v_mul_f32_dpp v73, v24, v73 quad_perm:[1,1,1,1] row_mask:0xf bank_mask:0xf
  v_mul_f32_dpp v74, v24, v74 quad_perm:[2,2,2,2] row_mask:0xf bank_mask:0xf
  v_mul_f32_dpp v75, v24, v75 quad_perm:[3,3,3,3] row_mask:0xf bank_mask:0xf
  v_mul_f32_dpp v76, v24, v76 quad_perm:[0,0,0,0] row_mask:0xf bank_mask:0xf
  v_mul_f32_dpp v77, v24, v77 quad_perm:[1,1,1,1] row_mask:0xf bank_mask:0xf
  v_mul_f32_dpp v78, v24, v78 quad_perm:[2,2,2,2] row_mask:0xf bank_mask:0xf
  v_mul_f32_dpp v79, v24, v79 quad_perm:[3,3,3,3] row_mask:0xf bank_mask:0xf
  s_waitcnt lgkmcnt(0)
  s_mov_b32 s46, 1
  s_atomic_add s46, s[92:93], 0 glc
  v_mfma_f32_16x16x32_bf16 v[48:51], v[120:123], v[80:83], v[48:51]
  v_mfma_f32_16x16x32_bf16 v[52:55], v[120:123], v[84:87], v[52:55]
  v_mfma_f32_16x16x32_bf16 v[56:59], v[120:123], v[88:91], v[56:59]
  v_mfma_f32_16x16x32_bf16 v[60:63], v[120:123], v[92:95], v[60:63]
  v_mfma_f32_16x16x32_bf16 v[64:67], v[120:123], v[96:99], v[64:67]
  v_mfma_f32_16x16x32_bf16 v[68:71], v[120:123], v[100:103], v[68:71]
  v_mfma_f32_16x16x32_bf16 v[72:75], v[120:123], v[104:107], v[72:75]
  v_mfma_f32_16x16x32_bf16 v[76:79], v[120:123], v[108:111], v[76:79]
  s_add_u32 m0, s47, 8192
  s_nop 0
  global_load_lds_dwordx4 v8, s[36:37] offset:0 nt
  global_load_lds_dwordx4 v9, s[36:37] offset:1024 nt
  global_load_lds_dwordx4 v8, s[36:37] offset:2048 nt
  global_load_lds_dwordx4 v9, s[36:37] offset:3072 nt
  s_add_u32 m0, s47, 12288
  s_nop 0
  global_load_lds_dwordx4 v8, s[38:39] offset:0 nt
  global_load_lds_dwordx4 v9, s[38:39] offset:1024 nt
  global_load_lds_dwordx4 v8, s[38:39] offset:2048 nt
  global_load_lds_dwordx4 v9, s[38:39] offset:3072 nt
  s_nop 7
  s_branch L_dtop_43
L_dt0_44:
  v_mfma_f32_16x16x32_bf16 v[112:115], v[80:83], v[32:35], 0
  v_mfma_f32_16x16x32_bf16 v[112:115], v[84:87], v[36:39], v[112:115]
  v_mfma_f32_16x16x32_bf16 v[112:115], v[88:91], v[40:43], v[112:115]
  v_mfma_f32_16x16x32_bf16 v[112:115], v[92:95], v[44:47], v[112:115]
  v_mfma_f32_16x16x32_bf16 v[116:119], v[96:99], v[32:35], 0
  v_mfma_f32_16x16x32_bf16 v[116:119], v[100:103], v[36:39], v[116:119]
  v_mfma_f32_16x16x32_bf16 v[116:119], v[104:107], v[40:43], v[116:119]
  v_mfma_f32_16x16x32_bf16 v[116:119], v[108:111], v[44:47], v[116:119]
  s_waitcnt vmcnt(16)
  ds_read_b64_tr_b16 v[80:81], v14 offset:24576
  ds_read_b64_tr_b16 v[84:85], v15 offset:24576
  ds_read_b64_tr_b16 v[88:89], v16 offset:24576
  ds_read_b64_tr_b16 v[92:93], v17 offset:24576
  ds_read_b64_tr_b16 v[96:97], v18 offset:24576
  ds_read_b64_tr_b16 v[100:101], v19 offset:24576
  ds_read_b64_tr_b16 v[104:105], v20 offset:24576
  ds_read_b64_tr_b16 v[108:109], v21 offset:24576
  ds_read_b64_tr_b16 v[82:83], v14 offset:28672
  ds_read_b64_tr_b16 v[86:87], v15 offset:28672
  ds_read_b64_tr_b16 v[90:91], v16 offset:28672
  ds_read_b64_tr_b16 v[94:95], v17 offset:28672
  ds_read_b64_tr_b16 v[98:99], v18 offset:28672
  ds_read_b64_tr_b16 v[102:103], v19 offset:28672
  ds_read_b64_tr_b16 v[106:107], v20 offset:28672
  ds_read_b64_tr_b16 v[110:111], v21 offset:28672
  v_cvt_pk_bf16_f32 v120, v112, v113
  v_cvt_pk_bf16_f32 v121, v114, v115
  v_cvt_pk_bf16_f32 v122, v116, v117
  v_cvt_pk_bf16_f32 v123, v118, v119
  v_lshlrev_b32 v112, 16, v120
  v_and_b32 v113, 0xffff0000, v120
  v_lshlrev_b32 v114, 16, v121
  v_and_b32 v115, 0xffff0000, v121
  v_lshlrev_b32 v116, 16, v122
  v_and_b32 v117, 0xffff0000, v122
  v_lshlrev_b32 v118, 16, v123
  v_and_b32 v119, 0xffff0000, v123
  v_mul_f32 v112, s58, v112
  v_mul_f32 v113, s58, v113
  v_mul_f32 v114, s58, v114
  v_mul_f32 v115, s58, v115
  v_mul_f32 v116, s58, v116
  v_mul_f32 v117, s58, v117
  v_mul_f32 v118, s58, v118
  v_mul_f32 v119, s58, v119
  v_cvt_pk_bf16_f32 v120, v112, v113
  v_cvt_pk_bf16_f32 v121, v114, v115
  v_cvt_pk_bf16_f32 v122, v116, v117
  v_cvt_pk_bf16_f32 v123, v118, v119
  v_lshlrev_b32 v112, 16, v120
  v_and_b32 v113, 0xffff0000, v120
  v_lshlrev_b32 v114, 16, v121
  v_and_b32 v115, 0xffff0000, v121
  v_lshlrev_b32 v116, 16, v122
  v_and_b32 v117, 0xffff0000, v122
  v_lshlrev_b32 v118, 16, v123
  v_and_b32 v119, 0xffff0000, v123
  v_max3_f32 v124, v112, v113, v114
  v_max3_f32 v125, v115, v116, v117
  v_max3_f32 v124, v124, v118, v119
  v_max_f32 v124, v124, v125
  v_mov_b32 v125, v124
  s_nop 1
  v_permlane16_swap_b32 v124, v125
  v_max_f32 v124, v124, v125
  v_mov_b32 v125, v124
  s_nop 1
  v_permlane32_swap_b32 v124, v125
  v_max_f32 v124, v124, v125
  v_mul_f32 v124, s62, v124
  v_max_f32 v124, v124, v22
  v_sub_f32 v24, v22, v124
  v_exp_f32 v24, v24
  v_mov_b32 v22, v124
  v_fma_f32 v112, v112, s62, -v22
  v_fma_f32 v113, v113, s62, -v22
  v_fma_f32 v114, v114, s62, -v22
  v_fma_f32 v115, v115, s62, -v22
  v_fma_f32 v116, v116, s62, -v22
  v_fma_f32 v117, v117, s62, -v22
  v_fma_f32 v118, v118, s62, -v22
  v_fma_f32 v119, v119, s62, -v22
  v_exp_f32 v112, v112
  v_exp_f32 v113, v113
  v_exp_f32 v114, v114
  v_exp_f32 v115, v115
  v_exp_f32 v116, v116
  v_exp_f32 v117, v117
  v_exp_f32 v118, v118
  v_exp_f32 v119, v119
  v_mul_f32 v23, v23, v24
  v_cvt_pk_bf16_f32 v120, v112, v113
  v_cvt_pk_bf16_f32 v121, v114, v115
  v_cvt_pk_bf16_f32 v122, v116, v117
  v_cvt_pk_bf16_f32 v123, v118, v119
  v_add_f32 v124, v112, v113
  v_add_f32 v125, v114, v115
  v_add_f32 v124, v124, v116
  v_add_f32 v125, v125, v117
  v_add_f32 v124, v124, v118
  v_add_f32 v125, v125, v119
  v_add_f32 v124, v124, v125
  v_add_f32 v23, v23, v124
  v_mul_f32_dpp v48, v24, v48 quad_perm:[0,0,0,0] row_mask:0xf bank_mask:0xf
  v_mul_f32_dpp v49, v24, v49 quad_perm:[1,1,1,1] row_mask:0xf bank_mask:0xf
  v_mul_f32_dpp v50, v24, v50 quad_perm:[2,2,2,2] row_mask:0xf bank_mask:0xf
  v_mul_f32_dpp v51, v24, v51 quad_perm:[3,3,3,3] row_mask:0xf bank_mask:0xf
  v_mul_f32_dpp v52, v24, v52 quad_perm:[0,0,0,0] row_mask:0xf bank_mask:0xf
  v_mul_f32_dpp v53, v24, v53 quad_perm:[1,1,1,1] row_mask:0xf bank_mask:0xf
  v_mul_f32_dpp v54, v24, v54 quad_perm:[2,2,2,2] row_mask:0xf bank_mask:0xf
  v_mul_f32_dpp v55, v24, v55 quad_perm:[3,3,3,3] row_mask:0xf bank_mask:0xf
  v_mul_f32_dpp v56, v24, v56 quad_perm:[0,0,0,0] row_mask:0xf bank_mask:0xf
  v_mul_f32_dpp v57, v24, v57 quad_perm:[1,1,1,1] row_mask:0xf bank_mask:0xf
  v_mul_f32_dpp v58, v24, v58 quad_perm:[2,2,2,2] row_mask:0xf bank_mask:0xf
  v_mul_f32_dpp v59, v24, v59 quad_perm:[3,3,3,3] row_mask:0xf bank_mask:0xf
  v_mul_f32_dpp v60, v24, v60 quad_perm:[0,0,0,0] row_mask:0xf bank_mask:0xf
  v_mul_f32_dpp v61, v24, v61 quad_perm:[1,1,1,1] row_mask:0xf bank_mask:0xf
  v_mul_f32_dpp v62, v24, v62 quad_perm:[2,2,2,2] row_mask:0xf bank_mask:0xf
  v_mul_f32_dpp v63, v24, v63 quad_perm:[3,3,3,3] row_mask:0xf bank_mask:0xf
  v_mul_f32_dpp v64, v24, v64 quad_perm:[0,0,0,0] row_mask:0xf bank_mask:0xf
  v_mul_f32_dpp v65, v24, v65 quad_perm:[1,1,1,1] row_mask:0xf bank_mask:0xf
  v_mul_f32_dpp v66, v24, v66 quad_perm:[2,2,2,2] row_mask:0xf bank_mask:0xf
  v_mul_f32_dpp v67, v24, v67 quad_perm:[3,3,3,3] row_mask:0xf bank_mask:0xf
  v_mul_f32_dpp v68, v24, v68 quad_perm:[0,0,0,0] row_mask:0xf bank_mask:0xf
  v_mul_f32_dpp v69, v24, v69 quad_perm:[1,1,1,1] row_mask:0xf bank_mask:0xf
  v_mul_f32_dpp v70, v24, v70 quad_perm:[2,2,2,2] row_mask:0xf bank_mask:0xf
  v_mul_f32_dpp v71, v24, v71 quad_perm:[3,3,3,3] row_mask:0xf bank_mask:0xf
  v_mul_f32_dpp v72, v24, v72 quad_perm:[0,0,0,0] row_mask:0xf bank_mask:0xf
  v_mul_f32_dpp v73, v24, v73 quad_perm:[1,1,1,1] row_mask:0xf bank_mask:0xf
  v_mul_f32_dpp v74, v24, v74 quad_perm:[2,2,2,2] row_mask:0xf bank_mask:0xf
  v_mul_f32_dpp v75, v24, v75 quad_perm:[3,3,3,3] row_mask:0xf bank_mask:0xf
  v_mul_f32_dpp v76, v24, v76 quad_perm:[0,0,0,0] row_mask:0xf bank_mask:0xf
  v_mul_f32_dpp v77, v24, v77 quad_perm:[1,1,1,1] row_mask:0xf bank_mask:0xf
  v_mul_f32_dpp v78, v24, v78 quad_perm:[2,2,2,2] row_mask:0xf bank_mask:0xf
  v_mul_f32_dpp v79, v24, v79 quad_perm:[3,3,3,3] row_mask:0xf bank_mask:0xf
  s_waitcnt lgkmcnt(0)
  v_mfma_f32_16x16x32_bf16 v[48:51], v[120:123], v[80:83], v[48:51]
  v_mfma_f32_16x16x32_bf16 v[52:55], v[120:123], v[84:87], v[52:55]
  v_mfma_f32_16x16x32_bf16 v[56:59], v[120:123], v[88:91], v[56:59]
  v_mfma_f32_16x16x32_bf16 v[60:63], v[120:123], v[92:95], v[60:63]
  v_mfma_f32_16x16x32_bf16 v[64:67], v[120:123], v[96:99], v[64:67]
  v_mfma_f32_16x16x32_bf16 v[68:71], v[120:123], v[100:103], v[68:71]
  v_mfma_f32_16x16x32_bf16 v[72:75], v[120:123], v[104:107], v[72:75]
  v_mfma_f32_16x16x32_bf16 v[76:79], v[120:123], v[108:111], v[76:79]
  s_waitcnt vmcnt(8)
  ds_read_b128 v[80:83], v10 offset:0
  ds_read_b128 v[84:87], v11 offset:0
  ds_read_b128 v[88:91], v12 offset:0
  ds_read_b128 v[92:95], v13 offset:0
  ds_read_b128 v[96:99], v10 offset:4096
  ds_read_b128 v[100:103], v11 offset:4096
  ds_read_b128 v[104:107], v12 offset:4096
  ds_read_b128 v[108:111], v13 offset:4096
  s_waitcnt lgkmcnt(0)
  v_mfma_f32_16x16x32_bf16 v[112:115], v[80:83], v[32:35], 0
  v_mfma_f32_16x16x32_bf16 v[112:115], v[84:87], v[36:39], v[112:115]
  v_mfma_f32_16x16x32_bf16 v[112:115], v[88:91], v[40:43], v[112:115]
  v_mfma_f32_16x16x32_bf16 v[112:115], v[92:95], v[44:47], v[112:115]
  v_mfma_f32_16x16x32_bf16 v[116:119], v[96:99], v[32:35], 0
  v_mfma_f32_16x16x32_bf16 v[116:119], v[100:103], v[36:39], v[116:119]
  v_mfma_f32_16x16x32_bf16 v[116:119], v[104:107], v[40:43], v[116:119]
  v_mfma_f32_16x16x32_bf16 v[116:119], v[108:111], v[44:47], v[116:119]
  s_waitcnt vmcnt(0)
  ds_read_b64_tr_b16 v[80:81], v14 offset:8192
  ds_read_b64_tr_b16 v[84:85], v15 offset:8192
  ds_read_b64_tr_b16 v[88:89], v16 offset:8192
  ds_read_b64_tr_b16 v[92:93], v17 offset:8192
  ds_read_b64_tr_b16 v[96:97], v18 offset:8192
  ds_read_b64_tr_b16 v[100:101], v19 offset:8192
  ds_read_b64_tr_b16 v[104:105], v20 offset:8192
  ds_read_b64_tr_b16 v[108:109], v21 offset:8192
  ds_read_b64_tr_b16 v[82:83], v14 offset:12288
  ds_read_b64_tr_b16 v[86:87], v15 offset:12288
  ds_read_b64_tr_b16 v[90:91], v16 offset:12288
  ds_read_b64_tr_b16 v[94:95], v17 offset:12288
  ds_read_b64_tr_b16 v[98:99], v18 offset:12288
  ds_read_b64_tr_b16 v[102:103], v19 offset:12288
  ds_read_b64_tr_b16 v[106:107], v20 offset:12288
  ds_read_b64_tr_b16 v[110:111], v21 offset:12288
  v_cvt_pk_bf16_f32 v120, v112, v113
  v_cvt_pk_bf16_f32 v121, v114, v115
  v_cvt_pk_bf16_f32 v122, v116, v117
  v_cvt_pk_bf16_f32 v123, v118, v119
  v_lshlrev_b32 v112, 16, v120
  v_and_b32 v113, 0xffff0000, v120
  v_lshlrev_b32 v114, 16, v121
  v_and_b32 v115, 0xffff0000, v121
  v_lshlrev_b32 v116, 16, v122
  v_and_b32 v117, 0xffff0000, v122
  v_lshlrev_b32 v118, 16, v123
  v_and_b32 v119, 0xffff0000, v123
  v_mul_f32 v112, s58, v112
  v_mul_f32 v113, s58, v113
  v_mul_f32 v114, s58, v114
  v_mul_f32 v115, s58, v115
  v_mul_f32 v116, s58, v116
  v_mul_f32 v117, s58, v117
  v_mul_f32 v118, s58, v118
  v_mul_f32 v119, s58, v119
  v_cvt_pk_bf16_f32 v120, v112, v113
  v_cvt_pk_bf16_f32 v121, v114, v115
  v_cvt_pk_bf16_f32 v122, v116, v117
  v_cvt_pk_bf16_f32 v123, v118, v119
  v_lshlrev_b32 v112, 16, v120
  v_and_b32 v113, 0xffff0000, v120
  v_lshlrev_b32 v114, 16, v121
  v_and_b32 v115, 0xffff0000, v121
  v_lshlrev_b32 v116, 16, v122
  v_and_b32 v117, 0xffff0000, v122
  v_lshlrev_b32 v118, 16, v123
  v_and_b32 v119, 0xffff0000, v123
  v_max3_f32 v124, v112, v113, v114
  v_max3_f32 v125, v115, v116, v117
  v_max3_f32 v124, v124, v118, v119
  v_max_f32 v124, v124, v125
  v_mov_b32 v125, v124
  s_nop 1
  v_permlane16_swap_b32 v124, v125
  v_max_f32 v124, v124, v125
  v_mov_b32 v125, v124
  s_nop 1
  v_permlane32_swap_b32 v124, v125
  v_max_f32 v124, v124, v125
  v_mul_f32 v124, s62, v124
  v_max_f32 v124, v124, v22
  v_sub_f32 v24, v22, v124
  v_exp_f32 v24, v24
  v_mov_b32 v22, v124
  v_fma_f32 v112, v112, s62, -v22
  v_fma_f32 v113, v113, s62, -v22
  v_fma_f32 v114, v114, s62, -v22
  v_fma_f32 v115, v115, s62, -v22
  v_fma_f32 v116, v116, s62, -v22
  v_fma_f32 v117, v117, s62, -v22
  v_fma_f32 v118, v118, s62, -v22
  v_fma_f32 v119, v119, s62, -v22
  v_exp_f32 v112, v112
  v_exp_f32 v113, v113
  v_exp_f32 v114, v114
  v_exp_f32 v115, v115
  v_exp_f32 v116, v116
  v_exp_f32 v117, v117
  v_exp_f32 v118, v118
  v_exp_f32 v119, v119
  v_mul_f32 v23, v23, v24
  v_cvt_pk_bf16_f32 v120, v112, v113
  v_cvt_pk_bf16_f32 v121, v114, v115
  v_cvt_pk_bf16_f32 v122, v116, v117
  v_cvt_pk_bf16_f32 v123, v118, v119
  v_add_f32 v124, v112, v113
  v_add_f32 v125, v114, v115
  v_add_f32 v124, v124, v116
  v_add_f32 v125, v125, v117
  v_add_f32 v124, v124, v118
  v_add_f32 v125, v125, v119
  v_add_f32 v124, v124, v125
  v_add_f32 v23, v23, v124
  v_mul_f32_dpp v48, v24, v48 quad_perm:[0,0,0,0] row_mask:0xf bank_mask:0xf
  v_mul_f32_dpp v49, v24, v49 quad_perm:[1,1,1,1] row_mask:0xf bank_mask:0xf
  v_mul_f32_dpp v50, v24, v50 quad_perm:[2,2,2,2] row_mask:0xf bank_mask:0xf
  v_mul_f32_dpp v51, v24, v51 quad_perm:[3,3,3,3] row_mask:0xf bank_mask:0xf
  v_mul_f32_dpp v52, v24, v52 quad_perm:[0,0,0,0] row_mask:0xf bank_mask:0xf
  v_mul_f32_dpp v53, v24, v53 quad_perm:[1,1,1,1] row_mask:0xf bank_mask:0xf
  v_mul_f32_dpp v54, v24, v54 quad_perm:[2,2,2,2] row_mask:0xf bank_mask:0xf
  v_mul_f32_dpp v55, v24, v55 quad_perm:[3,3,3,3] row_mask:0xf bank_mask:0xf
  v_mul_f32_dpp v56, v24, v56 quad_perm:[0,0,0,0] row_mask:0xf bank_mask:0xf
  v_mul_f32_dpp v57, v24, v57 quad_perm:[1,1,1,1] row_mask:0xf bank_mask:0xf
  v_mul_f32_dpp v58, v24, v58 quad_perm:[2,2,2,2] row_mask:0xf bank_mask:0xf
  v_mul_f32_dpp v59, v24, v59 quad_perm:[3,3,3,3] row_mask:0xf bank_mask:0xf
  v_mul_f32_dpp v60, v24, v60 quad_perm:[0,0,0,0] row_mask:0xf bank_mask:0xf
  v_mul_f32_dpp v61, v24, v61 quad_perm:[1,1,1,1] row_mask:0xf bank_mask:0xf
  v_mul_f32_dpp v62, v24, v62 quad_perm:[2,2,2,2] row_mask:0xf bank_mask:0xf
  v_mul_f32_dpp v63, v24, v63 quad_perm:[3,3,3,3] row_mask:0xf bank_mask:0xf
  v_mul_f32_dpp v64, v24, v64 quad_perm:[0,0,0,0] row_mask:0xf bank_mask:0xf
  v_mul_f32_dpp v65, v24, v65 quad_perm:[1,1,1,1] row_mask:0xf bank_mask:0xf
  v_mul_f32_dpp v66, v24, v66 quad_perm:[2,2,2,2] row_mask:0xf bank_mask:0xf
  v_mul_f32_dpp v67, v24, v67 quad_perm:[3,3,3,3] row_mask:0xf bank_mask:0xf
  v_mul_f32_dpp v68, v24, v68 quad_perm:[0,0,0,0] row_mask:0xf bank_mask:0xf
  v_mul_f32_dpp v69, v24, v69 quad_perm:[1,1,1,1] row_mask:0xf bank_mask:0xf
  v_mul_f32_dpp v70, v24, v70 quad_perm:[2,2,2,2] row_mask:0xf bank_mask:0xf
  v_mul_f32_dpp v71, v24, v71 quad_perm:[3,3,3,3] row_mask:0xf bank_mask:0xf
  v_mul_f32_dpp v72, v24, v72 quad_perm:[0,0,0,0] row_mask:0xf bank_mask:0xf
  v_mul_f32_dpp v73, v24, v73 quad_perm:[1,1,1,1] row_mask:0xf bank_mask:0xf
  v_mul_f32_dpp v74, v24, v74 quad_perm:[2,2,2,2] row_mask:0xf bank_mask:0xf
  v_mul_f32_dpp v75, v24, v75 quad_perm:[3,3,3,3] row_mask:0xf bank_mask:0xf
  v_mul_f32_dpp v76, v24, v76 quad_perm:[0,0,0,0] row_mask:0xf bank_mask:0xf
  v_mul_f32_dpp v77, v24, v77 quad_perm:[1,1,1,1] row_mask:0xf bank_mask:0xf
  v_mul_f32_dpp v78, v24, v78 quad_perm:[2,2,2,2] row_mask:0xf bank_mask:0xf
  v_mul_f32_dpp v79, v24, v79 quad_perm:[3,3,3,3] row_mask:0xf bank_mask:0xf
  s_waitcnt lgkmcnt(0)
  v_mfma_f32_16x16x32_bf16 v[48:51], v[120:123], v[80:83], v[48:51]
  v_mfma_f32_16x16x32_bf16 v[52:55], v[120:123], v[84:87], v[52:55]
  v_mfma_f32_16x16x32_bf16 v[56:59], v[120:123], v[88:91], v[56:59]
  v_mfma_f32_16x16x32_bf16 v[60:63], v[120:123], v[92:95], v[60:63]
  v_mfma_f32_16x16x32_bf16 v[64:67], v[120:123], v[96:99], v[64:67]
  v_mfma_f32_16x16x32_bf16 v[68:71], v[120:123], v[100:103], v[68:71]
  v_mfma_f32_16x16x32_bf16 v[72:75], v[120:123], v[104:107], v[72:75]
  v_mfma_f32_16x16x32_bf16 v[76:79], v[120:123], v[108:111], v[76:79]
  s_nop 7
  s_branch L_ddone_46
L_dt1_45:
  v_mfma_f32_16x16x32_bf16 v[112:115], v[80:83], v[32:35], 0
  v_mfma_f32_16x16x32_bf16 v[112:115], v[84:87], v[36:39], v[112:115]
  v_mfma_f32_16x16x32_bf16 v[112:115], v[88:91], v[40:43], v[112:115]
  v_mfma_f32_16x16x32_bf16 v[112:115], v[92:95], v[44:47], v[112:115]
  v_mfma_f32_16x16x32_bf16 v[116:119], v[96:99], v[32:35], 0
  v_mfma_f32_16x16x32_bf16 v[116:119], v[100:103], v[36:39], v[116:119]
  v_mfma_f32_16x16x32_bf16 v[116:119], v[104:107], v[40:43], v[116:119]
  v_mfma_f32_16x16x32_bf16 v[116:119], v[108:111], v[44:47], v[116:119]
  s_waitcnt vmcnt(16)
  ds_read_b64_tr_b16 v[80:81], v14 offset:8192
  ds_read_b64_tr_b16 v[84:85], v15 offset:8192
  ds_read_b64_tr_b16 v[88:89], v16 offset:8192
  ds_read_b64_tr_b16 v[92:93], v17 offset:8192
  ds_read_b64_tr_b16 v[96:97], v18 offset:8192
  ds_read_b64_tr_b16 v[100:101], v19 offset:8192
  ds_read_b64_tr_b16 v[104:105], v20 offset:8192
  ds_read_b64_tr_b16 v[108:109], v21 offset:8192
  ds_read_b64_tr_b16 v[82:83], v14 offset:12288
  ds_read_b64_tr_b16 v[86:87], v15 offset:12288
  ds_read_b64_tr_b16 v[90:91], v16 offset:12288
  ds_read_b64_tr_b16 v[94:95], v17 offset:12288
  ds_read_b64_tr_b16 v[98:99], v18 offset:12288
  ds_read_b64_tr_b16 v[102:103], v19 offset:12288
  ds_read_b64_tr_b16 v[106:107], v20 offset:12288
  ds_read_b64_tr_b16 v[110:111], v21 offset:12288
  v_cvt_pk_bf16_f32 v120, v112, v113
  v_cvt_pk_bf16_f32 v121, v114, v115
  v_cvt_pk_bf16_f32 v122, v116, v117
  v_cvt_pk_bf16_f32 v123, v118, v119
  v_lshlrev_b32 v112, 16, v120
  v_and_b32 v113, 0xffff0000, v120
  v_lshlrev_b32 v114, 16, v121
  v_and_b32 v115, 0xffff0000, v121
  v_lshlrev_b32 v116, 16, v122
  v_and_b32 v117, 0xffff0000, v122
  v_lshlrev_b32 v118, 16, v123
  v_and_b32 v119, 0xffff0000, v123
  v_mul_f32 v112, s58, v112
  v_mul_f32 v113, s58, v113
  v_mul_f32 v114, s58, v114
  v_mul_f32 v115, s58, v115
  v_mul_f32 v116, s58, v116
  v_mul_f32 v117, s58, v117
  v_mul_f32 v118, s58, v118
  v_mul_f32 v119, s58, v119
  v_cvt_pk_bf16_f32 v120, v112, v113
  v_cvt_pk_bf16_f32 v121, v114, v115
  v_cvt_pk_bf16_f32 v122, v116, v117
  v_cvt_pk_bf16_f32 v123, v118, v119
  v_lshlrev_b32 v112, 16, v120
  v_and_b32 v113, 0xffff0000, v120
  v_lshlrev_b32 v114, 16, v121
  v_and_b32 v115, 0xffff0000, v121
  v_lshlrev_b32 v116, 16, v122
  v_and_b32 v117, 0xffff0000, v122
  v_lshlrev_b32 v118, 16, v123
  v_and_b32 v119, 0xffff0000, v123
  v_max3_f32 v124, v112, v113, v114
  v_max3_f32 v125, v115, v116, v117
  v_max3_f32 v124, v124, v118, v119
  v_max_f32 v124, v124, v125
  v_mov_b32 v125, v124
  s_nop 1
  v_permlane16_swap_b32 v124, v125
  v_max_f32 v124, v124, v125
  v_mov_b32 v125, v124
  s_nop 1
  v_permlane32_swap_b32 v124, v125
  v_max_f32 v124, v124, v125
  v_mul_f32 v124, s62, v124
  v_max_f32 v124, v124, v22
  v_sub_f32 v24, v22, v124
  v_exp_f32 v24, v24
  v_mov_b32 v22, v124
  v_fma_f32 v112, v112, s62, -v22
  v_fma_f32 v113, v113, s62, -v22
  v_fma_f32 v114, v114, s62, -v22
  v_fma_f32 v115, v115, s62, -v22
  v_fma_f32 v116, v116, s62, -v22
  v_fma_f32 v117, v117, s62, -v22
  v_fma_f32 v118, v118, s62, -v22
  v_fma_f32 v119, v119, s62, -v22
  v_exp_f32 v112, v112
  v_exp_f32 v113, v113
  v_exp_f32 v114, v114
  v_exp_f32 v115, v115
  v_exp_f32 v116, v116
  v_exp_f32 v117, v117
  v_exp_f32 v118, v118
  v_exp_f32 v119, v119
  v_mul_f32 v23, v23, v24
  v_cvt_pk_bf16_f32 v120, v112, v113
  v_cvt_pk_bf16_f32 v121, v114, v115
  v_cvt_pk_bf16_f32 v122, v116, v117
  v_cvt_pk_bf16_f32 v123, v118, v119
  v_add_f32 v124, v112, v113
  v_add_f32 v125, v114, v115
  v_add_f32 v124, v124, v116
  v_add_f32 v125, v125, v117
  v_add_f32 v124, v124, v118
  v_add_f32 v125, v125, v119
  v_add_f32 v124, v124, v125
  v_add_f32 v23, v23, v124
  v_mul_f32_dpp v48, v24, v48 quad_perm:[0,0,0,0] row_mask:0xf bank_mask:0xf
  v_mul_f32_dpp v49, v24, v49 quad_perm:[1,1,1,1] row_mask:0xf bank_mask:0xf
  v_mul_f32_dpp v50, v24, v50 quad_perm:[2,2,2,2] row_mask:0xf bank_mask:0xf
  v_mul_f32_dpp v51, v24, v51 quad_perm:[3,3,3,3] row_mask:0xf bank_mask:0xf
  v_mul_f32_dpp v52, v24, v52 quad_perm:[0,0,0,0] row_mask:0xf bank_mask:0xf
  v_mul_f32_dpp v53, v24, v53 quad_perm:[1,1,1,1] row_mask:0xf bank_mask:0xf
  v_mul_f32_dpp v54, v24, v54 quad_perm:[2,2,2,2] row_mask:0xf bank_mask:0xf
  v_mul_f32_dpp v55, v24, v55 quad_perm:[3,3,3,3] row_mask:0xf bank_mask:0xf
  v_mul_f32_dpp v56, v24, v56 quad_perm:[0,0,0,0] row_mask:0xf bank_mask:0xf
  v_mul_f32_dpp v57, v24, v57 quad_perm:[1,1,1,1] row_mask:0xf bank_mask:0xf
  v_mul_f32_dpp v58, v24, v58 quad_perm:[2,2,2,2] row_mask:0xf bank_mask:0xf
  v_mul_f32_dpp v59, v24, v59 quad_perm:[3,3,3,3] row_mask:0xf bank_mask:0xf
  v_mul_f32_dpp v60, v24, v60 quad_perm:[0,0,0,0] row_mask:0xf bank_mask:0xf
  v_mul_f32_dpp v61, v24, v61 quad_perm:[1,1,1,1] row_mask:0xf bank_mask:0xf
  v_mul_f32_dpp v62, v24, v62 quad_perm:[2,2,2,2] row_mask:0xf bank_mask:0xf
  v_mul_f32_dpp v63, v24, v63 quad_perm:[3,3,3,3] row_mask:0xf bank_mask:0xf
  v_mul_f32_dpp v64, v24, v64 quad_perm:[0,0,0,0] row_mask:0xf bank_mask:0xf
  v_mul_f32_dpp v65, v24, v65 quad_perm:[1,1,1,1] row_mask:0xf bank_mask:0xf
  v_mul_f32_dpp v66, v24, v66 quad_perm:[2,2,2,2] row_mask:0xf bank_mask:0xf
  v_mul_f32_dpp v67, v24, v67 quad_perm:[3,3,3,3] row_mask:0xf bank_mask:0xf
  v_mul_f32_dpp v68, v24, v68 quad_perm:[0,0,0,0] row_mask:0xf bank_mask:0xf
  v_mul_f32_dpp v69, v24, v69 quad_perm:[1,1,1,1] row_mask:0xf bank_mask:0xf
  v_mul_f32_dpp v70, v24, v70 quad_perm:[2,2,2,2] row_mask:0xf bank_mask:0xf
  v_mul_f32_dpp v71, v24, v71 quad_perm:[3,3,3,3] row_mask:0xf bank_mask:0xf
  v_mul_f32_dpp v72, v24, v72 quad_perm:[0,0,0,0] row_mask:0xf bank_mask:0xf
  v_mul_f32_dpp v73, v24, v73 quad_perm:[1,1,1,1] row_mask:0xf bank_mask:0xf
  v_mul_f32_dpp v74, v24, v74 quad_perm:[2,2,2,2] row_mask:0xf bank_mask:0xf
  v_mul_f32_dpp v75, v24, v75 quad_perm:[3,3,3,3] row_mask:0xf bank_mask:0xf
  v_mul_f32_dpp v76, v24, v76 quad_perm:[0,0,0,0] row_mask:0xf bank_mask:0xf
  v_mul_f32_dpp v77, v24, v77 quad_perm:[1,1,1,1] row_mask:0xf bank_mask:0xf
  v_mul_f32_dpp v78, v24, v78 quad_perm:[2,2,2,2] row_mask:0xf bank_mask:0xf
  v_mul_f32_dpp v79, v24, v79 quad_perm:[3,3,3,3] row_mask:0xf bank_mask:0xf
  s_waitcnt lgkmcnt(0)
  v_mfma_f32_16x16x32_bf16 v[48:51], v[120:123], v[80:83], v[48:51]
  v_mfma_f32_16x16x32_bf16 v[52:55], v[120:123], v[84:87], v[52:55]
  v_mfma_f32_16x16x32_bf16 v[56:59], v[120:123], v[88:91], v[56:59]
  v_mfma_f32_16x16x32_bf16 v[60:63], v[120:123], v[92:95], v[60:63]
  v_mfma_f32_16x16x32_bf16 v[64:67], v[120:123], v[96:99], v[64:67]
  v_mfma_f32_16x16x32_bf16 v[68:71], v[120:123], v[100:103], v[68:71]
  v_mfma_f32_16x16x32_bf16 v[72:75], v[120:123], v[104:107], v[72:75]
  v_mfma_f32_16x16x32_bf16 v[76:79], v[120:123], v[108:111], v[76:79]
  s_waitcnt vmcnt(8)
  ds_read_b128 v[80:83], v10 offset:16384
  ds_read_b128 v[84:87], v11 offset:16384
  ds_read_b128 v[88:91], v12 offset:16384
  ds_read_b128 v[92:95], v13 offset:16384
  ds_read_b128 v[96:99], v10 offset:20480
  ds_read_b128 v[100:103], v11 offset:20480
  ds_read_b128 v[104:107], v12 offset:20480
  ds_read_b128 v[108:111], v13 offset:20480
  s_waitcnt lgkmcnt(0)
  v_mfma_f32_16x16x32_bf16 v[112:115], v[80:83], v[32:35], 0
  v_mfma_f32_16x16x32_bf16 v[112:115], v[84:87], v[36:39], v[112:115]
  v_mfma_f32_16x16x32_bf16 v[112:115], v[88:91], v[40:43], v[112:115]
  v_mfma_f32_16x16x32_bf16 v[112:115], v[92:95], v[44:47], v[112:115]
  v_mfma_f32_16x16x32_bf16 v[116:119], v[96:99], v[32:35], 0
  v_mfma_f32_16x16x32_bf16 v[116:119], v[100:103], v[36:39], v[116:119]
  v_mfma_f32_16x16x32_bf16 v[116:119], v[104:107], v[40:43], v[116:119]
  v_mfma_f32_16x16x32_bf16 v[116:119], v[108:111], v[44:47], v[116:119]
  s_waitcnt vmcnt(0)
  ds_read_b64_tr_b16 v[80:81], v14 offset:24576
  ds_read_b64_tr_b16 v[84:85], v15 offset:24576
  ds_read_b64_tr_b16 v[88:89], v16 offset:24576
  ds_read_b64_tr_b16 v[92:93], v17 offset:24576
  ds_read_b64_tr_b16 v[96:97], v18 offset:24576
  ds_read_b64_tr_b16 v[100:101], v19 offset:24576
  ds_read_b64_tr_b16 v[104:105], v20 offset:24576
  ds_read_b64_tr_b16 v[108:109], v21 offset:24576
  ds_read_b64_tr_b16 v[82:83], v14 offset:28672
  ds_read_b64_tr_b16 v[86:87], v15 offset:28672
  ds_read_b64_tr_b16 v[90:91], v16 offset:28672
  ds_read_b64_tr_b16 v[94:95], v17 offset:28672
  ds_read_b64_tr_b16 v[98:99], v18 offset:28672
  ds_read_b64_tr_b16 v[102:103], v19 offset:28672
  ds_read_b64_tr_b16 v[106:107], v20 offset:28672
  ds_read_b64_tr_b16 v[110:111], v21 offset:28672
  v_cvt_pk_bf16_f32 v120, v112, v113
  v_cvt_pk_bf16_f32 v121, v114, v115
  v_cvt_pk_bf16_f32 v122, v116, v117
  v_cvt_pk_bf16_f32 v123, v118, v119
  v_lshlrev_b32 v112, 16, v120
  v_and_b32 v113, 0xffff0000, v120
  v_lshlrev_b32 v114, 16, v121
  v_and_b32 v115, 0xffff0000, v121
  v_lshlrev_b32 v116, 16, v122
  v_and_b32 v117, 0xffff0000, v122
  v_lshlrev_b32 v118, 16, v123
  v_and_b32 v119, 0xffff0000, v123
  v_mul_f32 v112, s58, v112
  v_mul_f32 v113, s58, v113
  v_mul_f32 v114, s58, v114
  v_mul_f32 v115, s58, v115
  v_mul_f32 v116, s58, v116
  v_mul_f32 v117, s58, v117
  v_mul_f32 v118, s58, v118
  v_mul_f32 v119, s58, v119
  v_cvt_pk_bf16_f32 v120, v112, v113
  v_cvt_pk_bf16_f32 v121, v114, v115
  v_cvt_pk_bf16_f32 v122, v116, v117
  v_cvt_pk_bf16_f32 v123, v118, v119
  v_lshlrev_b32 v112, 16, v120
  v_and_b32 v113, 0xffff0000, v120
  v_lshlrev_b32 v114, 16, v121
  v_and_b32 v115, 0xffff0000, v121
  v_lshlrev_b32 v116, 16, v122
  v_and_b32 v117, 0xffff0000, v122
  v_lshlrev_b32 v118, 16, v123
  v_and_b32 v119, 0xffff0000, v123
  v_max3_f32 v124, v112, v113, v114
  v_max3_f32 v125, v115, v116, v117
  v_max3_f32 v124, v124, v118, v119
  v_max_f32 v124, v124, v125
  v_mov_b32 v125, v124
  s_nop 1
  v_permlane16_swap_b32 v124, v125
  v_max_f32 v124, v124, v125
  v_mov_b32 v125, v124
  s_nop 1
  v_permlane32_swap_b32 v124, v125
  v_max_f32 v124, v124, v125
  v_mul_f32 v124, s62, v124
  v_max_f32 v124, v124, v22
  v_sub_f32 v24, v22, v124
  v_exp_f32 v24, v24
  v_mov_b32 v22, v124
  v_fma_f32 v112, v112, s62, -v22
  v_fma_f32 v113, v113, s62, -v22
  v_fma_f32 v114, v114, s62, -v22
  v_fma_f32 v115, v115, s62, -v22
  v_fma_f32 v116, v116, s62, -v22
  v_fma_f32 v117, v117, s62, -v22
  v_fma_f32 v118, v118, s62, -v22
  v_fma_f32 v119, v119, s62, -v22
  v_exp_f32 v112, v112
  v_exp_f32 v113, v113
  v_exp_f32 v114, v114
  v_exp_f32 v115, v115
  v_exp_f32 v116, v116
  v_exp_f32 v117, v117
  v_exp_f32 v118, v118
  v_exp_f32 v119, v119
  v_mul_f32 v23, v23, v24
  v_cvt_pk_bf16_f32 v120, v112, v113
  v_cvt_pk_bf16_f32 v121, v114, v115
  v_cvt_pk_bf16_f32 v122, v116, v117
  v_cvt_pk_bf16_f32 v123, v118, v119
  v_add_f32 v124, v112, v113
  v_add_f32 v125, v114, v115
  v_add_f32 v124, v124, v116
  v_add_f32 v125, v125, v117
  v_add_f32 v124, v124, v118
  v_add_f32 v125, v125, v119
  v_add_f32 v124, v124, v125
  v_add_f32 v23, v23, v124
  v_mul_f32_dpp v48, v24, v48 quad_perm:[0,0,0,0] row_mask:0xf bank_mask:0xf
  v_mul_f32_dpp v49, v24, v49 quad_perm:[1,1,1,1] row_mask:0xf bank_mask:0xf
  v_mul_f32_dpp v50, v24, v50 quad_perm:[2,2,2,2] row_mask:0xf bank_mask:0xf
  v_mul_f32_dpp v51, v24, v51 quad_perm:[3,3,3,3] row_mask:0xf bank_mask:0xf
  v_mul_f32_dpp v52, v24, v52 quad_perm:[0,0,0,0] row_mask:0xf bank_mask:0xf
  v_mul_f32_dpp v53, v24, v53 quad_perm:[1,1,1,1] row_mask:0xf bank_mask:0xf
  v_mul_f32_dpp v54, v24, v54 quad_perm:[2,2,2,2] row_mask:0xf bank_mask:0xf
  v_mul_f32_dpp v55, v24, v55 quad_perm:[3,3,3,3] row_mask:0xf bank_mask:0xf
  v_mul_f32_dpp v56, v24, v56 quad_perm:[0,0,0,0] row_mask:0xf bank_mask:0xf
  v_mul_f32_dpp v57, v24, v57 quad_perm:[1,1,1,1] row_mask:0xf bank_mask:0xf
  v_mul_f32_dpp v58, v24, v58 quad_perm:[2,2,2,2] row_mask:0xf bank_mask:0xf
  v_mul_f32_dpp v59, v24, v59 quad_perm:[3,3,3,3] row_mask:0xf bank_mask:0xf
  v_mul_f32_dpp v60, v24, v60 quad_perm:[0,0,0,0] row_mask:0xf bank_mask:0xf
  v_mul_f32_dpp v61, v24, v61 quad_perm:[1,1,1,1] row_mask:0xf bank_mask:0xf
  v_mul_f32_dpp v62, v24, v62 quad_perm:[2,2,2,2] row_mask:0xf bank_mask:0xf
  v_mul_f32_dpp v63, v24, v63 quad_perm:[3,3,3,3] row_mask:0xf bank_mask:0xf
  v_mul_f32_dpp v64, v24, v64 quad_perm:[0,0,0,0] row_mask:0xf bank_mask:0xf
  v_mul_f32_dpp v65, v24, v65 quad_perm:[1,1,1,1] row_mask:0xf bank_mask:0xf
  v_mul_f32_dpp v66, v24, v66 quad_perm:[2,2,2,2] row_mask:0xf bank_mask:0xf
  v_mul_f32_dpp v67, v24, v67 quad_perm:[3,3,3,3] row_mask:0xf bank_mask:0xf
  v_mul_f32_dpp v68, v24, v68 quad_perm:[0,0,0,0] row_mask:0xf bank_mask:0xf
  v_mul_f32_dpp v69, v24, v69 quad_perm:[1,1,1,1] row_mask:0xf bank_mask:0xf
  v_mul_f32_dpp v70, v24, v70 quad_perm:[2,2,2,2] row_mask:0xf bank_mask:0xf
  v_mul_f32_dpp v71, v24, v71 quad_perm:[3,3,3,3] row_mask:0xf bank_mask:0xf
  v_mul_f32_dpp v72, v24, v72 quad_perm:[0,0,0,0] row_mask:0xf bank_mask:0xf
  v_mul_f32_dpp v73, v24, v73 quad_perm:[1,1,1,1] row_mask:0xf bank_mask:0xf
  v_mul_f32_dpp v74, v24, v74 quad_perm:[2,2,2,2] row_mask:0xf bank_mask:0xf
  v_mul_f32_dpp v75, v24, v75 quad_perm:[3,3,3,3] row_mask:0xf bank_mask:0xf
  v_mul_f32_dpp v76, v24, v76 quad_perm:[0,0,0,0] row_mask:0xf bank_mask:0xf
  v_mul_f32_dpp v77, v24, v77 quad_perm:[1,1,1,1] row_mask:0xf bank_mask:0xf
  v_mul_f32_dpp v78, v24, v78 quad_perm:[2,2,2,2] row_mask:0xf bank_mask:0xf
  v_mul_f32_dpp v79, v24, v79 quad_perm:[3,3,3,3] row_mask:0xf bank_mask:0xf
  s_waitcnt lgkmcnt(0)
  v_mfma_f32_16x16x32_bf16 v[48:51], v[120:123], v[80:83], v[48:51]
  v_mfma_f32_16x16x32_bf16 v[52:55], v[120:123], v[84:87], v[52:55]
  v_mfma_f32_16x16x32_bf16 v[56:59], v[120:123], v[88:91], v[56:59]
  v_mfma_f32_16x16x32_bf16 v[60:63], v[120:123], v[92:95], v[60:63]
  v_mfma_f32_16x16x32_bf16 v[64:67], v[120:123], v[96:99], v[64:67]
  v_mfma_f32_16x16x32_bf16 v[68:71], v[120:123], v[100:103], v[68:71]
  v_mfma_f32_16x16x32_bf16 v[72:75], v[120:123], v[104:107], v[72:75]
  v_mfma_f32_16x16x32_bf16 v[76:79], v[120:123], v[108:111], v[76:79]
  s_nop 7
L_ddone_46:
  v_mov_b32 v124, v23
  s_nop 1
  v_permlane16_swap_b32 v23, v124
  v_add_f32 v23, v23, v124
  v_mov_b32 v124, v23
  s_nop 1
  v_permlane32_swap_b32 v23, v124
  v_add_f32 v23, v23, v124
  s_lshl_b32 s31, s3, 11
  v_lshl_add_u32 v124, v2, 4, s31
  ds_write_b128 v124, v[48:51] offset:0
  ds_write_b128 v124, v[52:55] offset:256
  ds_write_b128 v124, v[56:59] offset:512
  ds_write_b128 v124, v[60:63] offset:768
  ds_write_b128 v124, v[64:67] offset:1024
  ds_write_b128 v124, v[68:71] offset:1280
  ds_write_b128 v124, v[72:75] offset:1536
  ds_write_b128 v124, v[76:79] offset:1792
  v_and_b32 v125, 3, v2
  s_lshl_b32 s31, s3, 5
  v_lshl_add_u32 v125, v125, 3, s31
  ds_write_b64 v125, v[22:23] offset:8192
  s_waitcnt lgkmcnt(0)
  s_barrier
  v_lshrrev_b32 v104, 3, v1
  v_and_b32 v105, 7, v1
  v_lshlrev_b32 v106, 8, v104
  v_lshl_add_u32 v106, v105, 5, v106
  s_lshl_b32 s31, s3, 2
  v_add_u32 v106, s31, v106
  ds_read_b32 v108, v106 offset:0
  ds_read_b32 v109, v106 offset:16
  ds_read_b32 v110, v106 offset:2048
  ds_read_b32 v111, v106 offset:2064
  ds_read_b32 v112, v106 offset:4096
  ds_read_b32 v113, v106 offset:4112
  ds_read_b32 v114, v106 offset:6144
  ds_read_b32 v115, v106 offset:6160
  s_lshl_b32 s31, s3, 3
  v_mov_b32 v107, s31
  ds_read_b64 v[116:117], v107 offset:8192
  ds_read_b64 v[118:119], v107 offset:8224
  ds_read_b64 v[120:121], v107 offset:8256
  ds_read_b64 v[122:123], v107 offset:8288
  s_waitcnt lgkmcnt(0)
  v_max3_f32 v124, v116, v118, v120
  v_max_f32 v124, v124, v122
  v_sub_f32 v116, v116, v124
  v_sub_f32 v118, v118, v124
  v_sub_f32 v120, v120, v124
  v_sub_f32 v122, v122, v124
  v_exp_f32 v116, v116
  v_exp_f32 v118, v118
  v_exp_f32 v120, v120
  v_exp_f32 v122, v122
  v_mul_f32 v125, v116, v117
  v_mul_f32 v126, v116, v108
  v_mul_f32 v127, v116, v109
  v_fmac_f32 v125, v118, v119
  v_fmac_f32 v126, v118, v110
  v_fmac_f32 v127, v118, v111
  v_fmac_f32 v125, v120, v121
  v_fmac_f32 v126, v120, v112
  v_fmac_f32 v127, v120, v113
  v_fmac_f32 v125, v122, v123
  v_fmac_f32 v126, v122, v114
  v_fmac_f32 v127, v122, v115
  v_min_u32 v124, s63, v124
  v_min_u32 v125, s63, v125
  v_min_u32 v126, s63, v126
  v_min_u32 v127, s63, v127
  v_lshlrev_b32 v104, 7, v104
  s_lshl_b32 s31, s3, 10
  s_add_u32 s31, s31, 4096
  v_add_u32 v104, s31, v104
  v_lshl_add_u32 v105, v105, 3, v104
  global_store_dwordx2 v105, v[126:127], s[40:41] sc1
  global_store_dwordx2 v104, v[124:125], s[40:41] offset:64 sc1
  v_lshlrev_b32 v124, 2, v0
  v_add_u32 v124, 49152, v124
  v_lshlrev_b32 v125, 2, v0
  v_add_u32 v125, 86016, v125
  v_lshlrev_b32 v126, 2, v0
  v_add_u32 v126, 122880, v126
  v_lshlrev_b32 v127, 2, v0
  v_add_u32 v127, 159744, v127
  ds_read_b32 v80, v124 offset:0
  ds_read_b32 v81, v124 offset:1024
  ds_read_b32 v82, v124 offset:2048
  ds_read_b32 v83, v124 offset:3072
  ds_read_b32 v84, v125 offset:0
  ds_read_b32 v85, v125 offset:1024
  ds_read_b32 v86, v125 offset:2048
  ds_read_b32 v87, v125 offset:3072
  ds_read_b32 v88, v126 offset:0
  ds_read_b32 v89, v126 offset:1024
  ds_read_b32 v90, v126 offset:2048
  ds_read_b32 v91, v126 offset:3072
  ds_read_b32 v92, v127 offset:0
  ds_read_b32 v93, v127 offset:1024
  ds_read_b32 v94, v127 offset:2048
  ds_read_b32 v95, v127 offset:3072
  s_waitcnt lgkmcnt(0)
  v_perm_b32 v31, v81, v80, s60
  v_perm_b32 v81, v81, v80, s61
  v_mov_b32 v80, v31
  v_perm_b32 v31, v83, v82, s60
  v_perm_b32 v83, v83, v82, s61
  v_mov_b32 v82, v31
  v_perm_b32 v31, v85, v84, s60
  v_perm_b32 v85, v85, v84, s61
  v_mov_b32 v84, v31
  v_perm_b32 v31, v87, v86, s60
  v_perm_b32 v87, v87, v86, s61
  v_mov_b32 v86, v31
  v_perm_b32 v31, v89, v88, s60
  v_perm_b32 v89, v89, v88, s61
  v_mov_b32 v88, v31
  v_perm_b32 v31, v91, v90, s60
  v_perm_b32 v91, v91, v90, s61
  v_mov_b32 v90, v31
  v_perm_b32 v31, v93, v92, s60
  v_perm_b32 v93, v93, v92, s61
  v_mov_b32 v92, v31
  v_perm_b32 v31, v95, v94, s60
  v_perm_b32 v95, v95, v94, s61
  v_mov_b32 v94, v31
  s_cmp_lg_u32 s3, 0
  s_cbranch_scc0 L_if_47
  s_cmp_lt_u32 s2, 224
  s_cbranch_scc0 L_if_48
  s_lshl_b32 s31, s3, 7
  v_lshl_add_u32 v31, v3, 3, s31
  s_movk_i32 s31, 3584
  v_mul_lo_u32 v31, v31, s31
  v_and_b32 v124, 7, v2
  v_lshl_add_u32 v31, v124, 1, v31
  s_lshl_b32 s31, s65, 4
  s_add_u32 s42, s16, s31
  s_addc_u32 s43, s17, 0
  s_mov_b32 exec_lo, 0x00ff00ff
  s_mov_b32 exec_hi, 0x00ff00ff
  global_load_ushort v48, v31, s[42:43]
  s_add_u32 s42, s42, 3584
  s_addc_u32 s43, s43, 0
  global_load_ushort v49, v31, s[42:43]
  s_add_u32 s42, s42, 3584
  s_addc_u32 s43, s43, 0
  global_load_ushort v50, v31, s[42:43]
  s_add_u32 s42, s42, 3584
  s_addc_u32 s43, s43, 0
  global_load_ushort v51, v31, s[42:43]
  s_add_u32 s42, s42, 3584
  s_addc_u32 s43, s43, 0
  global_load_ushort v52, v31, s[42:43]
  s_add_u32 s42, s42, 3584
  s_addc_u32 s43, s43, 0
  global_load_ushort v53, v31, s[42:43]
  s_add_u32 s42, s42, 3584
  s_addc_u32 s43, s43, 0
  global_load_ushort v54, v31, s[42:43]
  s_add_u32 s42, s42, 3584
  s_addc_u32 s43, s43, 0
  global_load_ushort v55, v31, s[42:43]
  s_add_u32 s42, s42, 89600
  s_addc_u32 s43, s43, 0
  global_load_ushort v56, v31, s[42:43]
  s_add_u32 s42, s42, 3584
  s_addc_u32 s43, s43, 0
  global_load_ushort v57, v31, s[42:43]
  s_add_u32 s42, s42, 3584
  s_addc_u32 s43, s43, 0
  global_load_ushort v58, v31, s[42:43]
  s_add_u32 s42, s42, 3584
  s_addc_u32 s43, s43, 0
  global_load_ushort v59, v31, s[42:43]
  s_add_u32 s42, s42, 3584
  s_addc_u32 s43, s43, 0
  global_load_ushort v60, v31, s[42:43]
  s_add_u32 s42, s42, 3584
  s_addc_u32 s43, s43, 0
  global_load_ushort v61, v31, s[42:43]
  s_add_u32 s42, s42, 3584
  s_addc_u32 s43, s43, 0
  global_load_ushort v62, v31, s[42:43]
  s_add_u32 s42, s42, 3584
  s_addc_u32 s43, s43, 0
  global_load_ushort v63, v31, s[42:43]
  s_add_u32 s42, s42, 89600
  s_addc_u32 s43, s43, 0
  global_load_ushort v64, v31, s[42:43]
  s_add_u32 s42, s42, 3584
  s_addc_u32 s43, s43, 0
  global_load_ushort v65, v31, s[42:43]
  s_add_u32 s42, s42, 3584
  s_addc_u32 s43, s43, 0
  global_load_ushort v66, v31, s[42:43]
  s_add_u32 s42, s42, 3584
  s_addc_u32 s43, s43, 0
  global_load_ushort v67, v31, s[42:43]
  s_add_u32 s42, s42, 3584
  s_addc_u32 s43, s43, 0
  global_load_ushort v68, v31, s[42:43]
  s_add_u32 s42, s42, 3584
  s_addc_u32 s43, s43, 0
  global_load_ushort v69, v31, s[42:43]
  s_add_u32 s42, s42, 3584
  s_addc_u32 s43, s43, 0
  global_load_ushort v70, v31, s[42:43]
  s_add_u32 s42, s42, 3584
  s_addc_u32 s43, s43, 0
  global_load_ushort v71, v31, s[42:43]
  s_add_u32 s42, s42, 89600
  s_addc_u32 s43, s43, 0
  global_load_ushort v72, v31, s[42:43]
  s_add_u32 s42, s42, 3584
  s_addc_u32 s43, s43, 0
  global_load_ushort v73, v31, s[42:43]
  s_add_u32 s42, s42, 3584
  s_addc_u32 s43, s43, 0
  global_load_ushort v74, v31, s[42:43]
  s_add_u32 s42, s42, 3584
  s_addc_u32 s43, s43, 0
  global_load_ushort v75, v31, s[42:43]
  s_add_u32 s42, s42, 3584
  s_addc_u32 s43, s43, 0
  global_load_ushort v76, v31, s[42:43]
  s_add_u32 s42, s42, 3584
  s_addc_u32 s43, s43, 0
  global_load_ushort v77, v31, s[42:43]
  s_add_u32 s42, s42, 3584
  s_addc_u32 s43, s43, 0
  global_load_ushort v78, v31, s[42:43]
  s_add_u32 s42, s42, 3584
  s_addc_u32 s43, s43, 0
  global_load_ushort v79, v31, s[42:43]
  s_add_u32 s42, s42, 89600
  s_addc_u32 s43, s43, 0
  s_add_u32 s42, s18, s31
  s_addc_u32 s43, s19, 0
  s_mov_b32 exec_lo, 0xff00ff00
  s_mov_b32 exec_hi, 0xff00ff00
  global_load_ushort v48, v31, s[42:43]
  s_add_u32 s42, s42, 3584
  s_addc_u32 s43, s43, 0
  global_load_ushort v49, v31, s[42:43]
  s_add_u32 s42, s42, 3584
  s_addc_u32 s43, s43, 0
  global_load_ushort v50, v31, s[42:43]
  s_add_u32 s42, s42, 3584
  s_addc_u32 s43, s43, 0
  global_load_ushort v51, v31, s[42:43]
  s_add_u32 s42, s42, 3584
  s_addc_u32 s43, s43, 0
  global_load_ushort v52, v31, s[42:43]
  s_add_u32 s42, s42, 3584
  s_addc_u32 s43, s43, 0
  global_load_ushort v53, v31, s[42:43]
  s_add_u32 s42, s42, 3584
  s_addc_u32 s43, s43, 0
  global_load_ushort v54, v31, s[42:43]
  s_add_u32 s42, s42, 3584
  s_addc_u32 s43, s43, 0
  global_load_ushort v55, v31, s[42:43]
  s_add_u32 s42, s42, 89600
  s_addc_u32 s43, s43, 0
  global_load_ushort v56, v31, s[42:43]
  s_add_u32 s42, s42, 3584
  s_addc_u32 s43, s43, 0
  global_load_ushort v57, v31, s[42:43]
  s_add_u32 s42, s42, 3584
  s_addc_u32 s43, s43, 0
  global_load_ushort v58, v31, s[42:43]
  s_add_u32 s42, s42, 3584
  s_addc_u32 s43, s43, 0
  global_load_ushort v59, v31, s[42:43]
  s_add_u32 s42, s42, 3584
  s_addc_u32 s43, s43, 0
  global_load_ushort v60, v31, s[42:43]
  s_add_u32 s42, s42, 3584
  s_addc_u32 s43, s43, 0
  global_load_ushort v61, v31, s[42:43]
  s_add_u32 s42, s42, 3584
  s_addc_u32 s43, s43, 0
  global_load_ushort v62, v31, s[42:43]
  s_add_u32 s42, s42, 3584
  s_addc_u32 s43, s43, 0
  global_load_ushort v63, v31, s[42:43]
  s_add_u32 s42, s42, 89600
  s_addc_u32 s43, s43, 0
  global_load_ushort v64, v31, s[42:43]
  s_add_u32 s42, s42, 3584
  s_addc_u32 s43, s43, 0
  global_load_ushort v65, v31, s[42:43]
  s_add_u32 s42, s42, 3584
  s_addc_u32 s43, s43, 0
  global_load_ushort v66, v31, s[42:43]
  s_add_u32 s42, s42, 3584
  s_addc_u32 s43, s43, 0
  global_load_ushort v67, v31, s[42:43]
  s_add_u32 s42, s42, 3584
  s_addc_u32 s43, s43, 0
  global_load_ushort v68, v31, s[42:43]
  s_add_u32 s42, s42, 3584
  s_addc_u32 s43, s43, 0
  global_load_ushort v69, v31, s[42:43]
  s_add_u32 s42, s42, 3584
  s_addc_u32 s43, s43, 0
  global_load_ushort v70, v31, s[42:43]
  s_add_u32 s42, s42, 3584
  s_addc_u32 s43, s43, 0
  global_load_ushort v71, v31, s[42:43]
  s_add_u32 s42, s42, 89600
  s_addc_u32 s43, s43, 0
  global_load_ushort v72, v31, s[42:43]
  s_add_u32 s42, s42, 3584
  s_addc_u32 s43, s43, 0
  global_load_ushort v73, v31, s[42:43]
  s_add_u32 s42, s42, 3584
  s_addc_u32 s43, s43, 0
  global_load_ushort v74, v31, s[42:43]
  s_add_u32 s42, s42, 3584
  s_addc_u32 s43, s43, 0
  global_load_ushort v75, v31, s[42:43]
  s_add_u32 s42, s42, 3584
  s_addc_u32 s43, s43, 0
  global_load_ushort v76, v31, s[42:43]
  s_add_u32 s42, s42, 3584
  s_addc_u32 s43, s43, 0
  global_load_ushort v77, v31, s[42:43]
  s_add_u32 s42, s42, 3584
  s_addc_u32 s43, s43, 0
  global_load_ushort v78, v31, s[42:43]
  s_add_u32 s42, s42, 3584
  s_addc_u32 s43, s43, 0
  global_load_ushort v79, v31, s[42:43]
  s_add_u32 s42, s42, 89600
  s_addc_u32 s43, s43, 0
  s_mov_b64 exec, -1
  s_lshl_b32 s31, s65, 13
  s_add_u32 s42, s20, s31
  s_addc_u32 s43, s21, 0
  v_lshlrev_b32 v31, 2, v0
  global_load_dword v96, v31, s[42:43] offset:0
  global_load_dword v97, v31, s[42:43] offset:1024
  global_load_dword v98, v31, s[42:43] offset:2048
  global_load_dword v99, v31, s[42:43] offset:3072
  s_add_u32 s42, s42, 4096
  s_addc_u32 s43, s43, 0
  global_load_dword v100, v31, s[42:43] offset:0
  global_load_dword v101, v31, s[42:43] offset:1024
  global_load_dword v102, v31, s[42:43] offset:2048
  global_load_dword v103, v31, s[42:43] offset:3072
L_if_48:
L_if_47:
  s_cmp_eq_u32 s3, 0
  s_cbranch_scc0 L_if_49
  v_and_b32 v104, 31, v1
  v_lshlrev_b32 v104, 14, v104
  s_lshl_b32 s31, s28, 19
  s_lshl_b32 s66, s29, 7
  s_add_u32 s31, s31, s66
  s_add_u32 s31, s31, 135168
  v_add_u32 v104, s31, v104
  v_lshrrev_b32 v105, 5, v1
  v_lshl_add_u32 v106, v105, 5, v104
  v_lshlrev_b32 v105, 4, v105
  s_nop 1
L_pl_50:
  global_load_dwordx4 v[108:111], v106, s[26:27] sc1
  global_load_dwordx4 v[112:115], v106, s[26:27] offset:16 sc1
  global_load_dwordx2 v[116:117], v104, s[26:27] offset:64 sc1
  s_waitcnt vmcnt(0)
  v_max3_u32 v107, v108, v109, v110
  v_max3_u32 v107, v107, v111, v112
  v_max3_u32 v107, v107, v113, v114
  v_max3_u32 v107, v107, v115, v116
  v_max_u32 v107, v107, v117
  v_cmp_eq_u32 vcc, -1, v107
  s_sub_u32 s30, s30, 1
  s_cselect_b32 s30, 0, s30
  s_cbranch_scc1 L_pd_51
  s_cbranch_vccnz L_pl_50
L_pd_51:
  v_mov_b32 v118, v116
  s_nop 1
  v_max_f32_dpp v118, v118, v118 quad_perm:[1,0,3,2] row_mask:0xf bank_mask:0xf
  s_nop 1
  v_max_f32_dpp v118, v118, v118 quad_perm:[2,3,0,1] row_mask:0xf bank_mask:0xf
  s_nop 1
  v_max_f32_dpp v118, v118, v118 row_half_mirror row_mask:0xf bank_mask:0xf
  s_nop 1
  v_max_f32_dpp v118, v118, v118 row_mirror row_mask:0xf bank_mask:0xf
  v_mov_b32 v119, v118
  s_nop 1
  v_permlane16_swap_b32 v118, v119
  v_max_f32 v118, v118, v119
  v_sub_f32 v119, v116, v118
  v_exp_f32 v119, v119
  s_nop 0
  v_mul_f32 v117, v119, v117
  v_mul_f32 v108, v119, v108
  v_mul_f32 v109, v119, v109
  v_mul_f32 v110, v119, v110
  v_mul_f32 v111, v119, v111
  v_mul_f32 v112, v119, v112
  v_mul_f32 v113, v119, v113
  v_mul_f32 v114, v119, v114
  v_mul_f32 v115, v119, v115
  v_add_f32_dpp v108, v108, v108 quad_perm:[1,0,3,2] row_mask:0xf bank_mask:0xf
  v_add_f32_dpp v109, v109, v109 quad_perm:[1,0,3,2] row_mask:0xf bank_mask:0xf
  v_add_f32_dpp v110, v110, v110 quad_perm:[1,0,3,2] row_mask:0xf bank_mask:0xf
  v_add_f32_dpp v111, v111, v111 quad_perm:[1,0,3,2] row_mask:0xf bank_mask:0xf
  v_add_f32_dpp v112, v112, v112 quad_perm:[1,0,3,2] row_mask:0xf bank_mask:0xf
  v_add_f32_dpp v113, v113, v113 quad_perm:[1,0,3,2] row_mask:0xf bank_mask:0xf
  v_add_f32_dpp v114, v114, v114 quad_perm:[1,0,3,2] row_mask:0xf bank_mask:0xf
  v_add_f32_dpp v115, v115, v115 quad_perm:[1,0,3,2] row_mask:0xf bank_mask:0xf
  v_add_f32_dpp v117, v117, v117 quad_perm:[1,0,3,2] row_mask:0xf bank_mask:0xf
  v_add_f32_dpp v108, v108, v108 quad_perm:[2,3,0,1] row_mask:0xf bank_mask:0xf
  v_add_f32_dpp v109, v109, v109 quad_perm:[2,3,0,1] row_mask:0xf bank_mask:0xf
  v_add_f32_dpp v110, v110, v110 quad_perm:[2,3,0,1] row_mask:0xf bank_mask:0xf
  v_add_f32_dpp v111, v111, v111 quad_perm:[2,3,0,1] row_mask:0xf bank_mask:0xf
  v_add_f32_dpp v112, v112, v112 quad_perm:[2,3,0,1] row_mask:0xf bank_mask:0xf
  v_add_f32_dpp v113, v113, v113 quad_perm:[2,3,0,1] row_mask:0xf bank_mask:0xf
  v_add_f32_dpp v114, v114, v114 quad_perm:[2,3,0,1] row_mask:0xf bank_mask:0xf
  v_add_f32_dpp v115, v115, v115 quad_perm:[2,3,0,1] row_mask:0xf bank_mask:0xf
  v_add_f32_dpp v117, v117, v117 quad_perm:[2,3,0,1] row_mask:0xf bank_mask:0xf
  v_add_f32_dpp v108, v108, v108 row_half_mirror row_mask:0xf bank_mask:0xf
  v_add_f32_dpp v109, v109, v109 row_half_mirror row_mask:0xf bank_mask:0xf
  v_add_f32_dpp v110, v110, v110 row_half_mirror row_mask:0xf bank_mask:0xf
  v_add_f32_dpp v111, v111, v111 row_half_mirror row_mask:0xf bank_mask:0xf
  v_add_f32_dpp v112, v112, v112 row_half_mirror row_mask:0xf bank_mask:0xf
  v_add_f32_dpp v113, v113, v113 row_half_mirror row_mask:0xf bank_mask:0xf
  v_add_f32_dpp v114, v114, v114 row_half_mirror row_mask:0xf bank_mask:0xf
  v_add_f32_dpp v115, v115, v115 row_half_mirror row_mask:0xf bank_mask:0xf
  v_add_f32_dpp v117, v117, v117 row_half_mirror row_mask:0xf bank_mask:0xf
  v_add_f32_dpp v108, v108, v108 row_mirror row_mask:0xf bank_mask:0xf
  v_add_f32_dpp v109, v109, v109 row_mirror row_mask:0xf bank_mask:0xf
  v_add_f32_dpp v110, v110, v110 row_mirror row_mask:0xf bank_mask:0xf
  v_add_f32_dpp v111, v111, v111 row_mirror row_mask:0xf bank_mask:0xf
  v_add_f32_dpp v112, v112, v112 row_mirror row_mask:0xf bank_mask:0xf
  v_add_f32_dpp v113, v113, v113 row_mirror row_mask:0xf bank_mask:0xf
  v_add_f32_dpp v114, v114, v114 row_mirror row_mask:0xf bank_mask:0xf
  v_add_f32_dpp v115, v115, v115 row_mirror row_mask:0xf bank_mask:0xf
  v_add_f32_dpp v117, v117, v117 row_mirror row_mask:0xf bank_mask:0xf
  v_mov_b32 v118, v108
  v_mov_b32 v119, v109
  v_mov_b32 v120, v110
  v_mov_b32 v121, v111
  v_mov_b32 v122, v112
  v_mov_b32 v123, v113
  v_mov_b32 v124, v114
  v_mov_b32 v125, v115
  v_mov_b32 v126, v117
  v_permlane16_swap_b32 v108, v118
  v_permlane16_swap_b32 v109, v119
  v_permlane16_swap_b32 v110, v120
  v_permlane16_swap_b32 v111, v121
  v_permlane16_swap_b32 v112, v122
  v_permlane16_swap_b32 v113, v123
  v_permlane16_swap_b32 v114, v124
  v_permlane16_swap_b32 v115, v125
  v_permlane16_swap_b32 v117, v126
  v_add_f32 v108, v108, v118
  v_add_f32 v109, v109, v119
  v_add_f32 v110, v110, v120
  v_add_f32 v111, v111, v121
  v_add_f32 v112, v112, v122
  v_add_f32 v113, v113, v123
  v_add_f32 v114, v114, v124
  v_add_f32 v115, v115, v125
  v_add_f32 v117, v117, v126
  v_rcp_f32 v117, v117
  s_nop 0
  v_mul_f32 v108, v108, v117
  v_mul_f32 v109, v109, v117
  v_mul_f32 v110, v110, v117
  v_mul_f32 v111, v111, v117
  v_mul_f32 v112, v112, v117
  v_mul_f32 v113, v113, v117
  v_mul_f32 v114, v114, v117
  v_mul_f32 v115, v115, v117
  v_cvt_pk_bf16_f32 v108, v108, v109
  v_cvt_pk_bf16_f32 v109, v110, v111
  v_cvt_pk_bf16_f32 v110, v112, v113
  v_cvt_pk_bf16_f32 v111, v114, v115
  ds_write_b128 v105, v[108:111] offset:10496
  s_waitcnt lgkmcnt(0)
L_if_49:
  s_barrier
  v_mov_b32 v104, 0
  ds_read_b128 v[108:111], v104 offset:10496
  ds_read_b128 v[112:115], v104 offset:10512
  v_mov_b32 v116, 0
  v_mov_b32 v117, 0
  v_lshlrev_b32 v104, 3, v0
  v_add_u32 v104, 10240, v104
  s_waitcnt lgkmcnt(0)
  v_dot2_f32_bf16 v116, v108, v80, v116
  v_dot2_f32_bf16 v117, v108, v81, v117
  v_dot2_f32_bf16 v116, v109, v82, v116
  v_dot2_f32_bf16 v117, v109, v83, v117
  v_dot2_f32_bf16 v116, v110, v84, v116
  v_dot2_f32_bf16 v117, v110, v85, v117
  v_dot2_f32_bf16 v116, v111, v86, v116
  v_dot2_f32_bf16 v117, v111, v87, v117
  v_dot2_f32_bf16 v116, v112, v88, v116
  v_dot2_f32_bf16 v117, v112, v89, v117
  v_dot2_f32_bf16 v116, v113, v90, v116
  v_dot2_f32_bf16 v117, v113, v91, v117
  v_dot2_f32_bf16 v116, v114, v92, v116
  v_dot2_f32_bf16 v117, v114, v93, v117
  v_dot2_f32_bf16 v116, v115, v94, v116
  v_dot2_f32_bf16 v117, v115, v95, v117
  s_nop 1
  v_min_u32 v116, s63, v116
  v_min_u32 v117, s63, v117
  global_store_dwordx2 v104, v[116:117], s[40:41] sc1
  s_cmp_lt_u32 s2, 32
  s_cbranch_scc0 L_if_52
  v_lshrrev_b32 v104, 2, v0
  v_lshlrev_b32 v104, 14, v104
  v_and_b32 v105, 3, v0
  v_lshl_add_u32 v104, v105, 4, v104
  s_lshl_b32 s31, s2, 6
  s_add_u32 s31, s31, 141312
  v_add_u32 v104, s31, v104
  v_add_u32 v106, 1048576, v104
  v_add_u32 v107, 2097152, v104
  v_add_u32 v108, 3145728, v104
  s_nop 1
L_pl_53:
  global_load_dwordx4 v[112:115], v104, s[26:27] sc1
  global_load_dwordx4 v[116:119], v106, s[26:27] sc1
  global_load_dwordx4 v[120:123], v107, s[26:27] sc1
  global_load_dwordx4 v[124:127], v108, s[26:27] sc1
  s_waitcnt vmcnt(0)
  v_max3_u32 v109, v112, v113, v114
  v_max3_u32 v109, v109, v115, v116
  v_max3_u32 v109, v109, v117, v118
  v_max3_u32 v109, v109, v119, v120
  v_max3_u32 v109, v109, v121, v122
  v_max3_u32 v109, v109, v123, v124
  v_max3_u32 v109, v109, v125, v126
  v_max_u32 v109, v109, v127
  v_cmp_eq_u32 vcc, -1, v109
  s_sub_u32 s30, s30, 1
  s_cselect_b32 s30, 0, s30
  s_cbranch_scc1 L_pd_54
  s_cbranch_vccnz L_pl_53
L_pd_54:
  v_add_f32 v112, v112, v116
  v_add_f32 v120, v120, v124
  v_add_f32 v113, v113, v117
  v_add_f32 v121, v121, v125
  v_add_f32 v114, v114, v118
  v_add_f32 v122, v122, v126
  v_add_f32 v115, v115, v119
  v_add_f32 v123, v123, v127
  v_add_f32 v112, v112, v120
  v_add_f32 v113, v113, v121
  v_add_f32 v114, v114, v122
  v_add_f32 v115, v115, v123
  v_add_f32_dpp v112, v112, v112 row_ror:4 row_mask:0xf bank_mask:0xf
  v_add_f32_dpp v113, v113, v113 row_ror:4 row_mask:0xf bank_mask:0xf
  v_add_f32_dpp v114, v114, v114 row_ror:4 row_mask:0xf bank_mask:0xf
  v_add_f32_dpp v115, v115, v115 row_ror:4 row_mask:0xf bank_mask:0xf
  v_add_f32_dpp v112, v112, v112 row_ror:8 row_mask:0xf bank_mask:0xf
  v_add_f32_dpp v113, v113, v113 row_ror:8 row_mask:0xf bank_mask:0xf
  v_add_f32_dpp v114, v114, v114 row_ror:8 row_mask:0xf bank_mask:0xf
  v_add_f32_dpp v115, v115, v115 row_ror:8 row_mask:0xf bank_mask:0xf
  v_mov_b32 v116, v112
  v_mov_b32 v117, v113
  v_mov_b32 v118, v114
  v_mov_b32 v119, v115
  v_permlane16_swap_b32 v112, v116
  v_permlane16_swap_b32 v113, v117
  v_permlane16_swap_b32 v114, v118
  v_permlane16_swap_b32 v115, v119
  v_add_f32 v112, v112, v116
  v_add_f32 v113, v113, v117
  v_add_f32 v114, v114, v118
  v_add_f32 v115, v115, v119
  v_mov_b32 v116, v112
  v_mov_b32 v117, v113
  v_mov_b32 v118, v114
  v_mov_b32 v119, v115
  v_permlane32_swap_b32 v112, v116
  v_permlane32_swap_b32 v113, v117
  v_permlane32_swap_b32 v114, v118
  v_permlane32_swap_b32 v115, v119
  v_add_f32 v112, v112, v116
  v_add_f32 v113, v113, v117
  v_add_f32 v114, v114, v118
  v_add_f32 v115, v115, v119
  s_lshl_b32 s31, s3, 6
  v_lshl_add_u32 v109, v105, 4, s31
  ds_write_b128 v109, v[112:115] offset:9728
  v_lshlrev_b32 v109, 4, v105
  s_waitcnt lgkmcnt(0)
  s_barrier
  ds_read_b128 v[112:115], v109 offset:9728
  ds_read_b128 v[116:119], v109 offset:9792
  ds_read_b128 v[120:123], v109 offset:9856
  ds_read_b128 v[124:127], v109 offset:9920
  s_waitcnt lgkmcnt(0)
  v_add_f32 v112, v112, v116
  v_add_f32 v120, v120, v124
  v_add_f32 v113, v113, v117
  v_add_f32 v121, v121, v125
  v_add_f32 v114, v114, v118
  v_add_f32 v122, v122, v126
  v_add_f32 v115, v115, v119
  v_add_f32 v123, v123, v127
  v_add_f32 v112, v112, v120
  v_add_f32 v113, v113, v121
  v_add_f32 v114, v114, v122
  v_add_f32 v115, v115, v123
  v_cvt_pk_bf16_f32 v116, v112, v113
  v_cvt_pk_bf16_f32 v117, v114, v115
  v_lshlrev_b32 v112, 16, v116
  v_and_b32 v113, 0xffff0000, v116
  v_lshlrev_b32 v120, 16, v26
  v_and_b32 v121, 0xffff0000, v26
  v_lshlrev_b32 v114, 16, v117
  v_and_b32 v115, 0xffff0000, v117
  v_lshlrev_b32 v122, 16, v27
  v_and_b32 v123, 0xffff0000, v27
  v_add_f32 v112, v112, v120
  v_add_f32 v113, v113, v121
  v_add_f32 v114, v114, v122
  v_add_f32 v115, v115, v123
  v_cvt_pk_bf16_f32 v26, v112, v113
  v_cvt_pk_bf16_f32 v27, v114, v115
  s_cmp_eq_u32 s3, 0
  s_cbranch_scc0 L_if_55
  s_lshl_b32 s31, s2, 7
  s_add_u32 s31, s31, 69632
  v_lshl_add_u32 v109, v105, 3, s31
  v_min_u32 v112, s63, v26
  v_min_u32 v113, s63, v27
  global_store_dwordx2 v109, v[112:113], s[26:27] sc1
L_if_55:
L_if_52:
  s_cmp_eq_u32 s3, 0
  s_cbranch_scc0 L_if_56
  s_cmp_lt_u32 s2, 224
  s_cbranch_scc0 L_if_57
  s_lshl_b32 s31, s3, 7
  v_lshl_add_u32 v31, v3, 3, s31
  s_movk_i32 s31, 3584
  v_mul_lo_u32 v31, v31, s31
  v_and_b32 v124, 7, v2
  v_lshl_add_u32 v31, v124, 1, v31
  s_lshl_b32 s31, s65, 4
  s_add_u32 s42, s16, s31
  s_addc_u32 s43, s17, 0
  s_mov_b32 exec_lo, 0x00ff00ff
  s_mov_b32 exec_hi, 0x00ff00ff
  global_load_ushort v48, v31, s[42:43]
  s_add_u32 s42, s42, 3584
  s_addc_u32 s43, s43, 0
  global_load_ushort v49, v31, s[42:43]
  s_add_u32 s42, s42, 3584
  s_addc_u32 s43, s43, 0
  global_load_ushort v50, v31, s[42:43]
  s_add_u32 s42, s42, 3584
  s_addc_u32 s43, s43, 0
  global_load_ushort v51, v31, s[42:43]
  s_add_u32 s42, s42, 3584
  s_addc_u32 s43, s43, 0
  global_load_ushort v52, v31, s[42:43]
  s_add_u32 s42, s42, 3584
  s_addc_u32 s43, s43, 0
  global_load_ushort v53, v31, s[42:43]
  s_add_u32 s42, s42, 3584
  s_addc_u32 s43, s43, 0
  global_load_ushort v54, v31, s[42:43]
  s_add_u32 s42, s42, 3584
  s_addc_u32 s43, s43, 0
  global_load_ushort v55, v31, s[42:43]
  s_add_u32 s42, s42, 89600
  s_addc_u32 s43, s43, 0
  global_load_ushort v56, v31, s[42:43]
  s_add_u32 s42, s42, 3584
  s_addc_u32 s43, s43, 0
  global_load_ushort v57, v31, s[42:43]
  s_add_u32 s42, s42, 3584
  s_addc_u32 s43, s43, 0
  global_load_ushort v58, v31, s[42:43]
  s_add_u32 s42, s42, 3584
  s_addc_u32 s43, s43, 0
  global_load_ushort v59, v31, s[42:43]
  s_add_u32 s42, s42, 3584
  s_addc_u32 s43, s43, 0
  global_load_ushort v60, v31, s[42:43]
  s_add_u32 s42, s42, 3584
  s_addc_u32 s43, s43, 0
  global_load_ushort v61, v31, s[42:43]
  s_add_u32 s42, s42, 3584
  s_addc_u32 s43, s43, 0
  global_load_ushort v62, v31, s[42:43]
  s_add_u32 s42, s42, 3584
  s_addc_u32 s43, s43, 0
  global_load_ushort v63, v31, s[42:43]
  s_add_u32 s42, s42, 89600
  s_addc_u32 s43, s43, 0
  global_load_ushort v64, v31, s[42:43]
  s_add_u32 s42, s42, 3584
  s_addc_u32 s43, s43, 0
  global_load_ushort v65, v31, s[42:43]
  s_add_u32 s42, s42, 3584
  s_addc_u32 s43, s43, 0
  global_load_ushort v66, v31, s[42:43]
  s_add_u32 s42, s42, 3584
  s_addc_u32 s43, s43, 0
  global_load_ushort v67, v31, s[42:43]
  s_add_u32 s42, s42, 3584
  s_addc_u32 s43, s43, 0
  global_load_ushort v68, v31, s[42:43]
  s_add_u32 s42, s42, 3584
  s_addc_u32 s43, s43, 0
  global_load_ushort v69, v31, s[42:43]
  s_add_u32 s42, s42, 3584
  s_addc_u32 s43, s43, 0
  global_load_ushort v70, v31, s[42:43]
  s_add_u32 s42, s42, 3584
  s_addc_u32 s43, s43, 0
  global_load_ushort v71, v31, s[42:43]
  s_add_u32 s42, s42, 89600
  s_addc_u32 s43, s43, 0
  global_load_ushort v72, v31, s[42:43]
  s_add_u32 s42, s42, 3584
  s_addc_u32 s43, s43, 0
  global_load_ushort v73, v31, s[42:43]
  s_add_u32 s42, s42, 3584
  s_addc_u32 s43, s43, 0
  global_load_ushort v74, v31, s[42:43]
  s_add_u32 s42, s42, 3584
  s_addc_u32 s43, s43, 0
  global_load_ushort v75, v31, s[42:43]
  s_add_u32 s42, s42, 3584
  s_addc_u32 s43, s43, 0
  global_load_ushort v76, v31, s[42:43]
  s_add_u32 s42, s42, 3584
  s_addc_u32 s43, s43, 0
  global_load_ushort v77, v31, s[42:43]
  s_add_u32 s42, s42, 3584
  s_addc_u32 s43, s43, 0
  global_load_ushort v78, v31, s[42:43]
  s_add_u32 s42, s42, 3584
  s_addc_u32 s43, s43, 0
  global_load_ushort v79, v31, s[42:43]
  s_add_u32 s42, s42, 89600
  s_addc_u32 s43, s43, 0
  s_add_u32 s42, s18, s31
  s_addc_u32 s43, s19, 0
  s_mov_b32 exec_lo, 0xff00ff00
  s_mov_b32 exec_hi, 0xff00ff00
  global_load_ushort v48, v31, s[42:43]
  s_add_u32 s42, s42, 3584
  s_addc_u32 s43, s43, 0
  global_load_ushort v49, v31, s[42:43]
  s_add_u32 s42, s42, 3584
  s_addc_u32 s43, s43, 0
  global_load_ushort v50, v31, s[42:43]
  s_add_u32 s42, s42, 3584
  s_addc_u32 s43, s43, 0
  global_load_ushort v51, v31, s[42:43]
  s_add_u32 s42, s42, 3584
  s_addc_u32 s43, s43, 0
  global_load_ushort v52, v31, s[42:43]
  s_add_u32 s42, s42, 3584
  s_addc_u32 s43, s43, 0
  global_load_ushort v53, v31, s[42:43]
  s_add_u32 s42, s42, 3584
  s_addc_u32 s43, s43, 0
  global_load_ushort v54, v31, s[42:43]
  s_add_u32 s42, s42, 3584
  s_addc_u32 s43, s43, 0
  global_load_ushort v55, v31, s[42:43]
  s_add_u32 s42, s42, 89600
  s_addc_u32 s43, s43, 0
  global_load_ushort v56, v31, s[42:43]
  s_add_u32 s42, s42, 3584
  s_addc_u32 s43, s43, 0
  global_load_ushort v57, v31, s[42:43]
  s_add_u32 s42, s42, 3584
  s_addc_u32 s43, s43, 0
  global_load_ushort v58, v31, s[42:43]
  s_add_u32 s42, s42, 3584
  s_addc_u32 s43, s43, 0
  global_load_ushort v59, v31, s[42:43]
  s_add_u32 s42, s42, 3584
  s_addc_u32 s43, s43, 0
  global_load_ushort v60, v31, s[42:43]
  s_add_u32 s42, s42, 3584
  s_addc_u32 s43, s43, 0
  global_load_ushort v61, v31, s[42:43]
  s_add_u32 s42, s42, 3584
  s_addc_u32 s43, s43, 0
  global_load_ushort v62, v31, s[42:43]
  s_add_u32 s42, s42, 3584
  s_addc_u32 s43, s43, 0
  global_load_ushort v63, v31, s[42:43]
  s_add_u32 s42, s42, 89600
  s_addc_u32 s43, s43, 0
  global_load_ushort v64, v31, s[42:43]
  s_add_u32 s42, s42, 3584
  s_addc_u32 s43, s43, 0
  global_load_ushort v65, v31, s[42:43]
  s_add_u32 s42, s42, 3584
  s_addc_u32 s43, s43, 0
  global_load_ushort v66, v31, s[42:43]
  s_add_u32 s42, s42, 3584
  s_addc_u32 s43, s43, 0
  global_load_ushort v67, v31, s[42:43]
  s_add_u32 s42, s42, 3584
  s_addc_u32 s43, s43, 0
  global_load_ushort v68, v31, s[42:43]
  s_add_u32 s42, s42, 3584
  s_addc_u32 s43, s43, 0
  global_load_ushort v69, v31, s[42:43]
  s_add_u32 s42, s42, 3584
  s_addc_u32 s43, s43, 0
  global_load_ushort v70, v31, s[42:43]
  s_add_u32 s42, s42, 3584
  s_addc_u32 s43, s43, 0
  global_load_ushort v71, v31, s[42:43]
  s_add_u32 s42, s42, 89600
  s_addc_u32 s43, s43, 0
  global_load_ushort v72, v31, s[42:43]
  s_add_u32 s42, s42, 3584
  s_addc_u32 s43, s43, 0
  global_load_ushort v73, v31, s[42:43]
  s_add_u32 s42, s42, 3584
  s_addc_u32 s43, s43, 0
  global_load_ushort v74, v31, s[42:43]
  s_add_u32 s42, s42, 3584
  s_addc_u32 s43, s43, 0
  global_load_ushort v75, v31, s[42:43]
  s_add_u32 s42, s42, 3584
  s_addc_u32 s43, s43, 0
  global_load_ushort v76, v31, s[42:43]
  s_add_u32 s42, s42, 3584
  s_addc_u32 s43, s43, 0
  global_load_ushort v77, v31, s[42:43]
  s_add_u32 s42, s42, 3584
  s_addc_u32 s43, s43, 0
  global_load_ushort v78, v31, s[42:43]
  s_add_u32 s42, s42, 3584
  s_addc_u32 s43, s43, 0
  global_load_ushort v79, v31, s[42:43]
  s_add_u32 s42, s42, 89600
  s_addc_u32 s43, s43, 0
  s_mov_b64 exec, -1
  s_lshl_b32 s31, s65, 13
  s_add_u32 s42, s20, s31
  s_addc_u32 s43, s21, 0
  v_lshlrev_b32 v31, 2, v0
  global_load_dword v96, v31, s[42:43] offset:0
  global_load_dword v97, v31, s[42:43] offset:1024
  global_load_dword v98, v31, s[42:43] offset:2048
  global_load_dword v99, v31, s[42:43] offset:3072
  s_add_u32 s42, s42, 4096
  s_addc_u32 s43, s43, 0
  global_load_dword v100, v31, s[42:43] offset:0
  global_load_dword v101, v31, s[42:43] offset:1024
  global_load_dword v102, v31, s[42:43] offset:2048
  global_load_dword v103, v31, s[42:43] offset:3072
L_if_57:
L_if_56:
  s_cmp_lt_u32 s2, 224
  s_cbranch_scc0 L_if_58
  s_add_u32 s44, s26, 69632
  s_addc_u32 s45, s27, 0
  s_waitcnt vmcnt(0)
  v_lshl_or_b32 v32, v49, 16, v48
  v_lshl_or_b32 v33, v51, 16, v50
  v_lshl_or_b32 v34, v53, 16, v52
  v_lshl_or_b32 v35, v55, 16, v54
  v_lshl_or_b32 v36, v57, 16, v56
  v_lshl_or_b32 v37, v59, 16, v58
  v_lshl_or_b32 v38, v61, 16, v60
  v_lshl_or_b32 v39, v63, 16, v62
  v_lshl_or_b32 v40, v65, 16, v64
  v_lshl_or_b32 v41, v67, 16, v66
  v_lshl_or_b32 v42, v69, 16, v68
  v_lshl_or_b32 v43, v71, 16, v70
  v_lshl_or_b32 v44, v73, 16, v72
  v_lshl_or_b32 v45, v75, 16, v74
  v_lshl_or_b32 v46, v77, 16, v76
  v_lshl_or_b32 v47, v79, 16, v78
  v_perm_b32 v31, v97, v96, s60
  v_perm_b32 v97, v97, v96, s61
  v_mov_b32 v96, v31
  v_perm_b32 v31, v99, v98, s60
  v_perm_b32 v99, v99, v98, s61
  v_mov_b32 v98, v31
  v_perm_b32 v31, v101, v100, s60
  v_perm_b32 v101, v101, v100, s61
  v_mov_b32 v100, v31
  v_perm_b32 v31, v103, v102, s60
  v_perm_b32 v103, v103, v102, s61
  v_mov_b32 v102, v31
  s_cmp_eq_u32 s3, 0
  s_cbranch_scc0 L_if_59
  v_lshlrev_b32 v116, 4, v1
  s_nop 1
L_pl_60:
  global_load_dwordx4 v[120:123], v25, s[44:45] sc1
  s_waitcnt vmcnt(0)
  v_max3_u32 v117, v120, v121, v122
  v_max_u32 v117, v117, v123
  v_cmp_eq_u32 vcc, -1, v117
  s_sub_u32 s30, s30, 1
  s_cselect_b32 s30, 0, s30
  s_cbranch_scc1 L_pd_61
  s_cbranch_vccnz L_pl_60
L_pd_61:
  v_lshlrev_b32 v108, 16, v120
  v_and_b32 v109, 0xffff0000, v120
  v_lshlrev_b32 v110, 16, v121
  v_and_b32 v111, 0xffff0000, v121
  v_lshlrev_b32 v112, 16, v122
  v_and_b32 v113, 0xffff0000, v122
  v_lshlrev_b32 v114, 16, v123
  v_and_b32 v115, 0xffff0000, v123
  v_readfirstlane_b32 s67, v108
  s_nop 1
  v_subrev_f32 v104, s67, v108
  v_subrev_f32 v105, s67, v109
  v_add_f32 v117, v104, v105
  v_mul_f32 v118, v104, v104
  v_mul_f32 v119, v105, v105
  v_subrev_f32 v104, s67, v110
  v_subrev_f32 v105, s67, v111
  v_add_f32 v117, v117, v104
  v_fmac_f32 v118, v104, v104
  v_add_f32 v117, v117, v105
  v_fmac_f32 v119, v105, v105
  v_subrev_f32 v104, s67, v112
  v_subrev_f32 v105, s67, v113
  v_add_f32 v117, v117, v104
  v_fmac_f32 v118, v104, v104
  v_add_f32 v117, v117, v105
  v_fmac_f32 v119, v105, v105
  v_subrev_f32 v104, s67, v114
  v_subrev_f32 v105, s67, v115
  v_add_f32 v117, v117, v104
  v_fmac_f32 v118, v104, v104
  v_add_f32 v117, v117, v105
  v_fmac_f32 v119, v105, v105
  v_add_f32 v118, v118, v119
  v_add_f32_dpp v117, v117, v117 quad_perm:[1,0,3,2] row_mask:0xf bank_mask:0xf
  s_nop 0
  v_add_f32_dpp v118, v118, v118 quad_perm:[1,0,3,2] row_mask:0xf bank_mask:0xf
  v_add_f32_dpp v117, v117, v117 quad_perm:[2,3,0,1] row_mask:0xf bank_mask:0xf
  s_nop 0
  v_add_f32_dpp v118, v118, v118 quad_perm:[2,3,0,1] row_mask:0xf bank_mask:0xf
  v_add_f32_dpp v117, v117, v117 row_half_mirror row_mask:0xf bank_mask:0xf
  s_nop 0
  v_add_f32_dpp v118, v118, v118 row_half_mirror row_mask:0xf bank_mask:0xf
  v_add_f32_dpp v117, v117, v117 row_mirror row_mask:0xf bank_mask:0xf
  s_nop 0
  v_add_f32_dpp v118, v118, v118 row_mirror row_mask:0xf bank_mask:0xf
  v_mov_b32 v106, v117
  v_mov_b32 v107, v118
  s_nop 0
  v_permlane16_swap_b32 v117, v106
  v_permlane16_swap_b32 v118, v107
  v_add_f32 v117, v117, v106
  v_add_f32 v118, v118, v107
  v_mov_b32 v106, v117
  v_mov_b32 v107, v118
  s_nop 0
  v_permlane32_swap_b32 v117, v106
  v_permlane32_swap_b32 v118, v107
  v_add_f32 v117, v117, v106
  v_add_f32 v118, v118, v107
  v_mul_f32 v117, 0x3b000000, v117
  v_mul_f32 v118, 0x3b000000, v118
  v_fma_f32 v118, -v117, v117, v118
  v_max_f32 v118, 0, v118
  v_add_f32 v117, s67, v117
  v_cvt_pk_bf16_f32 v119, v117, v118
  v_lshlrev_b32 v117, 16, v119
  v_and_b32 v118, 0xffff0000, v119
  v_add_f32 v118, 0x3727c5ac, v118
  v_cvt_pk_bf16_f32 v118, v118, v118
  v_lshlrev_b32 v118, 16, v118
  v_sqrt_f32 v118, v118
  v_sub_f32 v108, v108, v117
  v_sub_f32 v109, v109, v117
  v_sub_f32 v110, v110, v117
  v_sub_f32 v111, v111, v117
  v_sub_f32 v112, v112, v117
  v_sub_f32 v113, v113, v117
  v_sub_f32 v114, v114, v117
  v_sub_f32 v115, v115, v117
  v_cvt_pk_bf16_f32 v118, v118, v118
  v_lshlrev_b32 v118, 16, v118
  v_rcp_f32 v118, v118
  v_cvt_pk_bf16_f32 v104, v108, v109
  v_cvt_pk_bf16_f32 v105, v110, v111
  v_cvt_pk_bf16_f32 v106, v112, v113
  v_cvt_pk_bf16_f32 v107, v114, v115
  v_lshlrev_b32 v108, 16, v104
  v_and_b32 v109, 0xffff0000, v104
  v_lshlrev_b32 v110, 16, v105
  v_and_b32 v111, 0xffff0000, v105
  v_lshlrev_b32 v112, 16, v106
  v_and_b32 v113, 0xffff0000, v106
  v_lshlrev_b32 v114, 16, v107
  v_and_b32 v115, 0xffff0000, v107
  v_mul_f32 v108, v108, v118
  v_mul_f32 v109, v109, v118
  v_mul_f32 v110, v110, v118
  v_mul_f32 v111, v111, v118
  v_mul_f32 v112, v112, v118
  v_mul_f32 v113, v113, v118
  v_mul_f32 v114, v114, v118
  v_mul_f32 v115, v115, v118
  v_cvt_pk_bf16_f32 v104, v108, v109
  v_cvt_pk_bf16_f32 v105, v110, v111
  v_cvt_pk_bf16_f32 v106, v112, v113
  v_cvt_pk_bf16_f32 v107, v114, v115
  ds_write_b128 v116, v[104:107] offset:12288
  s_waitcnt lgkmcnt(0)
L_if_59:
  s_barrier
  s_lshl_b32 s31, s3, 8
  v_lshl_add_u32 v31, v3, 4, s31
  ds_read_b128 v[104:107], v31 offset:12288
  ds_read_b128 v[108:111], v31 offset:12352
  ds_read_b128 v[112:115], v31 offset:12416
  ds_read_b128 v[116:119], v31 offset:12480
  s_lshl_b32 s31, s3, 6
  v_lshl_add_u32 v31, v2, 2, s31
  s_waitcnt lgkmcnt(0)
  v_mfma_f32_16x16x32_bf16 v[80:83], v[104:107], v[32:35], 0
  v_mfma_f32_16x16x32_bf16 v[80:83], v[108:111], v[36:39], v[80:83]
  v_mfma_f32_16x16x32_bf16 v[80:83], v[112:115], v[40:43], v[80:83]
  v_mfma_f32_16x16x32_bf16 v[80:83], v[116:119], v[44:47], v[80:83]
  s_nop 7
  ds_write_b32 v31, v80 offset:9984
  s_waitcnt lgkmcnt(0)
  s_barrier
  v_lshlrev_b32 v31, 2, v2
  ds_read_b32 v104, v31 offset:9984
  ds_read_b32 v105, v31 offset:10048
  ds_read_b32 v106, v31 offset:10112
  ds_read_b32 v107, v31 offset:10176
  s_waitcnt lgkmcnt(0)
  v_add_f32 v104, v104, v105
  v_add_f32 v106, v106, v107
  v_add_f32 v108, v104, v106
  v_cvt_pk_bf16_f32 v109, v108, v108
  v_lshlrev_b32 v109, 16, v109
  s_nop 1
  v_mov_b32_dpp v110, v109 row_ror:8 row_mask:0xf bank_mask:0xf
  v_mul_f32 v111, 0xbfb8aa3b, v109
  v_exp_f32 v111, v111
  s_nop 0
  v_add_f32 v111, 1.0, v111
  v_rcp_f32 v111, v111
  s_nop 0
  v_mul_f32 v111, v109, v111
  v_cvt_pk_bf16_f32 v111, v111, v111
  v_lshlrev_b32 v111, 16, v111
  v_mul_f32 v111, v111, v110
  s_nop 1
  v_mov_b32_dpp v112, v111 quad_perm:[0,0,2,2] row_mask:0xf bank_mask:0xf
  v_mov_b32_dpp v113, v111 quad_perm:[1,1,3,3] row_mask:0xf bank_mask:0xf
  v_cvt_pk_bf16_f32 v112, v112, v113
  s_nop 0
  v_readlane_b32 s48, v112, 0
  v_readlane_b32 s49, v112, 2
  v_readlane_b32 s50, v112, 4
  v_readlane_b32 s51, v112, 6
  v_mov_b32 v114, 0
  v_mov_b32 v115, 0
  v_dot2_f32_bf16 v114, s48, v96, v114
  v_dot2_f32_bf16 v115, s48, v97, v115
  v_dot2_f32_bf16 v114, s49, v98, v114
  v_dot2_f32_bf16 v115, s49, v99, v115
  v_dot2_f32_bf16 v114, s50, v100, v114
  v_dot2_f32_bf16 v115, s50, v101, v115
  v_dot2_f32_bf16 v114, s51, v102, v114
  v_dot2_f32_bf16 v115, s51, v103, v115
  s_nop 1
  v_min_u32 v114, s63, v114
  v_min_u32 v115, s63, v115
  v_lshlrev_b32 v104, 3, v0
  v_add_u32 v104, 14336, v104
  global_store_dwordx2 v104, v[114:115], s[40:41] sc1
L_if_58:
  s_cmp_lt_u32 s2, 32
  s_cbranch_scc0 L_if_62
  v_lshrrev_b32 v104, 2, v0
  v_lshlrev_b32 v104, 14, v104
  v_and_b32 v105, 3, v0
  v_lshl_add_u32 v104, v105, 4, v104
  s_lshl_b32 s31, s2, 6
  s_add_u32 s31, s31, 145408
  v_add_u32 v104, s31, v104
  v_add_u32 v106, 1048576, v104
  v_add_u32 v107, 2097152, v104
  v_add_u32 v108, 3145728, v104
  s_nop 1
L_pl_63:
  global_load_dwordx4 v[112:115], v104, s[26:27] sc1
  global_load_dwordx4 v[116:119], v106, s[26:27] sc1
  global_load_dwordx4 v[120:123], v107, s[26:27] sc1
  global_load_dwordx4 v[124:127], v108, s[26:27] sc1
  s_waitcnt vmcnt(0)
  v_max3_u32 v109, v112, v113, v114
  v_max3_u32 v109, v109, v115, v116
  v_max3_u32 v109, v109, v117, v118
  v_max3_u32 v109, v109, v119, v120
  v_max3_u32 v109, v109, v121, v122
  v_max3_u32 v109, v109, v123, v124
  v_max3_u32 v109, v109, v125, v126
  v_max_u32 v109, v109, v127
  v_cmp_eq_u32 vcc, -1, v109
  s_sub_u32 s30, s30, 1
  s_cselect_b32 s30, 0, s30
  s_cbranch_scc1 L_pd_64
  s_cbranch_vccnz L_pl_63
L_pd_64:
  v_add_f32 v112, v112, v116
  v_add_f32 v120, v120, v124
  v_add_f32 v113, v113, v117
  v_add_f32 v121, v121, v125
  v_add_f32 v114, v114, v118
  v_add_f32 v122, v122, v126
  v_add_f32 v115, v115, v119
  v_add_f32 v123, v123, v127
  v_add_f32 v112, v112, v120
  v_add_f32 v113, v113, v121
  v_add_f32 v114, v114, v122
  v_add_f32 v115, v115, v123
  v_add_f32_dpp v112, v112, v112 row_ror:4 row_mask:0xf bank_mask:0xf
  v_add_f32_dpp v113, v113, v113 row_ror:4 row_mask:0xf bank_mask:0xf
  v_add_f32_dpp v114, v114, v114 row_ror:4 row_mask:0xf bank_mask:0xf
  v_add_f32_dpp v115, v115, v115 row_ror:4 row_mask:0xf bank_mask:0xf
  v_add_f32_dpp v112, v112, v112 row_ror:8 row_mask:0xf bank_mask:0xf
  v_add_f32_dpp v113, v113, v113 row_ror:8 row_mask:0xf bank_mask:0xf
  v_add_f32_dpp v114, v114, v114 row_ror:8 row_mask:0xf bank_mask:0xf
  v_add_f32_dpp v115, v115, v115 row_ror:8 row_mask:0xf bank_mask:0xf
  v_mov_b32 v116, v112
  v_mov_b32 v117, v113
  v_mov_b32 v118, v114
  v_mov_b32 v119, v115
  v_permlane16_swap_b32 v112, v116
  v_permlane16_swap_b32 v113, v117
  v_permlane16_swap_b32 v114, v118
  v_permlane16_swap_b32 v115, v119
  v_add_f32 v112, v112, v116
  v_add_f32 v113, v113, v117
  v_add_f32 v114, v114, v118
  v_add_f32 v115, v115, v119
  v_mov_b32 v116, v112
  v_mov_b32 v117, v113
  v_mov_b32 v118, v114
  v_mov_b32 v119, v115
  v_permlane32_swap_b32 v112, v116
  v_permlane32_swap_b32 v113, v117
  v_permlane32_swap_b32 v114, v118
  v_permlane32_swap_b32 v115, v119
  v_add_f32 v112, v112, v116
  v_add_f32 v113, v113, v117
  v_add_f32 v114, v114, v118
  v_add_f32 v115, v115, v119
  s_lshl_b32 s31, s3, 6
  v_lshl_add_u32 v109, v105, 4, s31
  ds_write_b128 v109, v[112:115] offset:10240
  v_lshlrev_b32 v109, 4, v105
  s_waitcnt lgkmcnt(0)
  s_barrier
  ds_read_b128 v[112:115], v109 offset:10240
  ds_read_b128 v[116:119], v109 offset:10304
  ds_read_b128 v[120:123], v109 offset:10368
  ds_read_b128 v[124:127], v109 offset:10432
  s_waitcnt lgkmcnt(0)
  v_add_f32 v112, v112, v116
  v_add_f32 v120, v120, v124
  v_add_f32 v113, v113, v117
  v_add_f32 v121, v121, v125
  v_add_f32 v114, v114, v118
  v_add_f32 v122, v122, v126
  v_add_f32 v115, v115, v119
  v_add_f32 v123, v123, v127
  v_add_f32 v112, v112, v120
  v_add_f32 v113, v113, v121
  v_add_f32 v114, v114, v122
  v_add_f32 v115, v115, v123
  v_cvt_pk_bf16_f32 v116, v112, v113
  v_cvt_pk_bf16_f32 v117, v114, v115
  v_lshlrev_b32 v112, 16, v116
  v_and_b32 v113, 0xffff0000, v116
  v_lshlrev_b32 v120, 16, v26
  v_and_b32 v121, 0xffff0000, v26
  v_lshlrev_b32 v114, 16, v117
  v_and_b32 v115, 0xffff0000, v117
  v_lshlrev_b32 v122, 16, v27
  v_and_b32 v123, 0xffff0000, v27
  v_add_f32 v112, v112, v120
  v_add_f32 v113, v113, v121
  v_add_f32 v114, v114, v122
  v_add_f32 v115, v115, v123
  v_cvt_pk_bf16_f32 v26, v112, v113
  v_cvt_pk_bf16_f32 v27, v114, v115
  s_cmp_eq_u32 s3, 0
  s_cbranch_scc0 L_if_65
  s_lshl_b32 s31, s2, 5
  v_lshl_add_u32 v109, v105, 3, s31
  global_store_dwordx2 v109, v[26:27], s[22:23]
L_if_65:
L_if_62:
L_end:
  s_endpgm
.section .rodata,"a"
.p2align 6
.amdhsa_kernel interleave_layers__gqa_block_cached__glu_gated_swiglu__decode_kernel
  .amdhsa_next_free_vgpr 512
  .amdhsa_next_free_sgpr 102
  .amdhsa_accum_offset 256
  .amdhsa_group_segment_fixed_size 0
  .amdhsa_kernarg_size 96
  .amdhsa_user_sgpr_count 2
  .amdhsa_user_sgpr_kernarg_segment_ptr 1
  .amdhsa_system_sgpr_workgroup_id_x 1
.end_amdhsa_kernel
```
